```python
import torch

def _softmax(x, axis=-1):
    return torch.softmax(x, dim=axis)

def _gelu(x):
    return torch.nn.functional.gelu(x, approximate='tanh')

def _silu(x):
    return torch.nn.functional.silu(x)

def _sigmoid(x):
    return torch.sigmoid(x)

def _layernorm(x, axis=-1, eps=1e-05):
    m = x.mean(dim=axis, keepdim=True)
    v = x.var(dim=axis, keepdim=True, unbiased=False)
    return (x - m) / torch.sqrt(v + eps)

def _scatter_add(tgt, idx, src, axis=0):
    return tgt.clone().index_add_(axis, idx, src)

def _segment_sum(src, seg, n):
    out = torch.zeros((n,) + src.shape[1:], dtype=src.dtype)
    return out.index_add_(0, seg, src)

def _pad(x, pw):
    flat = tuple((v for pair in reversed(pw) for v in pair))
    return torch.nn.functional.pad(x, flat)
kernel_name = 'gated_mix__memory_aug_recurrent_mem_tr__dense_activation_silu__prompt'

def setup_inputs():

    _w = lambda a: (lambda t: t.to(torch.bfloat16) if t.is_floating_point() else t)(torch.as_tensor(a))

    def _A_setup():
        B, S, Dm = (1, 2048, 1024)
        H, Dh = (32, 128)
        M, seg = (8, 32)
        seg = min(seg, S)
        S = S // seg * seg
        return {'x': _w((lambda *s: torch.randn(*s, dtype=torch.bfloat16) * 0.1)(B, S, Dm)), 'mem0': _w((lambda *s: torch.randn(*s, dtype=torch.bfloat16) * 0.8)(B, M, Dm)), 'Wq': _w((lambda *s: torch.randn(*s, dtype=torch.bfloat16) * 6.4)(Dm, H, Dh) * Dm ** (-0.5)), 'Wk': _w((lambda *s: torch.randn(*s, dtype=torch.bfloat16) * 6.4)(Dm, H, Dh) * Dm ** (-0.5)), 'Wv': _w((lambda *s: torch.randn(*s, dtype=torch.bfloat16) * 0.8)(Dm, H, Dh) * Dm ** (-0.5)), 'Wo': _w((lambda *s: torch.randn(*s, dtype=torch.bfloat16) * 0.8)(H, Dh, Dm) * (H * Dh) ** (-0.5)), 'seg_len': seg}
    _A_in = _A_setup()

    def _B_setup():
        B, S, D, F = (1, 2048, 1024, 3584)
        return {'x': _w((lambda *s: torch.randn(*s, dtype=torch.bfloat16) * 0.1)(B, S, D)), 'w1': _w((lambda *s: torch.randn(*s, dtype=torch.bfloat16) * 3.2)(D, F) * D ** (-0.5)), 'w2': _w((lambda *s: torch.randn(*s, dtype=torch.bfloat16) * 3.2)(F, D) * F ** (-0.5))}
    _B_in = _B_setup()
    return {'A_x': _A_in['x'], 'A_mem0': _A_in['mem0'], 'A_Wq': _A_in['Wq'], 'A_Wk': _A_in['Wk'], 'A_Wv': _A_in['Wv'], 'A_Wo': _A_in['Wo'], 'A_seg_len': _A_in['seg_len'], 'B_x': _B_in['x'], 'B_w1': _B_in['w1'], 'B_w2': _B_in['w2'], 'gate_w': _w((lambda *s: torch.randn(*s, dtype=torch.bfloat16) * 0.1)(1024) * 16.0)}

def reference(A_x, A_mem0, A_Wq, A_Wk, A_Wv, A_Wo, A_seg_len, B_x, B_w1, B_w2, gate_w):

    def _A_ref(x, mem0, Wq, Wk, Wv, Wo, seg_len):
        B, S, Dm = x.shape
        H, Dh = (Wq.shape[1], Wq.shape[2])
        M = mem0.shape[1]
        scale = Dh ** (-0.5)
        n_seg = S // seg_len
        L = M + seg_len
        idx = torch.arange(L)
        mask = (idx[:, None] < M) | (idx[:, None] >= idx[None, :])
        mem = mem0
        outs = []
        for s in range(n_seg):
            xs = x[:, s * seg_len:(s + 1) * seg_len, :].clone()
            h = torch.concatenate([mem, xs], axis=1)
            q = torch.einsum('btd,dhe->bhte', h, Wq)
            k = torch.einsum('btd,dhe->bhte', h, Wk)
            v = torch.einsum('btd,dhe->bhte', h, Wv)
            scores = torch.einsum('bhqe,bhke->bhqk', q, k) * scale
            scores = torch.where(mask[None, None], scores, -1000000000.0)
            p = _softmax(scores, axis=-1)
            o = torch.einsum('bhqk,bhke->bhqe', p, v)
            o = torch.einsum('bhte,hed->btd', o, Wo)
            mem = o[:, :M, :].clone()
            outs.append(o[:, M:, :])
        return torch.concatenate(outs, axis=1)

    def _B_ref(x, w1, w2):
        h = torch.einsum('bsd,df->bsf', x, w1)
        h = _silu(h)
        out = torch.einsum('bsf,fd->bsd', h, w2)
        return out
    x = A_x
    g = _sigmoid((x * gate_w).sum(-1, keepdims=True))
    a = _A_ref(x, A_mem0, A_Wq, A_Wk, A_Wv, A_Wo, A_seg_len)
    b = _B_ref(x, B_w1, B_w2)
    return g * a + (1 - g) * b
```

```asm
; @launch grid=(256,1,1) block=(256,1,1) lds=163840
.amdgcn_target "amdgcn-amd-amdhsa--gfx950"
.text
.globl gated_mix__memory_aug_recurrent_mem_tr__dense_activation_silu__prompt_kernel
.p2align 8
.type gated_mix__memory_aug_recurrent_mem_tr__dense_activation_silu__prompt_kernel,@function
gated_mix__memory_aug_recurrent_mem_tr__dense_activation_silu__prompt_kernel:
  s_cmp_ge_u32 s2, 256
  s_cbranch_scc1 L_end
  s_getreg_b32 s28, hwreg(HW_REG_XCC_ID, 0, 4)
  s_load_dwordx4 s[4:7], s[0:1], 96
  v_lshrrev_b32 v2, 6, v0
  v_and_b32 v1, 63, v0
  v_readfirstlane_b32 s30, v2
  s_mov_b32 s31, 131072
  s_waitcnt lgkmcnt(0)
  s_mov_b32 s12, s4
  s_mov_b32 s13, s5
  s_mov_b32 s14, 256
  s_mov_b32 s15, 0x20000
  s_mov_b32 s8, s6
  s_mov_b32 s9, s7
  s_mov_b32 s10, 0x10000000
  s_mov_b32 s11, 0x20000
  s_mov_b32 s36, s6
  v_mov_b32 v2, 163328
  s_cmp_ge_u32 s28, 8
  s_cbranch_scc1 L_end
  s_cmp_lg_u32 s30, 0
  s_cbranch_scc1 L_noticket
  s_lshl_b32 s33, s28, 2
  s_add_u32 s34, s33, 128
  s_cmp_lt_u32 s28, 4
  s_cselect_b32 s33, s34, s33
  s_mov_b64 s[96:97], exec
  s_mov_b64 exec, 1
  v_mov_b32 v3, s33
  v_mov_b32 v4, 1
  buffer_atomic_add v4, v3, s[12:15], 0 offen sc0
  s_waitcnt vmcnt(0)
  ds_write_b32 v2, v4
  s_waitcnt lgkmcnt(0)
  s_mov_b64 exec, s[96:97]
L_noticket:
  s_barrier
  ds_read_b32 v4, v2
  s_waitcnt lgkmcnt(0)
  v_readfirstlane_b32 s29, v4
  s_nop 3
  s_cmp_ge_u32 s29, 32
  s_cbranch_scc1 L_end
  s_lshl_b32 s37, s28, 5
  s_add_u32 s37, s37, s29
  s_mov_b32 s39, s29
  s_and_b32 s33, s28, 3
  s_lshl_b32 s34, s33, 3
  s_and_b32 s35, s29, 7
  s_add_u32 s34, s34, s35
  s_cmp_lt_u32 s28, 4
  s_cbranch_scc0 L_bulk
  s_cmp_lt_u32 s39, 8
  s_cbranch_scc1 L_j_QK
  s_cmp_lt_u32 s39, 24
  s_cbranch_scc1 L_j_VO
  s_mov_b32 s29, s34
  s_branch L_role_WO
L_bulk:
  s_lshr_b32 s38, s39, 3
  s_cmp_eq_u32 s38, 3
  s_cbranch_scc1 L_f1g
  s_mov_b32 s29, s34
  s_cmp_eq_u32 s38, 0
  s_cbranch_scc1 L_role_K
  s_cmp_eq_u32 s38, 1
  s_cbranch_scc1 L_j_V
  s_branch L_role_Q
L_f1g:
  s_cmp_eq_u32 s39, 31
  s_cbranch_scc1 L_j_G
  s_mul_i32 s29, s33, 7
  s_add_u32 s29, s29, s35
  s_branch L_role_F1
L_j_V:
  s_branch L_role_V
L_j_G:
  s_mov_b32 s29, s33
  s_branch L_role_GATE
L_j_QK:
  s_branch L_role_QK
L_j_VO:
  s_branch L_role_VO
L_end:
  s_endpgm
L_role_K:
  s_load_dwordx2 s[4:5], s[0:1], 0
  s_waitcnt lgkmcnt(0)
  s_mov_b32 s16, s4
  s_mov_b32 s17, s5
  s_mov_b32 s18, 4194304
  s_mov_b32 s19, 0x20000
  s_load_dwordx2 s[4:5], s[0:1], 24
  s_waitcnt lgkmcnt(0)
  s_mov_b32 s20, s4
  s_mov_b32 s21, s5
  s_mov_b32 s22, 8388608
  s_mov_b32 s23, 0x20000
  s_cmp_lg_u32 s30, 0
  s_cbranch_scc1 w0_1
  s_lshl_b32 s33, s29, 7
  s_add_u32 s33, s33, 0
  s_mov_b64 s[96:97], exec
  s_mov_b64 exec, 1
  v_mov_b32 v10, s33
  v_mov_b32 v11, 0
  buffer_store_dword v11, v10, s[8:11], 0 offen sc1
  s_mov_b64 exec, s[96:97]
  s_lshl_b32 s33, s29, 7
  s_add_u32 s33, s33, 16384
  s_mov_b64 s[96:97], exec
  s_mov_b64 exec, 1
  v_mov_b32 v10, s33
  v_mov_b32 v11, 0
  buffer_store_dword v11, v10, s[8:11], 0 offen sc1
  s_mov_b64 exec, s[96:97]
  s_lshl_b32 s33, s29, 7
  s_add_u32 s33, s33, 49152
  s_mov_b64 s[96:97], exec
  s_mov_b64 exec, 1
  v_mov_b32 v10, s33
  v_mov_b32 v11, 0
  buffer_store_dword v11, v10, s[8:11], 0 offen sc1
  s_mov_b64 exec, s[96:97]
w0_1:
  s_lshl_b32 s52, s29, 7
  s_add_u32 s52, s52, 0
  s_mov_b32 s41, 32768
  s_lshl_b32 s33, s29, 13
  s_lshl_b32 s34, s30, 10
  s_add_u32 s49, s33, s34
  s_add_u32 s49, s49, 16777216
  s_mov_b32 s50, 4096
  v_lshrrev_b32 v10, 4, v1
  v_and_b32 v11, 15, v1
  s_lshr_b32 s33, s41, 2
  v_mul_lo_u32 v2, v10, s33
  v_lshlrev_b32 v12, 2, v10
  v_xor_b32 v12, v12, v11
  v_lshl_add_u32 v2, v12, 4, v2
  v_bfe_u32 v12, v1, 2, 2
  v_lshl_add_u32 v13, v10, 3, v12
  v_lshlrev_b32 v3, 8, v13
  v_and_b32 v13, 3, v1
  s_lshl_b32 s33, s30, 2
  v_add_u32 v13, s33, v13
  v_lshlrev_b32 v12, 2, v12
  v_xor_b32 v13, v13, v12
  v_lshl_add_u32 v3, v13, 4, v3
  v_add_u32 v4, 0x10000, v3
  v_lshlrev_b32 v8, 4, v1
  v_lshrrev_b32 v12, 3, v1
  v_and_b32 v13, 7, v1
  v_xor_b32 v13, v13, v12
  v_lshlrev_b32 v5, 11, v12
  v_lshl_add_u32 v5, v13, 4, v5
  v_and_b32 v12, 7, v1
  v_bfe_u32 v13, v1, 3, 1
  v_lshlrev_b32 v6, 14, v13
  v_lshl_add_u32 v6, v12, 7, v6
  v_xor_b32 v13, v10, v12
  v_lshl_add_u32 v6, v13, 4, v6
  v_xor_b32 v7, 64, v6
  s_lshl_b32 s40, s29, 8
  s_lshl_b32 s33, s41, 3
  s_mul_i32 s33, s33, s30
  s_add_u32 s40, s40, s33
  s_mul_i32 s34, s41, 24
  s_lshl_b32 s35, s30, 13
  v_add_u32 v13, s35, v8
  buffer_load_dwordx4 a[0:3], v2, s[20:23], s40 offen nt
  s_add_u32 s40, s40, s41
  buffer_load_dwordx4 a[4:7], v2, s[20:23], s40 offen nt
  s_add_u32 s40, s40, s41
  buffer_load_dwordx4 a[8:11], v2, s[20:23], s40 offen nt
  s_add_u32 s40, s40, s41
  buffer_load_dwordx4 a[12:15], v2, s[20:23], s40 offen nt
  s_add_u32 s40, s40, s41
  buffer_load_dwordx4 a[16:19], v2, s[20:23], s40 offen nt
  s_add_u32 s40, s40, s41
  buffer_load_dwordx4 a[20:23], v2, s[20:23], s40 offen nt
  s_add_u32 s40, s40, s41
  buffer_load_dwordx4 a[24:27], v2, s[20:23], s40 offen nt
  s_add_u32 s40, s40, s41
  buffer_load_dwordx4 a[28:31], v2, s[20:23], s40 offen nt
  s_add_u32 s40, s40, s41
  s_add_u32 s40, s40, s34
  buffer_load_dwordx4 a[32:35], v2, s[20:23], s40 offen nt
  s_add_u32 s40, s40, s41
  buffer_load_dwordx4 a[36:39], v2, s[20:23], s40 offen nt
  s_add_u32 s40, s40, s41
  buffer_load_dwordx4 a[40:43], v2, s[20:23], s40 offen nt
  s_add_u32 s40, s40, s41
  buffer_load_dwordx4 a[44:47], v2, s[20:23], s40 offen nt
  s_add_u32 s40, s40, s41
  buffer_load_dwordx4 a[48:51], v2, s[20:23], s40 offen nt
  s_add_u32 s40, s40, s41
  buffer_load_dwordx4 a[52:55], v2, s[20:23], s40 offen nt
  s_add_u32 s40, s40, s41
  buffer_load_dwordx4 a[56:59], v2, s[20:23], s40 offen nt
  s_add_u32 s40, s40, s41
  buffer_load_dwordx4 a[60:63], v2, s[20:23], s40 offen nt
  s_add_u32 s40, s40, s41
  s_add_u32 s40, s40, s34
  buffer_load_dwordx4 a[64:67], v2, s[20:23], s40 offen nt
  s_add_u32 s40, s40, s41
  buffer_load_dwordx4 a[68:71], v2, s[20:23], s40 offen nt
  s_add_u32 s40, s40, s41
  buffer_load_dwordx4 a[72:75], v2, s[20:23], s40 offen nt
  s_add_u32 s40, s40, s41
  buffer_load_dwordx4 a[76:79], v2, s[20:23], s40 offen nt
  s_add_u32 s40, s40, s41
  buffer_load_dwordx4 a[80:83], v2, s[20:23], s40 offen nt
  s_add_u32 s40, s40, s41
  buffer_load_dwordx4 a[84:87], v2, s[20:23], s40 offen nt
  s_add_u32 s40, s40, s41
  buffer_load_dwordx4 a[88:91], v2, s[20:23], s40 offen nt
  s_add_u32 s40, s40, s41
  buffer_load_dwordx4 a[92:95], v2, s[20:23], s40 offen nt
  s_add_u32 s40, s40, s41
  s_add_u32 s40, s40, s34
  buffer_load_dwordx4 a[96:99], v2, s[20:23], s40 offen nt
  s_add_u32 s40, s40, s41
  buffer_load_dwordx4 a[100:103], v2, s[20:23], s40 offen nt
  s_add_u32 s40, s40, s41
  buffer_load_dwordx4 a[104:107], v2, s[20:23], s40 offen nt
  s_add_u32 s40, s40, s41
  buffer_load_dwordx4 a[108:111], v2, s[20:23], s40 offen nt
  s_add_u32 s40, s40, s41
  buffer_load_dwordx4 a[112:115], v2, s[20:23], s40 offen nt
  s_add_u32 s40, s40, s41
  buffer_load_dwordx4 a[116:119], v2, s[20:23], s40 offen nt
  s_add_u32 s40, s40, s41
  buffer_load_dwordx4 a[120:123], v2, s[20:23], s40 offen nt
  s_add_u32 s40, s40, s41
  buffer_load_dwordx4 a[124:127], v2, s[20:23], s40 offen nt
  s_add_u32 s40, s40, s41
  s_add_u32 s40, s40, s34
  buffer_load_dwordx4 a[128:131], v2, s[20:23], s40 offen nt
  s_add_u32 s40, s40, s41
  buffer_load_dwordx4 a[132:135], v2, s[20:23], s40 offen nt
  s_add_u32 s40, s40, s41
  buffer_load_dwordx4 a[136:139], v2, s[20:23], s40 offen nt
  s_add_u32 s40, s40, s41
  buffer_load_dwordx4 a[140:143], v2, s[20:23], s40 offen nt
  s_add_u32 s40, s40, s41
  buffer_load_dwordx4 a[144:147], v2, s[20:23], s40 offen nt
  s_add_u32 s40, s40, s41
  buffer_load_dwordx4 a[148:151], v2, s[20:23], s40 offen nt
  s_add_u32 s40, s40, s41
  buffer_load_dwordx4 a[152:155], v2, s[20:23], s40 offen nt
  s_add_u32 s40, s40, s41
  buffer_load_dwordx4 a[156:159], v2, s[20:23], s40 offen nt
  s_add_u32 s40, s40, s41
  s_add_u32 s40, s40, s34
  buffer_load_dwordx4 a[160:163], v2, s[20:23], s40 offen nt
  s_add_u32 s40, s40, s41
  buffer_load_dwordx4 a[164:167], v2, s[20:23], s40 offen nt
  s_add_u32 s40, s40, s41
  buffer_load_dwordx4 a[168:171], v2, s[20:23], s40 offen nt
  s_add_u32 s40, s40, s41
  buffer_load_dwordx4 a[172:175], v2, s[20:23], s40 offen nt
  s_add_u32 s40, s40, s41
  buffer_load_dwordx4 a[176:179], v2, s[20:23], s40 offen nt
  s_add_u32 s40, s40, s41
  buffer_load_dwordx4 a[180:183], v2, s[20:23], s40 offen nt
  s_add_u32 s40, s40, s41
  buffer_load_dwordx4 a[184:187], v2, s[20:23], s40 offen nt
  s_add_u32 s40, s40, s41
  buffer_load_dwordx4 a[188:191], v2, s[20:23], s40 offen nt
  s_add_u32 s40, s40, s41
  s_add_u32 s40, s40, s34
  buffer_load_dwordx4 a[192:195], v2, s[20:23], s40 offen nt
  s_add_u32 s40, s40, s41
  buffer_load_dwordx4 a[196:199], v2, s[20:23], s40 offen nt
  s_add_u32 s40, s40, s41
  buffer_load_dwordx4 a[200:203], v2, s[20:23], s40 offen nt
  s_add_u32 s40, s40, s41
  buffer_load_dwordx4 a[204:207], v2, s[20:23], s40 offen nt
  s_add_u32 s40, s40, s41
  buffer_load_dwordx4 a[208:211], v2, s[20:23], s40 offen nt
  s_add_u32 s40, s40, s41
  buffer_load_dwordx4 a[212:215], v2, s[20:23], s40 offen nt
  s_add_u32 s40, s40, s41
  buffer_load_dwordx4 a[216:219], v2, s[20:23], s40 offen nt
  s_add_u32 s40, s40, s41
  buffer_load_dwordx4 a[220:223], v2, s[20:23], s40 offen nt
  s_add_u32 s40, s40, s41
  s_add_u32 s40, s40, s34
  s_waitcnt vmcnt(48)
  ds_write_b128 v13, a[0:3] offset:0
  ds_write_b128 v13, a[4:7] offset:1024
  ds_write_b128 v13, a[8:11] offset:2048
  ds_write_b128 v13, a[12:15] offset:3072
  ds_write_b128 v13, a[16:19] offset:4096
  ds_write_b128 v13, a[20:23] offset:5120
  ds_write_b128 v13, a[24:27] offset:6144
  ds_write_b128 v13, a[28:31] offset:7168
  s_waitcnt lgkmcnt(0)
  s_barrier
  ds_read_b64_tr_b16 a[0:1], v3 offset:0
  ds_read_b64_tr_b16 a[2:3], v3 offset:1024
  ds_read_b64_tr_b16 a[4:5], v3 offset:8
  ds_read_b64_tr_b16 a[6:7], v3 offset:1032
  ds_read_b64_tr_b16 a[8:9], v3 offset:8192
  ds_read_b64_tr_b16 a[10:11], v3 offset:9216
  ds_read_b64_tr_b16 a[12:13], v3 offset:8200
  ds_read_b64_tr_b16 a[14:15], v3 offset:9224
  ds_read_b64_tr_b16 a[16:17], v3 offset:16384
  ds_read_b64_tr_b16 a[18:19], v3 offset:17408
  ds_read_b64_tr_b16 a[20:21], v3 offset:16392
  ds_read_b64_tr_b16 a[22:23], v3 offset:17416
  ds_read_b64_tr_b16 a[24:25], v3 offset:24576
  ds_read_b64_tr_b16 a[26:27], v3 offset:25600
  ds_read_b64_tr_b16 a[28:29], v3 offset:24584
  ds_read_b64_tr_b16 a[30:31], v3 offset:25608
  s_waitcnt lgkmcnt(0)
  buffer_load_dwordx4 a[224:227], v2, s[20:23], s40 offen nt
  s_add_u32 s40, s40, s41
  buffer_load_dwordx4 a[228:231], v2, s[20:23], s40 offen nt
  s_add_u32 s40, s40, s41
  buffer_load_dwordx4 a[232:235], v2, s[20:23], s40 offen nt
  s_add_u32 s40, s40, s41
  buffer_load_dwordx4 a[236:239], v2, s[20:23], s40 offen nt
  s_add_u32 s40, s40, s41
  buffer_load_dwordx4 a[240:243], v2, s[20:23], s40 offen nt
  s_add_u32 s40, s40, s41
  buffer_load_dwordx4 a[244:247], v2, s[20:23], s40 offen nt
  s_add_u32 s40, s40, s41
  buffer_load_dwordx4 a[248:251], v2, s[20:23], s40 offen nt
  s_add_u32 s40, s40, s41
  buffer_load_dwordx4 a[252:255], v2, s[20:23], s40 offen nt
  s_add_u32 s40, s40, s41
  s_add_u32 s40, s40, s34
  s_cmp_lg_u32 s30, 0
  s_cbranch_scc1 ar_2
  s_mov_b64 s[96:97], exec
  s_mov_b64 exec, 1
  v_mov_b32 v10, 64
  v_mov_b32 v11, 1
  buffer_atomic_add v11, v10, s[12:15], 0 offen
  s_mov_b64 exec, s[96:97]
  s_branch are_3
ar_2:
  s_mov_b64 s[96:97], exec
  s_mov_b64 exec, 1
  v_mov_b32 v10, 81920
  buffer_load_dword v11, v10, s[8:11], 0 offen
  s_mov_b64 exec, s[96:97]
are_3:
  s_waitcnt vmcnt(49)
  ds_write_b128 v13, a[32:35] offset:32768
  ds_write_b128 v13, a[36:39] offset:33792
  ds_write_b128 v13, a[40:43] offset:34816
  ds_write_b128 v13, a[44:47] offset:35840
  ds_write_b128 v13, a[48:51] offset:36864
  ds_write_b128 v13, a[52:55] offset:37888
  ds_write_b128 v13, a[56:59] offset:38912
  ds_write_b128 v13, a[60:63] offset:39936
  s_waitcnt lgkmcnt(0)
  s_barrier
  ds_read_b64_tr_b16 a[32:33], v3 offset:32768
  ds_read_b64_tr_b16 a[34:35], v3 offset:33792
  ds_read_b64_tr_b16 a[36:37], v3 offset:32776
  ds_read_b64_tr_b16 a[38:39], v3 offset:33800
  ds_read_b64_tr_b16 a[40:41], v3 offset:40960
  ds_read_b64_tr_b16 a[42:43], v3 offset:41984
  ds_read_b64_tr_b16 a[44:45], v3 offset:40968
  ds_read_b64_tr_b16 a[46:47], v3 offset:41992
  ds_read_b64_tr_b16 a[48:49], v3 offset:49152
  ds_read_b64_tr_b16 a[50:51], v3 offset:50176
  ds_read_b64_tr_b16 a[52:53], v3 offset:49160
  ds_read_b64_tr_b16 a[54:55], v3 offset:50184
  ds_read_b64_tr_b16 a[56:57], v3 offset:57344
  ds_read_b64_tr_b16 a[58:59], v3 offset:58368
  ds_read_b64_tr_b16 a[60:61], v3 offset:57352
  ds_read_b64_tr_b16 a[62:63], v3 offset:58376
  s_waitcnt lgkmcnt(0)
  s_waitcnt vmcnt(41)
  ds_write_b128 v13, a[64:67] offset:0
  ds_write_b128 v13, a[68:71] offset:1024
  ds_write_b128 v13, a[72:75] offset:2048
  ds_write_b128 v13, a[76:79] offset:3072
  ds_write_b128 v13, a[80:83] offset:4096
  ds_write_b128 v13, a[84:87] offset:5120
  ds_write_b128 v13, a[88:91] offset:6144
  ds_write_b128 v13, a[92:95] offset:7168
  s_waitcnt lgkmcnt(0)
  s_barrier
  ds_read_b64_tr_b16 a[64:65], v3 offset:0
  ds_read_b64_tr_b16 a[66:67], v3 offset:1024
  ds_read_b64_tr_b16 a[68:69], v3 offset:8
  ds_read_b64_tr_b16 a[70:71], v3 offset:1032
  ds_read_b64_tr_b16 a[72:73], v3 offset:8192
  ds_read_b64_tr_b16 a[74:75], v3 offset:9216
  ds_read_b64_tr_b16 a[76:77], v3 offset:8200
  ds_read_b64_tr_b16 a[78:79], v3 offset:9224
  ds_read_b64_tr_b16 a[80:81], v3 offset:16384
  ds_read_b64_tr_b16 a[82:83], v3 offset:17408
  ds_read_b64_tr_b16 a[84:85], v3 offset:16392
  ds_read_b64_tr_b16 a[86:87], v3 offset:17416
  ds_read_b64_tr_b16 a[88:89], v3 offset:24576
  ds_read_b64_tr_b16 a[90:91], v3 offset:25600
  ds_read_b64_tr_b16 a[92:93], v3 offset:24584
  ds_read_b64_tr_b16 a[94:95], v3 offset:25608
  s_waitcnt lgkmcnt(0)
  s_waitcnt vmcnt(33)
  ds_write_b128 v13, a[96:99] offset:32768
  ds_write_b128 v13, a[100:103] offset:33792
  ds_write_b128 v13, a[104:107] offset:34816
  ds_write_b128 v13, a[108:111] offset:35840
  ds_write_b128 v13, a[112:115] offset:36864
  ds_write_b128 v13, a[116:119] offset:37888
  ds_write_b128 v13, a[120:123] offset:38912
  ds_write_b128 v13, a[124:127] offset:39936
  s_waitcnt lgkmcnt(0)
  s_barrier
  ds_read_b64_tr_b16 a[96:97], v3 offset:32768
  ds_read_b64_tr_b16 a[98:99], v3 offset:33792
  ds_read_b64_tr_b16 a[100:101], v3 offset:32776
  ds_read_b64_tr_b16 a[102:103], v3 offset:33800
  ds_read_b64_tr_b16 a[104:105], v3 offset:40960
  ds_read_b64_tr_b16 a[106:107], v3 offset:41984
  ds_read_b64_tr_b16 a[108:109], v3 offset:40968
  ds_read_b64_tr_b16 a[110:111], v3 offset:41992
  ds_read_b64_tr_b16 a[112:113], v3 offset:49152
  ds_read_b64_tr_b16 a[114:115], v3 offset:50176
  ds_read_b64_tr_b16 a[116:117], v3 offset:49160
  ds_read_b64_tr_b16 a[118:119], v3 offset:50184
  ds_read_b64_tr_b16 a[120:121], v3 offset:57344
  ds_read_b64_tr_b16 a[122:123], v3 offset:58368
  ds_read_b64_tr_b16 a[124:125], v3 offset:57352
  ds_read_b64_tr_b16 a[126:127], v3 offset:58376
  s_waitcnt lgkmcnt(0)
  s_waitcnt vmcnt(25)
  ds_write_b128 v13, a[128:131] offset:0
  ds_write_b128 v13, a[132:135] offset:1024
  ds_write_b128 v13, a[136:139] offset:2048
  ds_write_b128 v13, a[140:143] offset:3072
  ds_write_b128 v13, a[144:147] offset:4096
  ds_write_b128 v13, a[148:151] offset:5120
  ds_write_b128 v13, a[152:155] offset:6144
  ds_write_b128 v13, a[156:159] offset:7168
  s_waitcnt lgkmcnt(0)
  s_barrier
  ds_read_b64_tr_b16 a[128:129], v3 offset:0
  ds_read_b64_tr_b16 a[130:131], v3 offset:1024
  ds_read_b64_tr_b16 a[132:133], v3 offset:8
  ds_read_b64_tr_b16 a[134:135], v3 offset:1032
  ds_read_b64_tr_b16 a[136:137], v3 offset:8192
  ds_read_b64_tr_b16 a[138:139], v3 offset:9216
  ds_read_b64_tr_b16 a[140:141], v3 offset:8200
  ds_read_b64_tr_b16 a[142:143], v3 offset:9224
  ds_read_b64_tr_b16 a[144:145], v3 offset:16384
  ds_read_b64_tr_b16 a[146:147], v3 offset:17408
  ds_read_b64_tr_b16 a[148:149], v3 offset:16392
  ds_read_b64_tr_b16 a[150:151], v3 offset:17416
  ds_read_b64_tr_b16 a[152:153], v3 offset:24576
  ds_read_b64_tr_b16 a[154:155], v3 offset:25600
  ds_read_b64_tr_b16 a[156:157], v3 offset:24584
  ds_read_b64_tr_b16 a[158:159], v3 offset:25608
  s_waitcnt lgkmcnt(0)
  s_waitcnt vmcnt(17)
  ds_write_b128 v13, a[160:163] offset:32768
  ds_write_b128 v13, a[164:167] offset:33792
  ds_write_b128 v13, a[168:171] offset:34816
  ds_write_b128 v13, a[172:175] offset:35840
  ds_write_b128 v13, a[176:179] offset:36864
  ds_write_b128 v13, a[180:183] offset:37888
  ds_write_b128 v13, a[184:187] offset:38912
  ds_write_b128 v13, a[188:191] offset:39936
  s_waitcnt lgkmcnt(0)
  s_barrier
  ds_read_b64_tr_b16 a[160:161], v3 offset:32768
  ds_read_b64_tr_b16 a[162:163], v3 offset:33792
  ds_read_b64_tr_b16 a[164:165], v3 offset:32776
  ds_read_b64_tr_b16 a[166:167], v3 offset:33800
  ds_read_b64_tr_b16 a[168:169], v3 offset:40960
  ds_read_b64_tr_b16 a[170:171], v3 offset:41984
  ds_read_b64_tr_b16 a[172:173], v3 offset:40968
  ds_read_b64_tr_b16 a[174:175], v3 offset:41992
  ds_read_b64_tr_b16 a[176:177], v3 offset:49152
  ds_read_b64_tr_b16 a[178:179], v3 offset:50176
  ds_read_b64_tr_b16 a[180:181], v3 offset:49160
  ds_read_b64_tr_b16 a[182:183], v3 offset:50184
  ds_read_b64_tr_b16 a[184:185], v3 offset:57344
  ds_read_b64_tr_b16 a[186:187], v3 offset:58368
  ds_read_b64_tr_b16 a[188:189], v3 offset:57352
  ds_read_b64_tr_b16 a[190:191], v3 offset:58376
  s_waitcnt lgkmcnt(0)
  s_waitcnt vmcnt(9)
  ds_write_b128 v13, a[192:195] offset:0
  ds_write_b128 v13, a[196:199] offset:1024
  ds_write_b128 v13, a[200:203] offset:2048
  ds_write_b128 v13, a[204:207] offset:3072
  ds_write_b128 v13, a[208:211] offset:4096
  ds_write_b128 v13, a[212:215] offset:5120
  ds_write_b128 v13, a[216:219] offset:6144
  ds_write_b128 v13, a[220:223] offset:7168
  s_waitcnt lgkmcnt(0)
  s_barrier
  ds_read_b64_tr_b16 a[192:193], v3 offset:0
  ds_read_b64_tr_b16 a[194:195], v3 offset:1024
  ds_read_b64_tr_b16 a[196:197], v3 offset:8
  ds_read_b64_tr_b16 a[198:199], v3 offset:1032
  ds_read_b64_tr_b16 a[200:201], v3 offset:8192
  ds_read_b64_tr_b16 a[202:203], v3 offset:9216
  ds_read_b64_tr_b16 a[204:205], v3 offset:8200
  ds_read_b64_tr_b16 a[206:207], v3 offset:9224
  ds_read_b64_tr_b16 a[208:209], v3 offset:16384
  ds_read_b64_tr_b16 a[210:211], v3 offset:17408
  ds_read_b64_tr_b16 a[212:213], v3 offset:16392
  ds_read_b64_tr_b16 a[214:215], v3 offset:17416
  ds_read_b64_tr_b16 a[216:217], v3 offset:24576
  ds_read_b64_tr_b16 a[218:219], v3 offset:25600
  ds_read_b64_tr_b16 a[220:221], v3 offset:24584
  ds_read_b64_tr_b16 a[222:223], v3 offset:25608
  s_waitcnt lgkmcnt(0)
  s_waitcnt vmcnt(1)
  ds_write_b128 v13, a[224:227] offset:32768
  ds_write_b128 v13, a[228:231] offset:33792
  ds_write_b128 v13, a[232:235] offset:34816
  ds_write_b128 v13, a[236:239] offset:35840
  ds_write_b128 v13, a[240:243] offset:36864
  ds_write_b128 v13, a[244:247] offset:37888
  ds_write_b128 v13, a[248:251] offset:38912
  ds_write_b128 v13, a[252:255] offset:39936
  s_waitcnt lgkmcnt(0)
  s_barrier
  ds_read_b64_tr_b16 a[224:225], v3 offset:32768
  ds_read_b64_tr_b16 a[226:227], v3 offset:33792
  ds_read_b64_tr_b16 a[228:229], v3 offset:32776
  ds_read_b64_tr_b16 a[230:231], v3 offset:33800
  ds_read_b64_tr_b16 a[232:233], v3 offset:40960
  ds_read_b64_tr_b16 a[234:235], v3 offset:41984
  ds_read_b64_tr_b16 a[236:237], v3 offset:40968
  ds_read_b64_tr_b16 a[238:239], v3 offset:41992
  ds_read_b64_tr_b16 a[240:241], v3 offset:49152
  ds_read_b64_tr_b16 a[242:243], v3 offset:50176
  ds_read_b64_tr_b16 a[244:245], v3 offset:49160
  ds_read_b64_tr_b16 a[246:247], v3 offset:50184
  ds_read_b64_tr_b16 a[248:249], v3 offset:57344
  ds_read_b64_tr_b16 a[250:251], v3 offset:58368
  ds_read_b64_tr_b16 a[252:253], v3 offset:57352
  ds_read_b64_tr_b16 a[254:255], v3 offset:58376
  s_waitcnt lgkmcnt(0)
  s_barrier
  s_lshl_b32 s46, s30, 14
  s_mov_b32 s47, 65536
  s_mov_b32 s51, 262144
  s_mov_b32 s45, 64
  s_mov_b32 s42, 0
  s_mov_b32 s43, 1
  s_lshl_b32 s48, s30, 14
  s_mov_b32 s44, 0
  s_mov_b32 m0, s48
  s_nop 0
  buffer_load_dwordx4 v5, s[16:19], s46 offen offset:0 lds
  s_add_u32 m0, m0, 896
  s_nop 0
  buffer_load_dwordx4 v5, s[16:19], s46 offen offset:128 lds
  s_add_u32 m0, m0, 896
  s_nop 0
  buffer_load_dwordx4 v5, s[16:19], s46 offen offset:256 lds
  s_add_u32 m0, m0, 896
  s_nop 0
  buffer_load_dwordx4 v5, s[16:19], s46 offen offset:384 lds
  s_add_u32 m0, m0, 896
  s_nop 0
  buffer_load_dwordx4 v5, s[16:19], s46 offen offset:512 lds
  s_add_u32 m0, m0, 896
  s_nop 0
  buffer_load_dwordx4 v5, s[16:19], s46 offen offset:640 lds
  s_add_u32 m0, m0, 896
  s_nop 0
  buffer_load_dwordx4 v5, s[16:19], s46 offen offset:768 lds
  s_add_u32 m0, m0, 896
  s_nop 0
  buffer_load_dwordx4 v5, s[16:19], s46 offen offset:896 lds
  s_add_u32 m0, m0, 896
  s_nop 0
  buffer_load_dwordx4 v5, s[16:19], s46 offen offset:1024 lds
  s_add_u32 m0, m0, 896
  s_nop 0
  buffer_load_dwordx4 v5, s[16:19], s46 offen offset:1152 lds
  s_add_u32 m0, m0, 896
  s_nop 0
  buffer_load_dwordx4 v5, s[16:19], s46 offen offset:1280 lds
  s_add_u32 m0, m0, 896
  s_nop 0
  buffer_load_dwordx4 v5, s[16:19], s46 offen offset:1408 lds
  s_add_u32 m0, m0, 896
  s_nop 0
  buffer_load_dwordx4 v5, s[16:19], s46 offen offset:1536 lds
  s_add_u32 m0, m0, 896
  s_nop 0
  buffer_load_dwordx4 v5, s[16:19], s46 offen offset:1664 lds
  s_add_u32 m0, m0, 896
  s_nop 0
  buffer_load_dwordx4 v5, s[16:19], s46 offen offset:1792 lds
  s_add_u32 m0, m0, 896
  s_nop 0
  buffer_load_dwordx4 v5, s[16:19], s46 offen offset:1920 lds
  s_waitcnt vmcnt(0)
L_K_loop:
  s_waitcnt vmcnt(2)
  s_barrier
  s_cmp_lg_u32 s44, 1
  s_cbranch_scc1 nf1_5
  s_waitcnt vmcnt(0)
  s_barrier
  s_cmp_lg_u32 s30, 0
  s_cbranch_scc1 w0_6
  s_mov_b64 s[96:97], exec
  s_mov_b64 exec, 1
  v_mov_b32 v10, s52
  v_mov_b32 v11, 1
  buffer_store_dword v11, v10, s[8:11], 0 offen sc1
  s_mov_b64 exec, s[96:97]
w0_6:
  s_branch nf_4
nf1_5:
  s_cmp_lt_u32 s44, 2
  s_cbranch_scc1 nf_4
  s_sub_u32 s34, s44, 1
  s_cmp_lg_u32 s30, 0
  s_cbranch_scc1 w0_7
  s_mov_b64 s[96:97], exec
  s_mov_b64 exec, 1
  v_mov_b32 v10, s52
  v_mov_b32 v11, s34
  buffer_store_dword v11, v10, s[8:11], 0 offen sc1
  s_mov_b64 exec, s[96:97]
w0_7:
nf_4:
  s_add_u32 s46, s46, s47
  s_add_u32 s33, s44, 1
  s_cmp_lt_u32 s33, s45
  s_cselect_b32 s46, s46, 0xf0000000
  s_xor_b32 s48, s48, 0x10000
  ds_read_b128 v[32:35], v6 offset:0
  ds_read_b128 v[36:39], v6 offset:32768
  ds_read_b128 v[40:43], v7 offset:0
  ds_read_b128 v[44:47], v7 offset:32768
  ds_read_b128 v[48:51], v6 offset:1024
  ds_read_b128 v[52:55], v6 offset:33792
  ds_read_b128 v[56:59], v7 offset:1024
  s_waitcnt lgkmcnt(5)
  v_mfma_f32_16x16x32_bf16 v[16:19], a[0:3], v[32:35], 0
  ds_read_b128 v[60:63], v7 offset:33792
  v_mfma_f32_16x16x32_bf16 v[20:23], a[4:7], v[32:35], 0
  s_mov_b32 m0, s48
  v_mfma_f32_16x16x32_bf16 v[24:27], a[0:3], v[36:39], 0
  ds_read_b128 v[32:35], v6 offset:2048
  v_mfma_f32_16x16x32_bf16 v[28:31], a[4:7], v[36:39], 0
  buffer_load_dwordx4 v5, s[16:19], s46 offen offset:0 lds
  s_waitcnt lgkmcnt(5)
  v_mfma_f32_16x16x32_bf16 v[16:19], a[8:11], v[40:43], v[16:19]
  ds_read_b128 v[36:39], v6 offset:34816
  v_mfma_f32_16x16x32_bf16 v[20:23], a[12:15], v[40:43], v[20:23]
  s_add_u32 m0, m0, 896
  v_mfma_f32_16x16x32_bf16 v[24:27], a[8:11], v[44:47], v[24:27]
  ds_read_b128 v[40:43], v7 offset:2048
  v_mfma_f32_16x16x32_bf16 v[28:31], a[12:15], v[44:47], v[28:31]
  buffer_load_dwordx4 v5, s[16:19], s46 offen offset:128 lds
  s_waitcnt lgkmcnt(5)
  v_mfma_f32_16x16x32_bf16 v[16:19], a[16:19], v[48:51], v[16:19]
  ds_read_b128 v[44:47], v7 offset:34816
  v_mfma_f32_16x16x32_bf16 v[20:23], a[20:23], v[48:51], v[20:23]
  s_add_u32 m0, m0, 896
  v_mfma_f32_16x16x32_bf16 v[24:27], a[16:19], v[52:55], v[24:27]
  ds_read_b128 v[48:51], v6 offset:3072
  v_mfma_f32_16x16x32_bf16 v[28:31], a[20:23], v[52:55], v[28:31]
  buffer_load_dwordx4 v5, s[16:19], s46 offen offset:256 lds
  s_waitcnt lgkmcnt(5)
  v_mfma_f32_16x16x32_bf16 v[16:19], a[24:27], v[56:59], v[16:19]
  ds_read_b128 v[52:55], v6 offset:35840
  v_mfma_f32_16x16x32_bf16 v[20:23], a[28:31], v[56:59], v[20:23]
  s_add_u32 m0, m0, 896
  v_mfma_f32_16x16x32_bf16 v[24:27], a[24:27], v[60:63], v[24:27]
  ds_read_b128 v[56:59], v7 offset:3072
  v_mfma_f32_16x16x32_bf16 v[28:31], a[28:31], v[60:63], v[28:31]
  buffer_load_dwordx4 v5, s[16:19], s46 offen offset:384 lds
  s_waitcnt lgkmcnt(5)
  v_mfma_f32_16x16x32_bf16 v[16:19], a[32:35], v[32:35], v[16:19]
  ds_read_b128 v[60:63], v7 offset:35840
  v_mfma_f32_16x16x32_bf16 v[20:23], a[36:39], v[32:35], v[20:23]
  s_add_u32 m0, m0, 896
  v_mfma_f32_16x16x32_bf16 v[24:27], a[32:35], v[36:39], v[24:27]
  ds_read_b128 v[32:35], v6 offset:4096
  v_mfma_f32_16x16x32_bf16 v[28:31], a[36:39], v[36:39], v[28:31]
  buffer_load_dwordx4 v5, s[16:19], s46 offen offset:512 lds
  s_waitcnt lgkmcnt(5)
  v_mfma_f32_16x16x32_bf16 v[16:19], a[40:43], v[40:43], v[16:19]
  ds_read_b128 v[36:39], v6 offset:36864
  v_mfma_f32_16x16x32_bf16 v[20:23], a[44:47], v[40:43], v[20:23]
  s_add_u32 m0, m0, 896
  v_mfma_f32_16x16x32_bf16 v[24:27], a[40:43], v[44:47], v[24:27]
  ds_read_b128 v[40:43], v7 offset:4096
  v_mfma_f32_16x16x32_bf16 v[28:31], a[44:47], v[44:47], v[28:31]
  buffer_load_dwordx4 v5, s[16:19], s46 offen offset:640 lds
  s_waitcnt lgkmcnt(5)
  v_mfma_f32_16x16x32_bf16 v[16:19], a[48:51], v[48:51], v[16:19]
  ds_read_b128 v[44:47], v7 offset:36864
  v_mfma_f32_16x16x32_bf16 v[20:23], a[52:55], v[48:51], v[20:23]
  s_add_u32 m0, m0, 896
  v_mfma_f32_16x16x32_bf16 v[24:27], a[48:51], v[52:55], v[24:27]
  ds_read_b128 v[48:51], v6 offset:5120
  v_mfma_f32_16x16x32_bf16 v[28:31], a[52:55], v[52:55], v[28:31]
  buffer_load_dwordx4 v5, s[16:19], s46 offen offset:768 lds
  s_waitcnt lgkmcnt(5)
  v_mfma_f32_16x16x32_bf16 v[16:19], a[56:59], v[56:59], v[16:19]
  ds_read_b128 v[52:55], v6 offset:37888
  v_mfma_f32_16x16x32_bf16 v[20:23], a[60:63], v[56:59], v[20:23]
  s_add_u32 m0, m0, 896
  v_mfma_f32_16x16x32_bf16 v[24:27], a[56:59], v[60:63], v[24:27]
  ds_read_b128 v[56:59], v7 offset:5120
  v_mfma_f32_16x16x32_bf16 v[28:31], a[60:63], v[60:63], v[28:31]
  buffer_load_dwordx4 v5, s[16:19], s46 offen offset:896 lds
  s_waitcnt lgkmcnt(5)
  v_mfma_f32_16x16x32_bf16 v[16:19], a[64:67], v[32:35], v[16:19]
  ds_read_b128 v[60:63], v7 offset:37888
  v_mfma_f32_16x16x32_bf16 v[20:23], a[68:71], v[32:35], v[20:23]
  s_add_u32 m0, m0, 896
  v_mfma_f32_16x16x32_bf16 v[24:27], a[64:67], v[36:39], v[24:27]
  ds_read_b128 v[32:35], v6 offset:6144
  v_mfma_f32_16x16x32_bf16 v[28:31], a[68:71], v[36:39], v[28:31]
  buffer_load_dwordx4 v5, s[16:19], s46 offen offset:1024 lds
  s_waitcnt lgkmcnt(5)
  v_mfma_f32_16x16x32_bf16 v[16:19], a[72:75], v[40:43], v[16:19]
  ds_read_b128 v[36:39], v6 offset:38912
  v_mfma_f32_16x16x32_bf16 v[20:23], a[76:79], v[40:43], v[20:23]
  s_add_u32 m0, m0, 896
  v_mfma_f32_16x16x32_bf16 v[24:27], a[72:75], v[44:47], v[24:27]
  ds_read_b128 v[40:43], v7 offset:6144
  v_mfma_f32_16x16x32_bf16 v[28:31], a[76:79], v[44:47], v[28:31]
  buffer_load_dwordx4 v5, s[16:19], s46 offen offset:1152 lds
  s_waitcnt lgkmcnt(5)
  v_mfma_f32_16x16x32_bf16 v[16:19], a[80:83], v[48:51], v[16:19]
  ds_read_b128 v[44:47], v7 offset:38912
  v_mfma_f32_16x16x32_bf16 v[20:23], a[84:87], v[48:51], v[20:23]
  s_add_u32 m0, m0, 896
  v_mfma_f32_16x16x32_bf16 v[24:27], a[80:83], v[52:55], v[24:27]
  ds_read_b128 v[48:51], v6 offset:7168
  v_mfma_f32_16x16x32_bf16 v[28:31], a[84:87], v[52:55], v[28:31]
  buffer_load_dwordx4 v5, s[16:19], s46 offen offset:1280 lds
  s_waitcnt lgkmcnt(5)
  v_mfma_f32_16x16x32_bf16 v[16:19], a[88:91], v[56:59], v[16:19]
  ds_read_b128 v[52:55], v6 offset:39936
  v_mfma_f32_16x16x32_bf16 v[20:23], a[92:95], v[56:59], v[20:23]
  s_add_u32 m0, m0, 896
  v_mfma_f32_16x16x32_bf16 v[24:27], a[88:91], v[60:63], v[24:27]
  ds_read_b128 v[56:59], v7 offset:7168
  v_mfma_f32_16x16x32_bf16 v[28:31], a[92:95], v[60:63], v[28:31]
  buffer_load_dwordx4 v5, s[16:19], s46 offen offset:1408 lds
  s_waitcnt lgkmcnt(5)
  v_mfma_f32_16x16x32_bf16 v[16:19], a[96:99], v[32:35], v[16:19]
  ds_read_b128 v[60:63], v7 offset:39936
  v_mfma_f32_16x16x32_bf16 v[20:23], a[100:103], v[32:35], v[20:23]
  s_add_u32 m0, m0, 896
  v_mfma_f32_16x16x32_bf16 v[24:27], a[96:99], v[36:39], v[24:27]
  ds_read_b128 v[32:35], v6 offset:8192
  v_mfma_f32_16x16x32_bf16 v[28:31], a[100:103], v[36:39], v[28:31]
  buffer_load_dwordx4 v5, s[16:19], s46 offen offset:1536 lds
  s_waitcnt lgkmcnt(5)
  v_mfma_f32_16x16x32_bf16 v[16:19], a[104:107], v[40:43], v[16:19]
  ds_read_b128 v[36:39], v6 offset:40960
  v_mfma_f32_16x16x32_bf16 v[20:23], a[108:111], v[40:43], v[20:23]
  s_add_u32 m0, m0, 896
  v_mfma_f32_16x16x32_bf16 v[24:27], a[104:107], v[44:47], v[24:27]
  ds_read_b128 v[40:43], v7 offset:8192
  v_mfma_f32_16x16x32_bf16 v[28:31], a[108:111], v[44:47], v[28:31]
  buffer_load_dwordx4 v5, s[16:19], s46 offen offset:1664 lds
  s_waitcnt lgkmcnt(5)
  v_mfma_f32_16x16x32_bf16 v[16:19], a[112:115], v[48:51], v[16:19]
  ds_read_b128 v[44:47], v7 offset:40960
  v_mfma_f32_16x16x32_bf16 v[20:23], a[116:119], v[48:51], v[20:23]
  s_add_u32 m0, m0, 896
  v_mfma_f32_16x16x32_bf16 v[24:27], a[112:115], v[52:55], v[24:27]
  ds_read_b128 v[48:51], v6 offset:9216
  v_mfma_f32_16x16x32_bf16 v[28:31], a[116:119], v[52:55], v[28:31]
  buffer_load_dwordx4 v5, s[16:19], s46 offen offset:1792 lds
  s_waitcnt lgkmcnt(5)
  v_mfma_f32_16x16x32_bf16 v[16:19], a[120:123], v[56:59], v[16:19]
  ds_read_b128 v[52:55], v6 offset:41984
  v_mfma_f32_16x16x32_bf16 v[20:23], a[124:127], v[56:59], v[20:23]
  s_add_u32 m0, m0, 896
  v_mfma_f32_16x16x32_bf16 v[24:27], a[120:123], v[60:63], v[24:27]
  ds_read_b128 v[56:59], v7 offset:9216
  v_mfma_f32_16x16x32_bf16 v[28:31], a[124:127], v[60:63], v[28:31]
  buffer_load_dwordx4 v5, s[16:19], s46 offen offset:1920 lds
  s_waitcnt lgkmcnt(5)
  v_mfma_f32_16x16x32_bf16 v[16:19], a[128:131], v[32:35], v[16:19]
  ds_read_b128 v[60:63], v7 offset:41984
  v_mfma_f32_16x16x32_bf16 v[20:23], a[132:135], v[32:35], v[20:23]
  v_mfma_f32_16x16x32_bf16 v[24:27], a[128:131], v[36:39], v[24:27]
  ds_read_b128 v[32:35], v6 offset:10240
  v_mfma_f32_16x16x32_bf16 v[28:31], a[132:135], v[36:39], v[28:31]
  s_waitcnt lgkmcnt(5)
  v_mfma_f32_16x16x32_bf16 v[16:19], a[136:139], v[40:43], v[16:19]
  ds_read_b128 v[36:39], v6 offset:43008
  v_mfma_f32_16x16x32_bf16 v[20:23], a[140:143], v[40:43], v[20:23]
  v_mfma_f32_16x16x32_bf16 v[24:27], a[136:139], v[44:47], v[24:27]
  ds_read_b128 v[40:43], v7 offset:10240
  v_mfma_f32_16x16x32_bf16 v[28:31], a[140:143], v[44:47], v[28:31]
  s_waitcnt lgkmcnt(5)
  v_mfma_f32_16x16x32_bf16 v[16:19], a[144:147], v[48:51], v[16:19]
  ds_read_b128 v[44:47], v7 offset:43008
  v_mfma_f32_16x16x32_bf16 v[20:23], a[148:151], v[48:51], v[20:23]
  v_mfma_f32_16x16x32_bf16 v[24:27], a[144:147], v[52:55], v[24:27]
  ds_read_b128 v[48:51], v6 offset:11264
  v_mfma_f32_16x16x32_bf16 v[28:31], a[148:151], v[52:55], v[28:31]
  s_waitcnt lgkmcnt(5)
  v_mfma_f32_16x16x32_bf16 v[16:19], a[152:155], v[56:59], v[16:19]
  ds_read_b128 v[52:55], v6 offset:44032
  v_mfma_f32_16x16x32_bf16 v[20:23], a[156:159], v[56:59], v[20:23]
  v_mfma_f32_16x16x32_bf16 v[24:27], a[152:155], v[60:63], v[24:27]
  ds_read_b128 v[56:59], v7 offset:11264
  v_mfma_f32_16x16x32_bf16 v[28:31], a[156:159], v[60:63], v[28:31]
  s_waitcnt lgkmcnt(5)
  v_mfma_f32_16x16x32_bf16 v[16:19], a[160:163], v[32:35], v[16:19]
  ds_read_b128 v[60:63], v7 offset:44032
  v_mfma_f32_16x16x32_bf16 v[20:23], a[164:167], v[32:35], v[20:23]
  v_mfma_f32_16x16x32_bf16 v[24:27], a[160:163], v[36:39], v[24:27]
  ds_read_b128 v[32:35], v6 offset:12288
  v_mfma_f32_16x16x32_bf16 v[28:31], a[164:167], v[36:39], v[28:31]
  s_waitcnt lgkmcnt(5)
  v_mfma_f32_16x16x32_bf16 v[16:19], a[168:171], v[40:43], v[16:19]
  ds_read_b128 v[36:39], v6 offset:45056
  v_mfma_f32_16x16x32_bf16 v[20:23], a[172:175], v[40:43], v[20:23]
  v_mfma_f32_16x16x32_bf16 v[24:27], a[168:171], v[44:47], v[24:27]
  ds_read_b128 v[40:43], v7 offset:12288
  v_mfma_f32_16x16x32_bf16 v[28:31], a[172:175], v[44:47], v[28:31]
  s_waitcnt lgkmcnt(5)
  v_mfma_f32_16x16x32_bf16 v[16:19], a[176:179], v[48:51], v[16:19]
  ds_read_b128 v[44:47], v7 offset:45056
  v_mfma_f32_16x16x32_bf16 v[20:23], a[180:183], v[48:51], v[20:23]
  v_mfma_f32_16x16x32_bf16 v[24:27], a[176:179], v[52:55], v[24:27]
  ds_read_b128 v[48:51], v6 offset:13312
  v_mfma_f32_16x16x32_bf16 v[28:31], a[180:183], v[52:55], v[28:31]
  s_waitcnt lgkmcnt(5)
  v_mfma_f32_16x16x32_bf16 v[16:19], a[184:187], v[56:59], v[16:19]
  ds_read_b128 v[52:55], v6 offset:46080
  v_mfma_f32_16x16x32_bf16 v[20:23], a[188:191], v[56:59], v[20:23]
  v_mfma_f32_16x16x32_bf16 v[24:27], a[184:187], v[60:63], v[24:27]
  ds_read_b128 v[56:59], v7 offset:13312
  v_mfma_f32_16x16x32_bf16 v[28:31], a[188:191], v[60:63], v[28:31]
  s_waitcnt lgkmcnt(5)
  v_mfma_f32_16x16x32_bf16 v[16:19], a[192:195], v[32:35], v[16:19]
  ds_read_b128 v[60:63], v7 offset:46080
  v_mfma_f32_16x16x32_bf16 v[20:23], a[196:199], v[32:35], v[20:23]
  v_mfma_f32_16x16x32_bf16 v[24:27], a[192:195], v[36:39], v[24:27]
  ds_read_b128 v[32:35], v6 offset:14336
  v_mfma_f32_16x16x32_bf16 v[28:31], a[196:199], v[36:39], v[28:31]
  s_waitcnt lgkmcnt(5)
  v_mfma_f32_16x16x32_bf16 v[16:19], a[200:203], v[40:43], v[16:19]
  ds_read_b128 v[36:39], v6 offset:47104
  v_mfma_f32_16x16x32_bf16 v[20:23], a[204:207], v[40:43], v[20:23]
  v_mfma_f32_16x16x32_bf16 v[24:27], a[200:203], v[44:47], v[24:27]
  ds_read_b128 v[40:43], v7 offset:14336
  v_mfma_f32_16x16x32_bf16 v[28:31], a[204:207], v[44:47], v[28:31]
  s_waitcnt lgkmcnt(5)
  v_mfma_f32_16x16x32_bf16 v[16:19], a[208:211], v[48:51], v[16:19]
  ds_read_b128 v[44:47], v7 offset:47104
  v_mfma_f32_16x16x32_bf16 v[20:23], a[212:215], v[48:51], v[20:23]
  v_mfma_f32_16x16x32_bf16 v[24:27], a[208:211], v[52:55], v[24:27]
  ds_read_b128 v[48:51], v6 offset:15360
  v_mfma_f32_16x16x32_bf16 v[28:31], a[212:215], v[52:55], v[28:31]
  s_waitcnt lgkmcnt(5)
  v_mfma_f32_16x16x32_bf16 v[16:19], a[216:219], v[56:59], v[16:19]
  ds_read_b128 v[52:55], v6 offset:48128
  v_mfma_f32_16x16x32_bf16 v[20:23], a[220:223], v[56:59], v[20:23]
  v_mfma_f32_16x16x32_bf16 v[24:27], a[216:219], v[60:63], v[24:27]
  ds_read_b128 v[56:59], v7 offset:15360
  v_mfma_f32_16x16x32_bf16 v[28:31], a[220:223], v[60:63], v[28:31]
  s_waitcnt lgkmcnt(5)
  v_mfma_f32_16x16x32_bf16 v[16:19], a[224:227], v[32:35], v[16:19]
  ds_read_b128 v[60:63], v7 offset:48128
  v_mfma_f32_16x16x32_bf16 v[20:23], a[228:231], v[32:35], v[20:23]
  v_mfma_f32_16x16x32_bf16 v[24:27], a[224:227], v[36:39], v[24:27]
  v_mfma_f32_16x16x32_bf16 v[28:31], a[228:231], v[36:39], v[28:31]
  s_waitcnt lgkmcnt(4)
  v_mfma_f32_16x16x32_bf16 v[16:19], a[232:235], v[40:43], v[16:19]
  v_mfma_f32_16x16x32_bf16 v[20:23], a[236:239], v[40:43], v[20:23]
  v_mfma_f32_16x16x32_bf16 v[24:27], a[232:235], v[44:47], v[24:27]
  v_mfma_f32_16x16x32_bf16 v[28:31], a[236:239], v[44:47], v[28:31]
  s_waitcnt lgkmcnt(2)
  v_mfma_f32_16x16x32_bf16 v[16:19], a[240:243], v[48:51], v[16:19]
  v_mfma_f32_16x16x32_bf16 v[20:23], a[244:247], v[48:51], v[20:23]
  v_mfma_f32_16x16x32_bf16 v[24:27], a[240:243], v[52:55], v[24:27]
  v_mfma_f32_16x16x32_bf16 v[28:31], a[244:247], v[52:55], v[28:31]
  s_waitcnt lgkmcnt(0)
  v_mfma_f32_16x16x32_bf16 v[16:19], a[248:251], v[56:59], v[16:19]
  v_mfma_f32_16x16x32_bf16 v[20:23], a[252:255], v[56:59], v[20:23]
  v_mfma_f32_16x16x32_bf16 v[24:27], a[248:251], v[60:63], v[24:27]
  v_mfma_f32_16x16x32_bf16 v[28:31], a[252:255], v[60:63], v[28:31]
  s_nop 4
  v_cvt_pk_bf16_f32 v64, v16, v17
  v_cvt_pk_bf16_f32 v65, v18, v19
  v_cvt_pk_bf16_f32 v66, v20, v21
  v_cvt_pk_bf16_f32 v67, v22, v23
  buffer_store_dwordx4 v[64:67], v8, s[8:11], s49 offen sc1
  v_cvt_pk_bf16_f32 v68, v24, v25
  v_cvt_pk_bf16_f32 v69, v26, v27
  v_cvt_pk_bf16_f32 v70, v28, v29
  v_cvt_pk_bf16_f32 v71, v30, v31
  s_add_u32 s54, s49, s50
  buffer_store_dwordx4 v[68:71], v8, s[8:11], s54 offen sc1
  v_xor_b32 v6, 0x10000, v6
  v_xor_b32 v7, 0x10000, v7
  s_add_u32 s49, s49, s51
  s_add_u32 s42, s42, s43
  s_add_u32 s44, s44, 1
  s_cmp_lt_u32 s44, s45
  s_cbranch_scc1 L_K_loop
  s_waitcnt vmcnt(0)
  s_barrier
  s_cmp_lg_u32 s30, 0
  s_cbranch_scc1 w0_8
  s_mov_b64 s[96:97], exec
  s_mov_b64 exec, 1
  v_mov_b32 v10, s52
  v_mov_b32 v11, s45
  buffer_store_dword v11, v10, s[8:11], 0 offen sc1
  s_mov_b64 exec, s[96:97]
w0_8:
  s_branch L_role_F2
L_role_V:
  s_load_dwordx2 s[4:5], s[0:1], 0
  s_waitcnt lgkmcnt(0)
  s_mov_b32 s16, s4
  s_mov_b32 s17, s5
  s_mov_b32 s18, 4194304
  s_mov_b32 s19, 0x20000
  s_load_dwordx2 s[4:5], s[0:1], 32
  s_waitcnt lgkmcnt(0)
  s_mov_b32 s20, s4
  s_mov_b32 s21, s5
  s_mov_b32 s22, 8388608
  s_mov_b32 s23, 0x20000
  s_cmp_lg_u32 s30, 0
  s_cbranch_scc1 w0_9
  s_lshl_b32 s33, s29, 7
  s_add_u32 s33, s33, 4096
  s_mov_b64 s[96:97], exec
  s_mov_b64 exec, 1
  v_mov_b32 v10, s33
  v_mov_b32 v11, 0
  buffer_store_dword v11, v10, s[8:11], 0 offen sc1
  s_mov_b64 exec, s[96:97]
  s_lshl_b32 s33, s29, 7
  s_add_u32 s33, s33, 20480
  s_mov_b64 s[96:97], exec
  s_mov_b64 exec, 1
  v_mov_b32 v10, s33
  v_mov_b32 v11, 0
  buffer_store_dword v11, v10, s[8:11], 0 offen sc1
  s_mov_b64 exec, s[96:97]
w0_9:
  s_lshl_b32 s52, s29, 7
  s_add_u32 s52, s52, 4096
  s_mov_b32 s41, 32768
  s_lshl_b32 s33, s29, 13
  s_lshl_b32 s34, s30, 11
  s_add_u32 s49, s33, s34
  s_add_u32 s49, s49, 50331648
  s_mov_b32 s50, 1024
  v_lshrrev_b32 v10, 4, v1
  v_and_b32 v11, 15, v1
  s_lshr_b32 s33, s41, 2
  v_mul_lo_u32 v2, v10, s33
  v_lshlrev_b32 v12, 2, v10
  v_xor_b32 v12, v12, v11
  v_lshl_add_u32 v2, v12, 4, v2
  v_bfe_u32 v12, v1, 2, 2
  v_lshl_add_u32 v13, v10, 3, v12
  v_lshlrev_b32 v3, 8, v13
  v_and_b32 v13, 3, v1
  s_lshl_b32 s33, s30, 2
  v_add_u32 v13, s33, v13
  v_lshlrev_b32 v12, 2, v12
  v_xor_b32 v13, v13, v12
  v_lshl_add_u32 v3, v13, 4, v3
  v_add_u32 v4, 0x10000, v3
  v_lshlrev_b32 v8, 4, v1
  v_lshrrev_b32 v12, 3, v1
  v_and_b32 v13, 7, v1
  v_xor_b32 v13, v13, v12
  v_lshlrev_b32 v5, 11, v12
  v_lshl_add_u32 v5, v13, 4, v5
  v_and_b32 v12, 7, v1
  v_bfe_u32 v13, v1, 3, 1
  v_lshlrev_b32 v6, 14, v13
  v_lshl_add_u32 v6, v12, 7, v6
  v_xor_b32 v13, v10, v12
  v_lshl_add_u32 v6, v13, 4, v6
  v_xor_b32 v7, 64, v6
  s_lshl_b32 s40, s29, 8
  s_lshl_b32 s33, s41, 3
  s_mul_i32 s33, s33, s30
  s_add_u32 s40, s40, s33
  s_mul_i32 s34, s41, 24
  s_lshl_b32 s35, s30, 13
  v_add_u32 v13, s35, v8
  buffer_load_dwordx4 a[0:3], v2, s[20:23], s40 offen nt
  s_add_u32 s40, s40, s41
  buffer_load_dwordx4 a[4:7], v2, s[20:23], s40 offen nt
  s_add_u32 s40, s40, s41
  buffer_load_dwordx4 a[8:11], v2, s[20:23], s40 offen nt
  s_add_u32 s40, s40, s41
  buffer_load_dwordx4 a[12:15], v2, s[20:23], s40 offen nt
  s_add_u32 s40, s40, s41
  buffer_load_dwordx4 a[16:19], v2, s[20:23], s40 offen nt
  s_add_u32 s40, s40, s41
  buffer_load_dwordx4 a[20:23], v2, s[20:23], s40 offen nt
  s_add_u32 s40, s40, s41
  buffer_load_dwordx4 a[24:27], v2, s[20:23], s40 offen nt
  s_add_u32 s40, s40, s41
  buffer_load_dwordx4 a[28:31], v2, s[20:23], s40 offen nt
  s_add_u32 s40, s40, s41
  s_add_u32 s40, s40, s34
  buffer_load_dwordx4 a[32:35], v2, s[20:23], s40 offen nt
  s_add_u32 s40, s40, s41
  buffer_load_dwordx4 a[36:39], v2, s[20:23], s40 offen nt
  s_add_u32 s40, s40, s41
  buffer_load_dwordx4 a[40:43], v2, s[20:23], s40 offen nt
  s_add_u32 s40, s40, s41
  buffer_load_dwordx4 a[44:47], v2, s[20:23], s40 offen nt
  s_add_u32 s40, s40, s41
  buffer_load_dwordx4 a[48:51], v2, s[20:23], s40 offen nt
  s_add_u32 s40, s40, s41
  buffer_load_dwordx4 a[52:55], v2, s[20:23], s40 offen nt
  s_add_u32 s40, s40, s41
  buffer_load_dwordx4 a[56:59], v2, s[20:23], s40 offen nt
  s_add_u32 s40, s40, s41
  buffer_load_dwordx4 a[60:63], v2, s[20:23], s40 offen nt
  s_add_u32 s40, s40, s41
  s_add_u32 s40, s40, s34
  buffer_load_dwordx4 a[64:67], v2, s[20:23], s40 offen nt
  s_add_u32 s40, s40, s41
  buffer_load_dwordx4 a[68:71], v2, s[20:23], s40 offen nt
  s_add_u32 s40, s40, s41
  buffer_load_dwordx4 a[72:75], v2, s[20:23], s40 offen nt
  s_add_u32 s40, s40, s41
  buffer_load_dwordx4 a[76:79], v2, s[20:23], s40 offen nt
  s_add_u32 s40, s40, s41
  buffer_load_dwordx4 a[80:83], v2, s[20:23], s40 offen nt
  s_add_u32 s40, s40, s41
  buffer_load_dwordx4 a[84:87], v2, s[20:23], s40 offen nt
  s_add_u32 s40, s40, s41
  buffer_load_dwordx4 a[88:91], v2, s[20:23], s40 offen nt
  s_add_u32 s40, s40, s41
  buffer_load_dwordx4 a[92:95], v2, s[20:23], s40 offen nt
  s_add_u32 s40, s40, s41
  s_add_u32 s40, s40, s34
  buffer_load_dwordx4 a[96:99], v2, s[20:23], s40 offen nt
  s_add_u32 s40, s40, s41
  buffer_load_dwordx4 a[100:103], v2, s[20:23], s40 offen nt
  s_add_u32 s40, s40, s41
  buffer_load_dwordx4 a[104:107], v2, s[20:23], s40 offen nt
  s_add_u32 s40, s40, s41
  buffer_load_dwordx4 a[108:111], v2, s[20:23], s40 offen nt
  s_add_u32 s40, s40, s41
  buffer_load_dwordx4 a[112:115], v2, s[20:23], s40 offen nt
  s_add_u32 s40, s40, s41
  buffer_load_dwordx4 a[116:119], v2, s[20:23], s40 offen nt
  s_add_u32 s40, s40, s41
  buffer_load_dwordx4 a[120:123], v2, s[20:23], s40 offen nt
  s_add_u32 s40, s40, s41
  buffer_load_dwordx4 a[124:127], v2, s[20:23], s40 offen nt
  s_add_u32 s40, s40, s41
  s_add_u32 s40, s40, s34
  buffer_load_dwordx4 a[128:131], v2, s[20:23], s40 offen nt
  s_add_u32 s40, s40, s41
  buffer_load_dwordx4 a[132:135], v2, s[20:23], s40 offen nt
  s_add_u32 s40, s40, s41
  buffer_load_dwordx4 a[136:139], v2, s[20:23], s40 offen nt
  s_add_u32 s40, s40, s41
  buffer_load_dwordx4 a[140:143], v2, s[20:23], s40 offen nt
  s_add_u32 s40, s40, s41
  buffer_load_dwordx4 a[144:147], v2, s[20:23], s40 offen nt
  s_add_u32 s40, s40, s41
  buffer_load_dwordx4 a[148:151], v2, s[20:23], s40 offen nt
  s_add_u32 s40, s40, s41
  buffer_load_dwordx4 a[152:155], v2, s[20:23], s40 offen nt
  s_add_u32 s40, s40, s41
  buffer_load_dwordx4 a[156:159], v2, s[20:23], s40 offen nt
  s_add_u32 s40, s40, s41
  s_add_u32 s40, s40, s34
  buffer_load_dwordx4 a[160:163], v2, s[20:23], s40 offen nt
  s_add_u32 s40, s40, s41
  buffer_load_dwordx4 a[164:167], v2, s[20:23], s40 offen nt
  s_add_u32 s40, s40, s41
  buffer_load_dwordx4 a[168:171], v2, s[20:23], s40 offen nt
  s_add_u32 s40, s40, s41
  buffer_load_dwordx4 a[172:175], v2, s[20:23], s40 offen nt
  s_add_u32 s40, s40, s41
  buffer_load_dwordx4 a[176:179], v2, s[20:23], s40 offen nt
  s_add_u32 s40, s40, s41
  buffer_load_dwordx4 a[180:183], v2, s[20:23], s40 offen nt
  s_add_u32 s40, s40, s41
  buffer_load_dwordx4 a[184:187], v2, s[20:23], s40 offen nt
  s_add_u32 s40, s40, s41
  buffer_load_dwordx4 a[188:191], v2, s[20:23], s40 offen nt
  s_add_u32 s40, s40, s41
  s_add_u32 s40, s40, s34
  buffer_load_dwordx4 a[192:195], v2, s[20:23], s40 offen nt
  s_add_u32 s40, s40, s41
  buffer_load_dwordx4 a[196:199], v2, s[20:23], s40 offen nt
  s_add_u32 s40, s40, s41
  buffer_load_dwordx4 a[200:203], v2, s[20:23], s40 offen nt
  s_add_u32 s40, s40, s41
  buffer_load_dwordx4 a[204:207], v2, s[20:23], s40 offen nt
  s_add_u32 s40, s40, s41
  buffer_load_dwordx4 a[208:211], v2, s[20:23], s40 offen nt
  s_add_u32 s40, s40, s41
  buffer_load_dwordx4 a[212:215], v2, s[20:23], s40 offen nt
  s_add_u32 s40, s40, s41
  buffer_load_dwordx4 a[216:219], v2, s[20:23], s40 offen nt
  s_add_u32 s40, s40, s41
  buffer_load_dwordx4 a[220:223], v2, s[20:23], s40 offen nt
  s_add_u32 s40, s40, s41
  s_add_u32 s40, s40, s34
  s_waitcnt vmcnt(48)
  ds_write_b128 v13, a[0:3] offset:0
  ds_write_b128 v13, a[4:7] offset:1024
  ds_write_b128 v13, a[8:11] offset:2048
  ds_write_b128 v13, a[12:15] offset:3072
  ds_write_b128 v13, a[16:19] offset:4096
  ds_write_b128 v13, a[20:23] offset:5120
  ds_write_b128 v13, a[24:27] offset:6144
  ds_write_b128 v13, a[28:31] offset:7168
  s_waitcnt lgkmcnt(0)
  s_barrier
  ds_read_b64_tr_b16 a[0:1], v3 offset:0
  ds_read_b64_tr_b16 a[2:3], v3 offset:1024
  ds_read_b64_tr_b16 a[4:5], v3 offset:8
  ds_read_b64_tr_b16 a[6:7], v3 offset:1032
  ds_read_b64_tr_b16 a[8:9], v3 offset:8192
  ds_read_b64_tr_b16 a[10:11], v3 offset:9216
  ds_read_b64_tr_b16 a[12:13], v3 offset:8200
  ds_read_b64_tr_b16 a[14:15], v3 offset:9224
  ds_read_b64_tr_b16 a[16:17], v3 offset:16384
  ds_read_b64_tr_b16 a[18:19], v3 offset:17408
  ds_read_b64_tr_b16 a[20:21], v3 offset:16392
  ds_read_b64_tr_b16 a[22:23], v3 offset:17416
  ds_read_b64_tr_b16 a[24:25], v3 offset:24576
  ds_read_b64_tr_b16 a[26:27], v3 offset:25600
  ds_read_b64_tr_b16 a[28:29], v3 offset:24584
  ds_read_b64_tr_b16 a[30:31], v3 offset:25608
  s_waitcnt lgkmcnt(0)
  buffer_load_dwordx4 a[224:227], v2, s[20:23], s40 offen nt
  s_add_u32 s40, s40, s41
  buffer_load_dwordx4 a[228:231], v2, s[20:23], s40 offen nt
  s_add_u32 s40, s40, s41
  buffer_load_dwordx4 a[232:235], v2, s[20:23], s40 offen nt
  s_add_u32 s40, s40, s41
  buffer_load_dwordx4 a[236:239], v2, s[20:23], s40 offen nt
  s_add_u32 s40, s40, s41
  buffer_load_dwordx4 a[240:243], v2, s[20:23], s40 offen nt
  s_add_u32 s40, s40, s41
  buffer_load_dwordx4 a[244:247], v2, s[20:23], s40 offen nt
  s_add_u32 s40, s40, s41
  buffer_load_dwordx4 a[248:251], v2, s[20:23], s40 offen nt
  s_add_u32 s40, s40, s41
  buffer_load_dwordx4 a[252:255], v2, s[20:23], s40 offen nt
  s_add_u32 s40, s40, s41
  s_add_u32 s40, s40, s34
  s_cmp_lg_u32 s30, 0
  s_cbranch_scc1 ar_10
  s_mov_b64 s[96:97], exec
  s_mov_b64 exec, 1
  v_mov_b32 v10, 64
  v_mov_b32 v11, 1
  buffer_atomic_add v11, v10, s[12:15], 0 offen
  s_mov_b64 exec, s[96:97]
  s_branch are_11
ar_10:
  s_mov_b64 s[96:97], exec
  s_mov_b64 exec, 1
  v_mov_b32 v10, 81920
  buffer_load_dword v11, v10, s[8:11], 0 offen
  s_mov_b64 exec, s[96:97]
are_11:
  s_waitcnt vmcnt(49)
  ds_write_b128 v13, a[32:35] offset:32768
  ds_write_b128 v13, a[36:39] offset:33792
  ds_write_b128 v13, a[40:43] offset:34816
  ds_write_b128 v13, a[44:47] offset:35840
  ds_write_b128 v13, a[48:51] offset:36864
  ds_write_b128 v13, a[52:55] offset:37888
  ds_write_b128 v13, a[56:59] offset:38912
  ds_write_b128 v13, a[60:63] offset:39936
  s_waitcnt lgkmcnt(0)
  s_barrier
  ds_read_b64_tr_b16 a[32:33], v3 offset:32768
  ds_read_b64_tr_b16 a[34:35], v3 offset:33792
  ds_read_b64_tr_b16 a[36:37], v3 offset:32776
  ds_read_b64_tr_b16 a[38:39], v3 offset:33800
  ds_read_b64_tr_b16 a[40:41], v3 offset:40960
  ds_read_b64_tr_b16 a[42:43], v3 offset:41984
  ds_read_b64_tr_b16 a[44:45], v3 offset:40968
  ds_read_b64_tr_b16 a[46:47], v3 offset:41992
  ds_read_b64_tr_b16 a[48:49], v3 offset:49152
  ds_read_b64_tr_b16 a[50:51], v3 offset:50176
  ds_read_b64_tr_b16 a[52:53], v3 offset:49160
  ds_read_b64_tr_b16 a[54:55], v3 offset:50184
  ds_read_b64_tr_b16 a[56:57], v3 offset:57344
  ds_read_b64_tr_b16 a[58:59], v3 offset:58368
  ds_read_b64_tr_b16 a[60:61], v3 offset:57352
  ds_read_b64_tr_b16 a[62:63], v3 offset:58376
  s_waitcnt lgkmcnt(0)
  s_waitcnt vmcnt(41)
  ds_write_b128 v13, a[64:67] offset:0
  ds_write_b128 v13, a[68:71] offset:1024
  ds_write_b128 v13, a[72:75] offset:2048
  ds_write_b128 v13, a[76:79] offset:3072
  ds_write_b128 v13, a[80:83] offset:4096
  ds_write_b128 v13, a[84:87] offset:5120
  ds_write_b128 v13, a[88:91] offset:6144
  ds_write_b128 v13, a[92:95] offset:7168
  s_waitcnt lgkmcnt(0)
  s_barrier
  ds_read_b64_tr_b16 a[64:65], v3 offset:0
  ds_read_b64_tr_b16 a[66:67], v3 offset:1024
  ds_read_b64_tr_b16 a[68:69], v3 offset:8
  ds_read_b64_tr_b16 a[70:71], v3 offset:1032
  ds_read_b64_tr_b16 a[72:73], v3 offset:8192
  ds_read_b64_tr_b16 a[74:75], v3 offset:9216
  ds_read_b64_tr_b16 a[76:77], v3 offset:8200
  ds_read_b64_tr_b16 a[78:79], v3 offset:9224
  ds_read_b64_tr_b16 a[80:81], v3 offset:16384
  ds_read_b64_tr_b16 a[82:83], v3 offset:17408
  ds_read_b64_tr_b16 a[84:85], v3 offset:16392
  ds_read_b64_tr_b16 a[86:87], v3 offset:17416
  ds_read_b64_tr_b16 a[88:89], v3 offset:24576
  ds_read_b64_tr_b16 a[90:91], v3 offset:25600
  ds_read_b64_tr_b16 a[92:93], v3 offset:24584
  ds_read_b64_tr_b16 a[94:95], v3 offset:25608
  s_waitcnt lgkmcnt(0)
  s_waitcnt vmcnt(33)
  ds_write_b128 v13, a[96:99] offset:32768
  ds_write_b128 v13, a[100:103] offset:33792
  ds_write_b128 v13, a[104:107] offset:34816
  ds_write_b128 v13, a[108:111] offset:35840
  ds_write_b128 v13, a[112:115] offset:36864
  ds_write_b128 v13, a[116:119] offset:37888
  ds_write_b128 v13, a[120:123] offset:38912
  ds_write_b128 v13, a[124:127] offset:39936
  s_waitcnt lgkmcnt(0)
  s_barrier
  ds_read_b64_tr_b16 a[96:97], v3 offset:32768
  ds_read_b64_tr_b16 a[98:99], v3 offset:33792
  ds_read_b64_tr_b16 a[100:101], v3 offset:32776
  ds_read_b64_tr_b16 a[102:103], v3 offset:33800
  ds_read_b64_tr_b16 a[104:105], v3 offset:40960
  ds_read_b64_tr_b16 a[106:107], v3 offset:41984
  ds_read_b64_tr_b16 a[108:109], v3 offset:40968
  ds_read_b64_tr_b16 a[110:111], v3 offset:41992
  ds_read_b64_tr_b16 a[112:113], v3 offset:49152
  ds_read_b64_tr_b16 a[114:115], v3 offset:50176
  ds_read_b64_tr_b16 a[116:117], v3 offset:49160
  ds_read_b64_tr_b16 a[118:119], v3 offset:50184
  ds_read_b64_tr_b16 a[120:121], v3 offset:57344
  ds_read_b64_tr_b16 a[122:123], v3 offset:58368
  ds_read_b64_tr_b16 a[124:125], v3 offset:57352
  ds_read_b64_tr_b16 a[126:127], v3 offset:58376
  s_waitcnt lgkmcnt(0)
  s_waitcnt vmcnt(25)
  ds_write_b128 v13, a[128:131] offset:0
  ds_write_b128 v13, a[132:135] offset:1024
  ds_write_b128 v13, a[136:139] offset:2048
  ds_write_b128 v13, a[140:143] offset:3072
  ds_write_b128 v13, a[144:147] offset:4096
  ds_write_b128 v13, a[148:151] offset:5120
  ds_write_b128 v13, a[152:155] offset:6144
  ds_write_b128 v13, a[156:159] offset:7168
  s_waitcnt lgkmcnt(0)
  s_barrier
  ds_read_b64_tr_b16 a[128:129], v3 offset:0
  ds_read_b64_tr_b16 a[130:131], v3 offset:1024
  ds_read_b64_tr_b16 a[132:133], v3 offset:8
  ds_read_b64_tr_b16 a[134:135], v3 offset:1032
  ds_read_b64_tr_b16 a[136:137], v3 offset:8192
  ds_read_b64_tr_b16 a[138:139], v3 offset:9216
  ds_read_b64_tr_b16 a[140:141], v3 offset:8200
  ds_read_b64_tr_b16 a[142:143], v3 offset:9224
  ds_read_b64_tr_b16 a[144:145], v3 offset:16384
  ds_read_b64_tr_b16 a[146:147], v3 offset:17408
  ds_read_b64_tr_b16 a[148:149], v3 offset:16392
  ds_read_b64_tr_b16 a[150:151], v3 offset:17416
  ds_read_b64_tr_b16 a[152:153], v3 offset:24576
  ds_read_b64_tr_b16 a[154:155], v3 offset:25600
  ds_read_b64_tr_b16 a[156:157], v3 offset:24584
  ds_read_b64_tr_b16 a[158:159], v3 offset:25608
  s_waitcnt lgkmcnt(0)
  s_waitcnt vmcnt(17)
  ds_write_b128 v13, a[160:163] offset:32768
  ds_write_b128 v13, a[164:167] offset:33792
  ds_write_b128 v13, a[168:171] offset:34816
  ds_write_b128 v13, a[172:175] offset:35840
  ds_write_b128 v13, a[176:179] offset:36864
  ds_write_b128 v13, a[180:183] offset:37888
  ds_write_b128 v13, a[184:187] offset:38912
  ds_write_b128 v13, a[188:191] offset:39936
  s_waitcnt lgkmcnt(0)
  s_barrier
  ds_read_b64_tr_b16 a[160:161], v3 offset:32768
  ds_read_b64_tr_b16 a[162:163], v3 offset:33792
  ds_read_b64_tr_b16 a[164:165], v3 offset:32776
  ds_read_b64_tr_b16 a[166:167], v3 offset:33800
  ds_read_b64_tr_b16 a[168:169], v3 offset:40960
  ds_read_b64_tr_b16 a[170:171], v3 offset:41984
  ds_read_b64_tr_b16 a[172:173], v3 offset:40968
  ds_read_b64_tr_b16 a[174:175], v3 offset:41992
  ds_read_b64_tr_b16 a[176:177], v3 offset:49152
  ds_read_b64_tr_b16 a[178:179], v3 offset:50176
  ds_read_b64_tr_b16 a[180:181], v3 offset:49160
  ds_read_b64_tr_b16 a[182:183], v3 offset:50184
  ds_read_b64_tr_b16 a[184:185], v3 offset:57344
  ds_read_b64_tr_b16 a[186:187], v3 offset:58368
  ds_read_b64_tr_b16 a[188:189], v3 offset:57352
  ds_read_b64_tr_b16 a[190:191], v3 offset:58376
  s_waitcnt lgkmcnt(0)
  s_waitcnt vmcnt(9)
  ds_write_b128 v13, a[192:195] offset:0
  ds_write_b128 v13, a[196:199] offset:1024
  ds_write_b128 v13, a[200:203] offset:2048
  ds_write_b128 v13, a[204:207] offset:3072
  ds_write_b128 v13, a[208:211] offset:4096
  ds_write_b128 v13, a[212:215] offset:5120
  ds_write_b128 v13, a[216:219] offset:6144
  ds_write_b128 v13, a[220:223] offset:7168
  s_waitcnt lgkmcnt(0)
  s_barrier
  ds_read_b64_tr_b16 a[192:193], v3 offset:0
  ds_read_b64_tr_b16 a[194:195], v3 offset:1024
  ds_read_b64_tr_b16 a[196:197], v3 offset:8
  ds_read_b64_tr_b16 a[198:199], v3 offset:1032
  ds_read_b64_tr_b16 a[200:201], v3 offset:8192
  ds_read_b64_tr_b16 a[202:203], v3 offset:9216
  ds_read_b64_tr_b16 a[204:205], v3 offset:8200
  ds_read_b64_tr_b16 a[206:207], v3 offset:9224
  ds_read_b64_tr_b16 a[208:209], v3 offset:16384
  ds_read_b64_tr_b16 a[210:211], v3 offset:17408
  ds_read_b64_tr_b16 a[212:213], v3 offset:16392
  ds_read_b64_tr_b16 a[214:215], v3 offset:17416
  ds_read_b64_tr_b16 a[216:217], v3 offset:24576
  ds_read_b64_tr_b16 a[218:219], v3 offset:25600
  ds_read_b64_tr_b16 a[220:221], v3 offset:24584
  ds_read_b64_tr_b16 a[222:223], v3 offset:25608
  s_waitcnt lgkmcnt(0)
  s_waitcnt vmcnt(1)
  ds_write_b128 v13, a[224:227] offset:32768
  ds_write_b128 v13, a[228:231] offset:33792
  ds_write_b128 v13, a[232:235] offset:34816
  ds_write_b128 v13, a[236:239] offset:35840
  ds_write_b128 v13, a[240:243] offset:36864
  ds_write_b128 v13, a[244:247] offset:37888
  ds_write_b128 v13, a[248:251] offset:38912
  ds_write_b128 v13, a[252:255] offset:39936
  s_waitcnt lgkmcnt(0)
  s_barrier
  ds_read_b64_tr_b16 a[224:225], v3 offset:32768
  ds_read_b64_tr_b16 a[226:227], v3 offset:33792
  ds_read_b64_tr_b16 a[228:229], v3 offset:32776
  ds_read_b64_tr_b16 a[230:231], v3 offset:33800
  ds_read_b64_tr_b16 a[232:233], v3 offset:40960
  ds_read_b64_tr_b16 a[234:235], v3 offset:41984
  ds_read_b64_tr_b16 a[236:237], v3 offset:40968
  ds_read_b64_tr_b16 a[238:239], v3 offset:41992
  ds_read_b64_tr_b16 a[240:241], v3 offset:49152
  ds_read_b64_tr_b16 a[242:243], v3 offset:50176
  ds_read_b64_tr_b16 a[244:245], v3 offset:49160
  ds_read_b64_tr_b16 a[246:247], v3 offset:50184
  ds_read_b64_tr_b16 a[248:249], v3 offset:57344
  ds_read_b64_tr_b16 a[250:251], v3 offset:58368
  ds_read_b64_tr_b16 a[252:253], v3 offset:57352
  ds_read_b64_tr_b16 a[254:255], v3 offset:58376
  s_waitcnt lgkmcnt(0)
  s_barrier
  s_lshl_b32 s46, s30, 14
  s_mov_b32 s47, 65536
  s_mov_b32 s51, 262144
  s_mov_b32 s45, 64
  s_mov_b32 s42, 0
  s_mov_b32 s43, 1
  s_lshl_b32 s48, s30, 14
  s_mov_b32 s44, 0
  s_mov_b32 m0, s48
  s_nop 0
  buffer_load_dwordx4 v5, s[16:19], s46 offen offset:0 lds
  s_add_u32 m0, m0, 896
  s_nop 0
  buffer_load_dwordx4 v5, s[16:19], s46 offen offset:128 lds
  s_add_u32 m0, m0, 896
  s_nop 0
  buffer_load_dwordx4 v5, s[16:19], s46 offen offset:256 lds
  s_add_u32 m0, m0, 896
  s_nop 0
  buffer_load_dwordx4 v5, s[16:19], s46 offen offset:384 lds
  s_add_u32 m0, m0, 896
  s_nop 0
  buffer_load_dwordx4 v5, s[16:19], s46 offen offset:512 lds
  s_add_u32 m0, m0, 896
  s_nop 0
  buffer_load_dwordx4 v5, s[16:19], s46 offen offset:640 lds
  s_add_u32 m0, m0, 896
  s_nop 0
  buffer_load_dwordx4 v5, s[16:19], s46 offen offset:768 lds
  s_add_u32 m0, m0, 896
  s_nop 0
  buffer_load_dwordx4 v5, s[16:19], s46 offen offset:896 lds
  s_add_u32 m0, m0, 896
  s_nop 0
  buffer_load_dwordx4 v5, s[16:19], s46 offen offset:1024 lds
  s_add_u32 m0, m0, 896
  s_nop 0
  buffer_load_dwordx4 v5, s[16:19], s46 offen offset:1152 lds
  s_add_u32 m0, m0, 896
  s_nop 0
  buffer_load_dwordx4 v5, s[16:19], s46 offen offset:1280 lds
  s_add_u32 m0, m0, 896
  s_nop 0
  buffer_load_dwordx4 v5, s[16:19], s46 offen offset:1408 lds
  s_add_u32 m0, m0, 896
  s_nop 0
  buffer_load_dwordx4 v5, s[16:19], s46 offen offset:1536 lds
  s_add_u32 m0, m0, 896
  s_nop 0
  buffer_load_dwordx4 v5, s[16:19], s46 offen offset:1664 lds
  s_add_u32 m0, m0, 896
  s_nop 0
  buffer_load_dwordx4 v5, s[16:19], s46 offen offset:1792 lds
  s_add_u32 m0, m0, 896
  s_nop 0
  buffer_load_dwordx4 v5, s[16:19], s46 offen offset:1920 lds
  s_waitcnt vmcnt(0)
L_V_loop:
  s_waitcnt vmcnt(2)
  s_barrier
  s_cmp_lg_u32 s44, 1
  s_cbranch_scc1 nf1_13
  s_waitcnt vmcnt(0)
  s_barrier
  s_cmp_lg_u32 s30, 0
  s_cbranch_scc1 w0_14
  s_mov_b64 s[96:97], exec
  s_mov_b64 exec, 1
  v_mov_b32 v10, s52
  v_mov_b32 v11, 1
  buffer_store_dword v11, v10, s[8:11], 0 offen sc1
  s_mov_b64 exec, s[96:97]
w0_14:
  s_branch nf_12
nf1_13:
  s_cmp_lt_u32 s44, 2
  s_cbranch_scc1 nf_12
  s_sub_u32 s34, s44, 1
  s_cmp_lg_u32 s30, 0
  s_cbranch_scc1 w0_15
  s_mov_b64 s[96:97], exec
  s_mov_b64 exec, 1
  v_mov_b32 v10, s52
  v_mov_b32 v11, s34
  buffer_store_dword v11, v10, s[8:11], 0 offen sc1
  s_mov_b64 exec, s[96:97]
w0_15:
nf_12:
  s_add_u32 s46, s46, s47
  s_add_u32 s33, s44, 1
  s_cmp_lt_u32 s33, s45
  s_cselect_b32 s46, s46, 0xf0000000
  s_xor_b32 s48, s48, 0x10000
  ds_read_b128 v[32:35], v6 offset:0
  ds_read_b128 v[36:39], v6 offset:32768
  ds_read_b128 v[40:43], v7 offset:0
  ds_read_b128 v[44:47], v7 offset:32768
  ds_read_b128 v[48:51], v6 offset:1024
  ds_read_b128 v[52:55], v6 offset:33792
  ds_read_b128 v[56:59], v7 offset:1024
  s_waitcnt lgkmcnt(5)
  v_mfma_f32_16x16x32_bf16 v[16:19], v[32:35], a[0:3], 0
  ds_read_b128 v[60:63], v7 offset:33792
  v_mfma_f32_16x16x32_bf16 v[20:23], v[32:35], a[4:7], 0
  s_mov_b32 m0, s48
  v_mfma_f32_16x16x32_bf16 v[24:27], v[36:39], a[0:3], 0
  ds_read_b128 v[32:35], v6 offset:2048
  v_mfma_f32_16x16x32_bf16 v[28:31], v[36:39], a[4:7], 0
  buffer_load_dwordx4 v5, s[16:19], s46 offen offset:0 lds
  s_waitcnt lgkmcnt(5)
  v_mfma_f32_16x16x32_bf16 v[16:19], v[40:43], a[8:11], v[16:19]
  ds_read_b128 v[36:39], v6 offset:34816
  v_mfma_f32_16x16x32_bf16 v[20:23], v[40:43], a[12:15], v[20:23]
  s_add_u32 m0, m0, 896
  v_mfma_f32_16x16x32_bf16 v[24:27], v[44:47], a[8:11], v[24:27]
  ds_read_b128 v[40:43], v7 offset:2048
  v_mfma_f32_16x16x32_bf16 v[28:31], v[44:47], a[12:15], v[28:31]
  buffer_load_dwordx4 v5, s[16:19], s46 offen offset:128 lds
  s_waitcnt lgkmcnt(5)
  v_mfma_f32_16x16x32_bf16 v[16:19], v[48:51], a[16:19], v[16:19]
  ds_read_b128 v[44:47], v7 offset:34816
  v_mfma_f32_16x16x32_bf16 v[20:23], v[48:51], a[20:23], v[20:23]
  s_add_u32 m0, m0, 896
  v_mfma_f32_16x16x32_bf16 v[24:27], v[52:55], a[16:19], v[24:27]
  ds_read_b128 v[48:51], v6 offset:3072
  v_mfma_f32_16x16x32_bf16 v[28:31], v[52:55], a[20:23], v[28:31]
  buffer_load_dwordx4 v5, s[16:19], s46 offen offset:256 lds
  s_waitcnt lgkmcnt(5)
  v_mfma_f32_16x16x32_bf16 v[16:19], v[56:59], a[24:27], v[16:19]
  ds_read_b128 v[52:55], v6 offset:35840
  v_mfma_f32_16x16x32_bf16 v[20:23], v[56:59], a[28:31], v[20:23]
  s_add_u32 m0, m0, 896
  v_mfma_f32_16x16x32_bf16 v[24:27], v[60:63], a[24:27], v[24:27]
  ds_read_b128 v[56:59], v7 offset:3072
  v_mfma_f32_16x16x32_bf16 v[28:31], v[60:63], a[28:31], v[28:31]
  buffer_load_dwordx4 v5, s[16:19], s46 offen offset:384 lds
  s_waitcnt lgkmcnt(5)
  v_mfma_f32_16x16x32_bf16 v[16:19], v[32:35], a[32:35], v[16:19]
  ds_read_b128 v[60:63], v7 offset:35840
  v_mfma_f32_16x16x32_bf16 v[20:23], v[32:35], a[36:39], v[20:23]
  s_add_u32 m0, m0, 896
  v_mfma_f32_16x16x32_bf16 v[24:27], v[36:39], a[32:35], v[24:27]
  ds_read_b128 v[32:35], v6 offset:4096
  v_mfma_f32_16x16x32_bf16 v[28:31], v[36:39], a[36:39], v[28:31]
  buffer_load_dwordx4 v5, s[16:19], s46 offen offset:512 lds
  s_waitcnt lgkmcnt(5)
  v_mfma_f32_16x16x32_bf16 v[16:19], v[40:43], a[40:43], v[16:19]
  ds_read_b128 v[36:39], v6 offset:36864
  v_mfma_f32_16x16x32_bf16 v[20:23], v[40:43], a[44:47], v[20:23]
  s_add_u32 m0, m0, 896
  v_mfma_f32_16x16x32_bf16 v[24:27], v[44:47], a[40:43], v[24:27]
  ds_read_b128 v[40:43], v7 offset:4096
  v_mfma_f32_16x16x32_bf16 v[28:31], v[44:47], a[44:47], v[28:31]
  buffer_load_dwordx4 v5, s[16:19], s46 offen offset:640 lds
  s_waitcnt lgkmcnt(5)
  v_mfma_f32_16x16x32_bf16 v[16:19], v[48:51], a[48:51], v[16:19]
  ds_read_b128 v[44:47], v7 offset:36864
  v_mfma_f32_16x16x32_bf16 v[20:23], v[48:51], a[52:55], v[20:23]
  s_add_u32 m0, m0, 896
  v_mfma_f32_16x16x32_bf16 v[24:27], v[52:55], a[48:51], v[24:27]
  ds_read_b128 v[48:51], v6 offset:5120
  v_mfma_f32_16x16x32_bf16 v[28:31], v[52:55], a[52:55], v[28:31]
  buffer_load_dwordx4 v5, s[16:19], s46 offen offset:768 lds
  s_waitcnt lgkmcnt(5)
  v_mfma_f32_16x16x32_bf16 v[16:19], v[56:59], a[56:59], v[16:19]
  ds_read_b128 v[52:55], v6 offset:37888
  v_mfma_f32_16x16x32_bf16 v[20:23], v[56:59], a[60:63], v[20:23]
  s_add_u32 m0, m0, 896
  v_mfma_f32_16x16x32_bf16 v[24:27], v[60:63], a[56:59], v[24:27]
  ds_read_b128 v[56:59], v7 offset:5120
  v_mfma_f32_16x16x32_bf16 v[28:31], v[60:63], a[60:63], v[28:31]
  buffer_load_dwordx4 v5, s[16:19], s46 offen offset:896 lds
  s_waitcnt lgkmcnt(5)
  v_mfma_f32_16x16x32_bf16 v[16:19], v[32:35], a[64:67], v[16:19]
  ds_read_b128 v[60:63], v7 offset:37888
  v_mfma_f32_16x16x32_bf16 v[20:23], v[32:35], a[68:71], v[20:23]
  s_add_u32 m0, m0, 896
  v_mfma_f32_16x16x32_bf16 v[24:27], v[36:39], a[64:67], v[24:27]
  ds_read_b128 v[32:35], v6 offset:6144
  v_mfma_f32_16x16x32_bf16 v[28:31], v[36:39], a[68:71], v[28:31]
  buffer_load_dwordx4 v5, s[16:19], s46 offen offset:1024 lds
  s_waitcnt lgkmcnt(5)
  v_mfma_f32_16x16x32_bf16 v[16:19], v[40:43], a[72:75], v[16:19]
  ds_read_b128 v[36:39], v6 offset:38912
  v_mfma_f32_16x16x32_bf16 v[20:23], v[40:43], a[76:79], v[20:23]
  s_add_u32 m0, m0, 896
  v_mfma_f32_16x16x32_bf16 v[24:27], v[44:47], a[72:75], v[24:27]
  ds_read_b128 v[40:43], v7 offset:6144
  v_mfma_f32_16x16x32_bf16 v[28:31], v[44:47], a[76:79], v[28:31]
  buffer_load_dwordx4 v5, s[16:19], s46 offen offset:1152 lds
  s_waitcnt lgkmcnt(5)
  v_mfma_f32_16x16x32_bf16 v[16:19], v[48:51], a[80:83], v[16:19]
  ds_read_b128 v[44:47], v7 offset:38912
  v_mfma_f32_16x16x32_bf16 v[20:23], v[48:51], a[84:87], v[20:23]
  s_add_u32 m0, m0, 896
  v_mfma_f32_16x16x32_bf16 v[24:27], v[52:55], a[80:83], v[24:27]
  ds_read_b128 v[48:51], v6 offset:7168
  v_mfma_f32_16x16x32_bf16 v[28:31], v[52:55], a[84:87], v[28:31]
  buffer_load_dwordx4 v5, s[16:19], s46 offen offset:1280 lds
  s_waitcnt lgkmcnt(5)
  v_mfma_f32_16x16x32_bf16 v[16:19], v[56:59], a[88:91], v[16:19]
  ds_read_b128 v[52:55], v6 offset:39936
  v_mfma_f32_16x16x32_bf16 v[20:23], v[56:59], a[92:95], v[20:23]
  s_add_u32 m0, m0, 896
  v_mfma_f32_16x16x32_bf16 v[24:27], v[60:63], a[88:91], v[24:27]
  ds_read_b128 v[56:59], v7 offset:7168
  v_mfma_f32_16x16x32_bf16 v[28:31], v[60:63], a[92:95], v[28:31]
  buffer_load_dwordx4 v5, s[16:19], s46 offen offset:1408 lds
  s_waitcnt lgkmcnt(5)
  v_mfma_f32_16x16x32_bf16 v[16:19], v[32:35], a[96:99], v[16:19]
  ds_read_b128 v[60:63], v7 offset:39936
  v_mfma_f32_16x16x32_bf16 v[20:23], v[32:35], a[100:103], v[20:23]
  s_add_u32 m0, m0, 896
  v_mfma_f32_16x16x32_bf16 v[24:27], v[36:39], a[96:99], v[24:27]
  ds_read_b128 v[32:35], v6 offset:8192
  v_mfma_f32_16x16x32_bf16 v[28:31], v[36:39], a[100:103], v[28:31]
  buffer_load_dwordx4 v5, s[16:19], s46 offen offset:1536 lds
  s_waitcnt lgkmcnt(5)
  v_mfma_f32_16x16x32_bf16 v[16:19], v[40:43], a[104:107], v[16:19]
  ds_read_b128 v[36:39], v6 offset:40960
  v_mfma_f32_16x16x32_bf16 v[20:23], v[40:43], a[108:111], v[20:23]
  s_add_u32 m0, m0, 896
  v_mfma_f32_16x16x32_bf16 v[24:27], v[44:47], a[104:107], v[24:27]
  ds_read_b128 v[40:43], v7 offset:8192
  v_mfma_f32_16x16x32_bf16 v[28:31], v[44:47], a[108:111], v[28:31]
  buffer_load_dwordx4 v5, s[16:19], s46 offen offset:1664 lds
  s_waitcnt lgkmcnt(5)
  v_mfma_f32_16x16x32_bf16 v[16:19], v[48:51], a[112:115], v[16:19]
  ds_read_b128 v[44:47], v7 offset:40960
  v_mfma_f32_16x16x32_bf16 v[20:23], v[48:51], a[116:119], v[20:23]
  s_add_u32 m0, m0, 896
  v_mfma_f32_16x16x32_bf16 v[24:27], v[52:55], a[112:115], v[24:27]
  ds_read_b128 v[48:51], v6 offset:9216
  v_mfma_f32_16x16x32_bf16 v[28:31], v[52:55], a[116:119], v[28:31]
  buffer_load_dwordx4 v5, s[16:19], s46 offen offset:1792 lds
  s_waitcnt lgkmcnt(5)
  v_mfma_f32_16x16x32_bf16 v[16:19], v[56:59], a[120:123], v[16:19]
  ds_read_b128 v[52:55], v6 offset:41984
  v_mfma_f32_16x16x32_bf16 v[20:23], v[56:59], a[124:127], v[20:23]
  s_add_u32 m0, m0, 896
  v_mfma_f32_16x16x32_bf16 v[24:27], v[60:63], a[120:123], v[24:27]
  ds_read_b128 v[56:59], v7 offset:9216
  v_mfma_f32_16x16x32_bf16 v[28:31], v[60:63], a[124:127], v[28:31]
  buffer_load_dwordx4 v5, s[16:19], s46 offen offset:1920 lds
  s_waitcnt lgkmcnt(5)
  v_mfma_f32_16x16x32_bf16 v[16:19], v[32:35], a[128:131], v[16:19]
  ds_read_b128 v[60:63], v7 offset:41984
  v_mfma_f32_16x16x32_bf16 v[20:23], v[32:35], a[132:135], v[20:23]
  v_mfma_f32_16x16x32_bf16 v[24:27], v[36:39], a[128:131], v[24:27]
  ds_read_b128 v[32:35], v6 offset:10240
  v_mfma_f32_16x16x32_bf16 v[28:31], v[36:39], a[132:135], v[28:31]
  s_waitcnt lgkmcnt(5)
  v_mfma_f32_16x16x32_bf16 v[16:19], v[40:43], a[136:139], v[16:19]
  ds_read_b128 v[36:39], v6 offset:43008
  v_mfma_f32_16x16x32_bf16 v[20:23], v[40:43], a[140:143], v[20:23]
  v_mfma_f32_16x16x32_bf16 v[24:27], v[44:47], a[136:139], v[24:27]
  ds_read_b128 v[40:43], v7 offset:10240
  v_mfma_f32_16x16x32_bf16 v[28:31], v[44:47], a[140:143], v[28:31]
  s_waitcnt lgkmcnt(5)
  v_mfma_f32_16x16x32_bf16 v[16:19], v[48:51], a[144:147], v[16:19]
  ds_read_b128 v[44:47], v7 offset:43008
  v_mfma_f32_16x16x32_bf16 v[20:23], v[48:51], a[148:151], v[20:23]
  v_mfma_f32_16x16x32_bf16 v[24:27], v[52:55], a[144:147], v[24:27]
  ds_read_b128 v[48:51], v6 offset:11264
  v_mfma_f32_16x16x32_bf16 v[28:31], v[52:55], a[148:151], v[28:31]
  s_waitcnt lgkmcnt(5)
  v_mfma_f32_16x16x32_bf16 v[16:19], v[56:59], a[152:155], v[16:19]
  ds_read_b128 v[52:55], v6 offset:44032
  v_mfma_f32_16x16x32_bf16 v[20:23], v[56:59], a[156:159], v[20:23]
  v_mfma_f32_16x16x32_bf16 v[24:27], v[60:63], a[152:155], v[24:27]
  ds_read_b128 v[56:59], v7 offset:11264
  v_mfma_f32_16x16x32_bf16 v[28:31], v[60:63], a[156:159], v[28:31]
  s_waitcnt lgkmcnt(5)
  v_mfma_f32_16x16x32_bf16 v[16:19], v[32:35], a[160:163], v[16:19]
  ds_read_b128 v[60:63], v7 offset:44032
  v_mfma_f32_16x16x32_bf16 v[20:23], v[32:35], a[164:167], v[20:23]
  v_mfma_f32_16x16x32_bf16 v[24:27], v[36:39], a[160:163], v[24:27]
  ds_read_b128 v[32:35], v6 offset:12288
  v_mfma_f32_16x16x32_bf16 v[28:31], v[36:39], a[164:167], v[28:31]
  s_waitcnt lgkmcnt(5)
  v_mfma_f32_16x16x32_bf16 v[16:19], v[40:43], a[168:171], v[16:19]
  ds_read_b128 v[36:39], v6 offset:45056
  v_mfma_f32_16x16x32_bf16 v[20:23], v[40:43], a[172:175], v[20:23]
  v_mfma_f32_16x16x32_bf16 v[24:27], v[44:47], a[168:171], v[24:27]
  ds_read_b128 v[40:43], v7 offset:12288
  v_mfma_f32_16x16x32_bf16 v[28:31], v[44:47], a[172:175], v[28:31]
  s_waitcnt lgkmcnt(5)
  v_mfma_f32_16x16x32_bf16 v[16:19], v[48:51], a[176:179], v[16:19]
  ds_read_b128 v[44:47], v7 offset:45056
  v_mfma_f32_16x16x32_bf16 v[20:23], v[48:51], a[180:183], v[20:23]
  v_mfma_f32_16x16x32_bf16 v[24:27], v[52:55], a[176:179], v[24:27]
  ds_read_b128 v[48:51], v6 offset:13312
  v_mfma_f32_16x16x32_bf16 v[28:31], v[52:55], a[180:183], v[28:31]
  s_waitcnt lgkmcnt(5)
  v_mfma_f32_16x16x32_bf16 v[16:19], v[56:59], a[184:187], v[16:19]
  ds_read_b128 v[52:55], v6 offset:46080
  v_mfma_f32_16x16x32_bf16 v[20:23], v[56:59], a[188:191], v[20:23]
  v_mfma_f32_16x16x32_bf16 v[24:27], v[60:63], a[184:187], v[24:27]
  ds_read_b128 v[56:59], v7 offset:13312
  v_mfma_f32_16x16x32_bf16 v[28:31], v[60:63], a[188:191], v[28:31]
  s_waitcnt lgkmcnt(5)
  v_mfma_f32_16x16x32_bf16 v[16:19], v[32:35], a[192:195], v[16:19]
  ds_read_b128 v[60:63], v7 offset:46080
  v_mfma_f32_16x16x32_bf16 v[20:23], v[32:35], a[196:199], v[20:23]
  v_mfma_f32_16x16x32_bf16 v[24:27], v[36:39], a[192:195], v[24:27]
  ds_read_b128 v[32:35], v6 offset:14336
  v_mfma_f32_16x16x32_bf16 v[28:31], v[36:39], a[196:199], v[28:31]
  s_waitcnt lgkmcnt(5)
  v_mfma_f32_16x16x32_bf16 v[16:19], v[40:43], a[200:203], v[16:19]
  ds_read_b128 v[36:39], v6 offset:47104
  v_mfma_f32_16x16x32_bf16 v[20:23], v[40:43], a[204:207], v[20:23]
  v_mfma_f32_16x16x32_bf16 v[24:27], v[44:47], a[200:203], v[24:27]
  ds_read_b128 v[40:43], v7 offset:14336
  v_mfma_f32_16x16x32_bf16 v[28:31], v[44:47], a[204:207], v[28:31]
  s_waitcnt lgkmcnt(5)
  v_mfma_f32_16x16x32_bf16 v[16:19], v[48:51], a[208:211], v[16:19]
  ds_read_b128 v[44:47], v7 offset:47104
  v_mfma_f32_16x16x32_bf16 v[20:23], v[48:51], a[212:215], v[20:23]
  v_mfma_f32_16x16x32_bf16 v[24:27], v[52:55], a[208:211], v[24:27]
  ds_read_b128 v[48:51], v6 offset:15360
  v_mfma_f32_16x16x32_bf16 v[28:31], v[52:55], a[212:215], v[28:31]
  s_waitcnt lgkmcnt(5)
  v_mfma_f32_16x16x32_bf16 v[16:19], v[56:59], a[216:219], v[16:19]
  ds_read_b128 v[52:55], v6 offset:48128
  v_mfma_f32_16x16x32_bf16 v[20:23], v[56:59], a[220:223], v[20:23]
  v_mfma_f32_16x16x32_bf16 v[24:27], v[60:63], a[216:219], v[24:27]
  ds_read_b128 v[56:59], v7 offset:15360
  v_mfma_f32_16x16x32_bf16 v[28:31], v[60:63], a[220:223], v[28:31]
  s_waitcnt lgkmcnt(5)
  v_mfma_f32_16x16x32_bf16 v[16:19], v[32:35], a[224:227], v[16:19]
  ds_read_b128 v[60:63], v7 offset:48128
  v_mfma_f32_16x16x32_bf16 v[20:23], v[32:35], a[228:231], v[20:23]
  v_mfma_f32_16x16x32_bf16 v[24:27], v[36:39], a[224:227], v[24:27]
  v_mfma_f32_16x16x32_bf16 v[28:31], v[36:39], a[228:231], v[28:31]
  s_waitcnt lgkmcnt(4)
  v_mfma_f32_16x16x32_bf16 v[16:19], v[40:43], a[232:235], v[16:19]
  v_mfma_f32_16x16x32_bf16 v[20:23], v[40:43], a[236:239], v[20:23]
  v_mfma_f32_16x16x32_bf16 v[24:27], v[44:47], a[232:235], v[24:27]
  v_mfma_f32_16x16x32_bf16 v[28:31], v[44:47], a[236:239], v[28:31]
  s_waitcnt lgkmcnt(2)
  v_mfma_f32_16x16x32_bf16 v[16:19], v[48:51], a[240:243], v[16:19]
  v_mfma_f32_16x16x32_bf16 v[20:23], v[48:51], a[244:247], v[20:23]
  v_mfma_f32_16x16x32_bf16 v[24:27], v[52:55], a[240:243], v[24:27]
  v_mfma_f32_16x16x32_bf16 v[28:31], v[52:55], a[244:247], v[28:31]
  s_waitcnt lgkmcnt(0)
  v_mfma_f32_16x16x32_bf16 v[16:19], v[56:59], a[248:251], v[16:19]
  v_mfma_f32_16x16x32_bf16 v[20:23], v[56:59], a[252:255], v[20:23]
  v_mfma_f32_16x16x32_bf16 v[24:27], v[60:63], a[248:251], v[24:27]
  v_mfma_f32_16x16x32_bf16 v[28:31], v[60:63], a[252:255], v[28:31]
  s_nop 4
  v_cvt_pk_bf16_f32 v64, v16, v17
  v_cvt_pk_bf16_f32 v65, v18, v19
  v_cvt_pk_bf16_f32 v66, v24, v25
  v_cvt_pk_bf16_f32 v67, v26, v27
  buffer_store_dwordx4 v[64:67], v8, s[8:11], s49 offen sc1
  v_cvt_pk_bf16_f32 v68, v20, v21
  v_cvt_pk_bf16_f32 v69, v22, v23
  v_cvt_pk_bf16_f32 v70, v28, v29
  v_cvt_pk_bf16_f32 v71, v30, v31
  s_add_u32 s54, s49, s50
  buffer_store_dwordx4 v[68:71], v8, s[8:11], s54 offen sc1
  v_xor_b32 v6, 0x10000, v6
  v_xor_b32 v7, 0x10000, v7
  s_add_u32 s49, s49, s51
  s_add_u32 s42, s42, s43
  s_add_u32 s44, s44, 1
  s_cmp_lt_u32 s44, s45
  s_cbranch_scc1 L_V_loop
  s_waitcnt vmcnt(0)
  s_barrier
  s_cmp_lg_u32 s30, 0
  s_cbranch_scc1 w0_16
  s_mov_b64 s[96:97], exec
  s_mov_b64 exec, 1
  v_mov_b32 v10, s52
  v_mov_b32 v11, s45
  buffer_store_dword v11, v10, s[8:11], 0 offen sc1
  s_mov_b64 exec, s[96:97]
w0_16:
L_role_F2:
  s_load_dwordx2 s[4:5], s[0:1], 72
  s_waitcnt lgkmcnt(0)
  s_mov_b32 s20, s4
  s_mov_b32 s21, s5
  s_mov_b32 s22, 7340032
  s_mov_b32 s23, 0x20000
  s_mov_b32 s42, s38
  s_lshl_b32 s52, s42, 5
  s_add_u32 s52, s52, s29
  s_lshl_b32 s52, s52, 7
  s_add_u32 s52, s52, 16384
  s_mov_b32 s41, 8192
  s_lshr_b32 s33, s29, 3
  s_and_b32 s34, s29, 7
  s_mul_i32 s40, s33, 1835008
  s_lshl_b32 s34, s34, 8
  s_add_u32 s40, s40, s34
  s_lshl_b32 s46, s33, 16
  s_lshl_b32 s34, s30, 14
  s_add_u32 s46, s46, s34
  s_lshl_b32 s34, s42, 18
  s_add_u32 s46, s46, s34
  s_add_u32 s46, s46, 67108864
  s_lshl_b32 s49, s29, 13
  s_add_u32 s49, s49, s34
  s_lshl_b32 s34, s30, 10
  s_add_u32 s49, s49, s34
  s_add_u32 s49, s49, 117440512
  s_mov_b32 s50, 4096
  s_mov_b32 s47, 524288
  s_mov_b32 s51, 524288
  s_mov_b32 s45, 32
  s_mov_b32 s43, 2
  s_mul_i32 s33, s33, 7
  v_min_u32 v9, 6, v1
  v_add_u32 v9, s33, v9
  v_lshlrev_b32 v9, 7, v9
  v_add_u32 v9, 12288, v9
  v_lshrrev_b32 v10, 4, v1
  v_and_b32 v11, 15, v1
  s_lshr_b32 s33, s41, 2
  v_mul_lo_u32 v2, v10, s33
  v_lshlrev_b32 v12, 2, v10
  v_xor_b32 v12, v12, v11
  v_lshl_add_u32 v2, v12, 4, v2
  v_bfe_u32 v12, v1, 2, 2
  v_lshl_add_u32 v13, v10, 3, v12
  v_lshlrev_b32 v3, 8, v13
  v_and_b32 v13, 3, v1
  s_lshl_b32 s33, s30, 2
  v_add_u32 v13, s33, v13
  v_lshlrev_b32 v12, 2, v12
  v_xor_b32 v13, v13, v12
  v_lshl_add_u32 v3, v13, 4, v3
  v_add_u32 v4, 0x10000, v3
  v_lshlrev_b32 v8, 4, v1
  v_lshlrev_b32 v5, 4, v1
  v_lshlrev_b32 v6, 4, v1
  v_add_u32 v7, 0x4000, v6
  s_lshl_b32 s33, s41, 3
  s_mul_i32 s33, s33, s30
  s_add_u32 s40, s40, s33
  s_mul_i32 s34, s41, 24
  s_lshl_b32 s35, s30, 13
  v_add_u32 v13, s35, v8
  buffer_load_dwordx4 a[0:3], v2, s[20:23], s40 offen nt
  s_add_u32 s40, s40, s41
  buffer_load_dwordx4 a[4:7], v2, s[20:23], s40 offen nt
  s_add_u32 s40, s40, s41
  buffer_load_dwordx4 a[8:11], v2, s[20:23], s40 offen nt
  s_add_u32 s40, s40, s41
  buffer_load_dwordx4 a[12:15], v2, s[20:23], s40 offen nt
  s_add_u32 s40, s40, s41
  buffer_load_dwordx4 a[16:19], v2, s[20:23], s40 offen nt
  s_add_u32 s40, s40, s41
  buffer_load_dwordx4 a[20:23], v2, s[20:23], s40 offen nt
  s_add_u32 s40, s40, s41
  buffer_load_dwordx4 a[24:27], v2, s[20:23], s40 offen nt
  s_add_u32 s40, s40, s41
  buffer_load_dwordx4 a[28:31], v2, s[20:23], s40 offen nt
  s_add_u32 s40, s40, s41
  s_add_u32 s40, s40, s34
  buffer_load_dwordx4 a[32:35], v2, s[20:23], s40 offen nt
  s_add_u32 s40, s40, s41
  buffer_load_dwordx4 a[36:39], v2, s[20:23], s40 offen nt
  s_add_u32 s40, s40, s41
  buffer_load_dwordx4 a[40:43], v2, s[20:23], s40 offen nt
  s_add_u32 s40, s40, s41
  buffer_load_dwordx4 a[44:47], v2, s[20:23], s40 offen nt
  s_add_u32 s40, s40, s41
  buffer_load_dwordx4 a[48:51], v2, s[20:23], s40 offen nt
  s_add_u32 s40, s40, s41
  buffer_load_dwordx4 a[52:55], v2, s[20:23], s40 offen nt
  s_add_u32 s40, s40, s41
  buffer_load_dwordx4 a[56:59], v2, s[20:23], s40 offen nt
  s_add_u32 s40, s40, s41
  buffer_load_dwordx4 a[60:63], v2, s[20:23], s40 offen nt
  s_add_u32 s40, s40, s41
  s_add_u32 s40, s40, s34
  buffer_load_dwordx4 a[64:67], v2, s[20:23], s40 offen nt
  s_add_u32 s40, s40, s41
  buffer_load_dwordx4 a[68:71], v2, s[20:23], s40 offen nt
  s_add_u32 s40, s40, s41
  buffer_load_dwordx4 a[72:75], v2, s[20:23], s40 offen nt
  s_add_u32 s40, s40, s41
  buffer_load_dwordx4 a[76:79], v2, s[20:23], s40 offen nt
  s_add_u32 s40, s40, s41
  buffer_load_dwordx4 a[80:83], v2, s[20:23], s40 offen nt
  s_add_u32 s40, s40, s41
  buffer_load_dwordx4 a[84:87], v2, s[20:23], s40 offen nt
  s_add_u32 s40, s40, s41
  buffer_load_dwordx4 a[88:91], v2, s[20:23], s40 offen nt
  s_add_u32 s40, s40, s41
  buffer_load_dwordx4 a[92:95], v2, s[20:23], s40 offen nt
  s_add_u32 s40, s40, s41
  s_add_u32 s40, s40, s34
  buffer_load_dwordx4 a[96:99], v2, s[20:23], s40 offen nt
  s_add_u32 s40, s40, s41
  buffer_load_dwordx4 a[100:103], v2, s[20:23], s40 offen nt
  s_add_u32 s40, s40, s41
  buffer_load_dwordx4 a[104:107], v2, s[20:23], s40 offen nt
  s_add_u32 s40, s40, s41
  buffer_load_dwordx4 a[108:111], v2, s[20:23], s40 offen nt
  s_add_u32 s40, s40, s41
  buffer_load_dwordx4 a[112:115], v2, s[20:23], s40 offen nt
  s_add_u32 s40, s40, s41
  buffer_load_dwordx4 a[116:119], v2, s[20:23], s40 offen nt
  s_add_u32 s40, s40, s41
  buffer_load_dwordx4 a[120:123], v2, s[20:23], s40 offen nt
  s_add_u32 s40, s40, s41
  buffer_load_dwordx4 a[124:127], v2, s[20:23], s40 offen nt
  s_add_u32 s40, s40, s41
  s_add_u32 s40, s40, s34
  buffer_load_dwordx4 a[128:131], v2, s[20:23], s40 offen nt
  s_add_u32 s40, s40, s41
  buffer_load_dwordx4 a[132:135], v2, s[20:23], s40 offen nt
  s_add_u32 s40, s40, s41
  buffer_load_dwordx4 a[136:139], v2, s[20:23], s40 offen nt
  s_add_u32 s40, s40, s41
  buffer_load_dwordx4 a[140:143], v2, s[20:23], s40 offen nt
  s_add_u32 s40, s40, s41
  buffer_load_dwordx4 a[144:147], v2, s[20:23], s40 offen nt
  s_add_u32 s40, s40, s41
  buffer_load_dwordx4 a[148:151], v2, s[20:23], s40 offen nt
  s_add_u32 s40, s40, s41
  buffer_load_dwordx4 a[152:155], v2, s[20:23], s40 offen nt
  s_add_u32 s40, s40, s41
  buffer_load_dwordx4 a[156:159], v2, s[20:23], s40 offen nt
  s_add_u32 s40, s40, s41
  s_add_u32 s40, s40, s34
  buffer_load_dwordx4 a[160:163], v2, s[20:23], s40 offen nt
  s_add_u32 s40, s40, s41
  buffer_load_dwordx4 a[164:167], v2, s[20:23], s40 offen nt
  s_add_u32 s40, s40, s41
  buffer_load_dwordx4 a[168:171], v2, s[20:23], s40 offen nt
  s_add_u32 s40, s40, s41
  buffer_load_dwordx4 a[172:175], v2, s[20:23], s40 offen nt
  s_add_u32 s40, s40, s41
  buffer_load_dwordx4 a[176:179], v2, s[20:23], s40 offen nt
  s_add_u32 s40, s40, s41
  buffer_load_dwordx4 a[180:183], v2, s[20:23], s40 offen nt
  s_add_u32 s40, s40, s41
  buffer_load_dwordx4 a[184:187], v2, s[20:23], s40 offen nt
  s_add_u32 s40, s40, s41
  buffer_load_dwordx4 a[188:191], v2, s[20:23], s40 offen nt
  s_add_u32 s40, s40, s41
  s_add_u32 s40, s40, s34
  buffer_load_dwordx4 a[192:195], v2, s[20:23], s40 offen nt
  s_add_u32 s40, s40, s41
  buffer_load_dwordx4 a[196:199], v2, s[20:23], s40 offen nt
  s_add_u32 s40, s40, s41
  buffer_load_dwordx4 a[200:203], v2, s[20:23], s40 offen nt
  s_add_u32 s40, s40, s41
  buffer_load_dwordx4 a[204:207], v2, s[20:23], s40 offen nt
  s_add_u32 s40, s40, s41
  buffer_load_dwordx4 a[208:211], v2, s[20:23], s40 offen nt
  s_add_u32 s40, s40, s41
  buffer_load_dwordx4 a[212:215], v2, s[20:23], s40 offen nt
  s_add_u32 s40, s40, s41
  buffer_load_dwordx4 a[216:219], v2, s[20:23], s40 offen nt
  s_add_u32 s40, s40, s41
  buffer_load_dwordx4 a[220:223], v2, s[20:23], s40 offen nt
  s_add_u32 s40, s40, s41
  s_add_u32 s40, s40, s34
  s_waitcnt vmcnt(48)
  ds_write_b128 v13, a[0:3] offset:0
  ds_write_b128 v13, a[4:7] offset:1024
  ds_write_b128 v13, a[8:11] offset:2048
  ds_write_b128 v13, a[12:15] offset:3072
  ds_write_b128 v13, a[16:19] offset:4096
  ds_write_b128 v13, a[20:23] offset:5120
  ds_write_b128 v13, a[24:27] offset:6144
  ds_write_b128 v13, a[28:31] offset:7168
  s_waitcnt lgkmcnt(0)
  s_barrier
  ds_read_b64_tr_b16 a[0:1], v3 offset:0
  ds_read_b64_tr_b16 a[2:3], v3 offset:1024
  ds_read_b64_tr_b16 a[4:5], v3 offset:8
  ds_read_b64_tr_b16 a[6:7], v3 offset:1032
  ds_read_b64_tr_b16 a[8:9], v3 offset:8192
  ds_read_b64_tr_b16 a[10:11], v3 offset:9216
  ds_read_b64_tr_b16 a[12:13], v3 offset:8200
  ds_read_b64_tr_b16 a[14:15], v3 offset:9224
  ds_read_b64_tr_b16 a[16:17], v3 offset:16384
  ds_read_b64_tr_b16 a[18:19], v3 offset:17408
  ds_read_b64_tr_b16 a[20:21], v3 offset:16392
  ds_read_b64_tr_b16 a[22:23], v3 offset:17416
  ds_read_b64_tr_b16 a[24:25], v3 offset:24576
  ds_read_b64_tr_b16 a[26:27], v3 offset:25600
  ds_read_b64_tr_b16 a[28:29], v3 offset:24584
  ds_read_b64_tr_b16 a[30:31], v3 offset:25608
  s_waitcnt lgkmcnt(0)
  s_waitcnt vmcnt(40)
  ds_write_b128 v13, a[32:35] offset:32768
  ds_write_b128 v13, a[36:39] offset:33792
  ds_write_b128 v13, a[40:43] offset:34816
  ds_write_b128 v13, a[44:47] offset:35840
  ds_write_b128 v13, a[48:51] offset:36864
  ds_write_b128 v13, a[52:55] offset:37888
  ds_write_b128 v13, a[56:59] offset:38912
  ds_write_b128 v13, a[60:63] offset:39936
  s_waitcnt lgkmcnt(0)
  s_barrier
  ds_read_b64_tr_b16 a[32:33], v3 offset:32768
  ds_read_b64_tr_b16 a[34:35], v3 offset:33792
  ds_read_b64_tr_b16 a[36:37], v3 offset:32776
  ds_read_b64_tr_b16 a[38:39], v3 offset:33800
  ds_read_b64_tr_b16 a[40:41], v3 offset:40960
  ds_read_b64_tr_b16 a[42:43], v3 offset:41984
  ds_read_b64_tr_b16 a[44:45], v3 offset:40968
  ds_read_b64_tr_b16 a[46:47], v3 offset:41992
  ds_read_b64_tr_b16 a[48:49], v3 offset:49152
  ds_read_b64_tr_b16 a[50:51], v3 offset:50176
  ds_read_b64_tr_b16 a[52:53], v3 offset:49160
  ds_read_b64_tr_b16 a[54:55], v3 offset:50184
  ds_read_b64_tr_b16 a[56:57], v3 offset:57344
  ds_read_b64_tr_b16 a[58:59], v3 offset:58368
  ds_read_b64_tr_b16 a[60:61], v3 offset:57352
  ds_read_b64_tr_b16 a[62:63], v3 offset:58376
  s_waitcnt lgkmcnt(0)
  s_waitcnt vmcnt(32)
  ds_write_b128 v13, a[64:67] offset:0
  ds_write_b128 v13, a[68:71] offset:1024
  ds_write_b128 v13, a[72:75] offset:2048
  ds_write_b128 v13, a[76:79] offset:3072
  ds_write_b128 v13, a[80:83] offset:4096
  ds_write_b128 v13, a[84:87] offset:5120
  ds_write_b128 v13, a[88:91] offset:6144
  ds_write_b128 v13, a[92:95] offset:7168
  s_waitcnt lgkmcnt(0)
  s_barrier
  ds_read_b64_tr_b16 a[64:65], v3 offset:0
  ds_read_b64_tr_b16 a[66:67], v3 offset:1024
  ds_read_b64_tr_b16 a[68:69], v3 offset:8
  ds_read_b64_tr_b16 a[70:71], v3 offset:1032
  ds_read_b64_tr_b16 a[72:73], v3 offset:8192
  ds_read_b64_tr_b16 a[74:75], v3 offset:9216
  ds_read_b64_tr_b16 a[76:77], v3 offset:8200
  ds_read_b64_tr_b16 a[78:79], v3 offset:9224
  ds_read_b64_tr_b16 a[80:81], v3 offset:16384
  ds_read_b64_tr_b16 a[82:83], v3 offset:17408
  ds_read_b64_tr_b16 a[84:85], v3 offset:16392
  ds_read_b64_tr_b16 a[86:87], v3 offset:17416
  ds_read_b64_tr_b16 a[88:89], v3 offset:24576
  ds_read_b64_tr_b16 a[90:91], v3 offset:25600
  ds_read_b64_tr_b16 a[92:93], v3 offset:24584
  ds_read_b64_tr_b16 a[94:95], v3 offset:25608
  s_waitcnt lgkmcnt(0)
  s_waitcnt vmcnt(24)
  ds_write_b128 v13, a[96:99] offset:32768
  ds_write_b128 v13, a[100:103] offset:33792
  ds_write_b128 v13, a[104:107] offset:34816
  ds_write_b128 v13, a[108:111] offset:35840
  ds_write_b128 v13, a[112:115] offset:36864
  ds_write_b128 v13, a[116:119] offset:37888
  ds_write_b128 v13, a[120:123] offset:38912
  ds_write_b128 v13, a[124:127] offset:39936
  s_waitcnt lgkmcnt(0)
  s_barrier
  ds_read_b64_tr_b16 a[96:97], v3 offset:32768
  ds_read_b64_tr_b16 a[98:99], v3 offset:33792
  ds_read_b64_tr_b16 a[100:101], v3 offset:32776
  ds_read_b64_tr_b16 a[102:103], v3 offset:33800
  ds_read_b64_tr_b16 a[104:105], v3 offset:40960
  ds_read_b64_tr_b16 a[106:107], v3 offset:41984
  ds_read_b64_tr_b16 a[108:109], v3 offset:40968
  ds_read_b64_tr_b16 a[110:111], v3 offset:41992
  ds_read_b64_tr_b16 a[112:113], v3 offset:49152
  ds_read_b64_tr_b16 a[114:115], v3 offset:50176
  ds_read_b64_tr_b16 a[116:117], v3 offset:49160
  ds_read_b64_tr_b16 a[118:119], v3 offset:50184
  ds_read_b64_tr_b16 a[120:121], v3 offset:57344
  ds_read_b64_tr_b16 a[122:123], v3 offset:58368
  ds_read_b64_tr_b16 a[124:125], v3 offset:57352
  ds_read_b64_tr_b16 a[126:127], v3 offset:58376
  s_waitcnt lgkmcnt(0)
  s_waitcnt vmcnt(16)
  ds_write_b128 v13, a[128:131] offset:0
  ds_write_b128 v13, a[132:135] offset:1024
  ds_write_b128 v13, a[136:139] offset:2048
  ds_write_b128 v13, a[140:143] offset:3072
  ds_write_b128 v13, a[144:147] offset:4096
  ds_write_b128 v13, a[148:151] offset:5120
  ds_write_b128 v13, a[152:155] offset:6144
  ds_write_b128 v13, a[156:159] offset:7168
  s_waitcnt lgkmcnt(0)
  s_barrier
  ds_read_b64_tr_b16 a[128:129], v3 offset:0
  ds_read_b64_tr_b16 a[130:131], v3 offset:1024
  ds_read_b64_tr_b16 a[132:133], v3 offset:8
  ds_read_b64_tr_b16 a[134:135], v3 offset:1032
  ds_read_b64_tr_b16 a[136:137], v3 offset:8192
  ds_read_b64_tr_b16 a[138:139], v3 offset:9216
  ds_read_b64_tr_b16 a[140:141], v3 offset:8200
  ds_read_b64_tr_b16 a[142:143], v3 offset:9224
  ds_read_b64_tr_b16 a[144:145], v3 offset:16384
  ds_read_b64_tr_b16 a[146:147], v3 offset:17408
  ds_read_b64_tr_b16 a[148:149], v3 offset:16392
  ds_read_b64_tr_b16 a[150:151], v3 offset:17416
  ds_read_b64_tr_b16 a[152:153], v3 offset:24576
  ds_read_b64_tr_b16 a[154:155], v3 offset:25600
  ds_read_b64_tr_b16 a[156:157], v3 offset:24584
  ds_read_b64_tr_b16 a[158:159], v3 offset:25608
  s_waitcnt lgkmcnt(0)
  s_waitcnt vmcnt(8)
  ds_write_b128 v13, a[160:163] offset:32768
  ds_write_b128 v13, a[164:167] offset:33792
  ds_write_b128 v13, a[168:171] offset:34816
  ds_write_b128 v13, a[172:175] offset:35840
  ds_write_b128 v13, a[176:179] offset:36864
  ds_write_b128 v13, a[180:183] offset:37888
  ds_write_b128 v13, a[184:187] offset:38912
  ds_write_b128 v13, a[188:191] offset:39936
  s_waitcnt lgkmcnt(0)
  s_barrier
  ds_read_b64_tr_b16 a[160:161], v3 offset:32768
  ds_read_b64_tr_b16 a[162:163], v3 offset:33792
  ds_read_b64_tr_b16 a[164:165], v3 offset:32776
  ds_read_b64_tr_b16 a[166:167], v3 offset:33800
  ds_read_b64_tr_b16 a[168:169], v3 offset:40960
  ds_read_b64_tr_b16 a[170:171], v3 offset:41984
  ds_read_b64_tr_b16 a[172:173], v3 offset:40968
  ds_read_b64_tr_b16 a[174:175], v3 offset:41992
  ds_read_b64_tr_b16 a[176:177], v3 offset:49152
  ds_read_b64_tr_b16 a[178:179], v3 offset:50176
  ds_read_b64_tr_b16 a[180:181], v3 offset:49160
  ds_read_b64_tr_b16 a[182:183], v3 offset:50184
  ds_read_b64_tr_b16 a[184:185], v3 offset:57344
  ds_read_b64_tr_b16 a[186:187], v3 offset:58368
  ds_read_b64_tr_b16 a[188:189], v3 offset:57352
  ds_read_b64_tr_b16 a[190:191], v3 offset:58376
  s_waitcnt lgkmcnt(0)
  s_waitcnt vmcnt(0)
  ds_write_b128 v13, a[192:195] offset:0
  ds_write_b128 v13, a[196:199] offset:1024
  ds_write_b128 v13, a[200:203] offset:2048
  ds_write_b128 v13, a[204:207] offset:3072
  ds_write_b128 v13, a[208:211] offset:4096
  ds_write_b128 v13, a[212:215] offset:5120
  ds_write_b128 v13, a[216:219] offset:6144
  ds_write_b128 v13, a[220:223] offset:7168
  s_waitcnt lgkmcnt(0)
  s_barrier
  ds_read_b64_tr_b16 a[192:193], v3 offset:0
  ds_read_b64_tr_b16 a[194:195], v3 offset:1024
  ds_read_b64_tr_b16 a[196:197], v3 offset:8
  ds_read_b64_tr_b16 a[198:199], v3 offset:1032
  ds_read_b64_tr_b16 a[200:201], v3 offset:8192
  ds_read_b64_tr_b16 a[202:203], v3 offset:9216
  ds_read_b64_tr_b16 a[204:205], v3 offset:8200
  ds_read_b64_tr_b16 a[206:207], v3 offset:9224
  ds_read_b64_tr_b16 a[208:209], v3 offset:16384
  ds_read_b64_tr_b16 a[210:211], v3 offset:17408
  ds_read_b64_tr_b16 a[212:213], v3 offset:16392
  ds_read_b64_tr_b16 a[214:215], v3 offset:17416
  ds_read_b64_tr_b16 a[216:217], v3 offset:24576
  ds_read_b64_tr_b16 a[218:219], v3 offset:25600
  ds_read_b64_tr_b16 a[220:221], v3 offset:24584
  ds_read_b64_tr_b16 a[222:223], v3 offset:25608
  s_waitcnt lgkmcnt(0)
  s_barrier
  s_cmp_lg_u32 s30, 0
  s_cbranch_scc1 w0_17
  v_mov_b32 v10, 64
  s_mov_b32 s32, 0
wf_18:
  buffer_load_dword v11, v10, s[12:15], 0 offen sc1
  s_waitcnt vmcnt(0)
  v_cmp_gt_u32 vcc, 256, v11
  s_cbranch_vccz wfd_19
  s_sleep 4
  s_add_u32 s32, s32, 1
  s_cmp_lt_u32 s32, s31
  s_cbranch_scc1 wf_18
  s_mov_b32 s31, 0
wfd_19:
w0_17:
  s_barrier
  s_lshl_b32 s48, s30, 14
  s_mov_b32 s44, 0
  s_mov_b32 s53, 0
  s_add_u32 s55, s42, 1
  s_mov_b32 s32, 0
wf_21:
  buffer_load_dword v12, v9, s[8:11], 0 offen sc1
  s_waitcnt vmcnt(0)
  v_cmp_gt_u32 vcc, s55, v12
  s_cbranch_vccz wfd_22
  s_sleep 1
  s_add_u32 s32, s32, 1
  s_cmp_lt_u32 s32, s31
  s_cbranch_scc1 wf_21
  s_mov_b32 s31, 0
wfd_22:
  v_cmp_gt_u32 vcc, 64, v12
  s_cbranch_vccnz ic_20
  s_mov_b32 s53, 1
ic_20:
  s_add_u32 m0, s48, 0
  s_add_u32 s56, s46, 0
  buffer_load_dwordx4 v5, s[8:11], s56 offen offset:0 sc1 lds
  buffer_load_dwordx4 v5, s[8:11], s56 offen offset:1024 sc1 lds
  buffer_load_dwordx4 v5, s[8:11], s56 offen offset:2048 sc1 lds
  buffer_load_dwordx4 v5, s[8:11], s56 offen offset:3072 sc1 lds
  s_add_u32 m0, s48, 4096
  s_add_u32 s56, s46, 4096
  buffer_load_dwordx4 v5, s[8:11], s56 offen offset:0 sc1 lds
  buffer_load_dwordx4 v5, s[8:11], s56 offen offset:1024 sc1 lds
  buffer_load_dwordx4 v5, s[8:11], s56 offen offset:2048 sc1 lds
  buffer_load_dwordx4 v5, s[8:11], s56 offen offset:3072 sc1 lds
  s_add_u32 m0, s48, 8192
  s_add_u32 s56, s46, 8192
  buffer_load_dwordx4 v5, s[8:11], s56 offen offset:0 sc1 lds
  buffer_load_dwordx4 v5, s[8:11], s56 offen offset:1024 sc1 lds
  buffer_load_dwordx4 v5, s[8:11], s56 offen offset:2048 sc1 lds
  buffer_load_dwordx4 v5, s[8:11], s56 offen offset:3072 sc1 lds
  s_add_u32 m0, s48, 12288
  s_add_u32 s56, s46, 12288
  buffer_load_dwordx4 v5, s[8:11], s56 offen offset:0 sc1 lds
  buffer_load_dwordx4 v5, s[8:11], s56 offen offset:1024 sc1 lds
  s_waitcnt vmcnt(0)
L_F2_loop:
  s_waitcnt vmcnt(2)
  s_barrier
  s_cmp_lt_u32 s44, 2
  s_cbranch_scc1 nf_23
  s_sub_u32 s34, s44, 1
  s_cmp_lg_u32 s30, 0
  s_cbranch_scc1 w0_24
  s_mov_b64 s[96:97], exec
  s_mov_b64 exec, 1
  v_mov_b32 v10, s52
  v_mov_b32 v11, s34
  buffer_store_dword v11, v10, s[8:11], 0 offen sc1
  s_mov_b64 exec, s[96:97]
w0_24:
nf_23:
  s_add_u32 s46, s46, s47
  s_add_u32 s33, s44, 1
  s_cmp_lt_u32 s33, s45
  s_cselect_b32 s46, s46, 0xf0000000
  s_xor_b32 s48, s48, 0x10000
  s_add_u32 s55, s42, s43
  s_add_u32 s55, s55, 1
  s_min_u32 s55, s55, 64
  s_cmp_lg_u32 s53, 0
  s_cbranch_scc1 ic_25
  s_mov_b32 s32, 0
wf_26:
  buffer_load_dword v12, v9, s[8:11], 0 offen sc1
  s_waitcnt vmcnt(0)
  v_cmp_gt_u32 vcc, s55, v12
  s_cbranch_vccz wfd_27
  s_sleep 1
  s_add_u32 s32, s32, 1
  s_cmp_lt_u32 s32, s31
  s_cbranch_scc1 wf_26
  s_mov_b32 s31, 0
wfd_27:
  v_cmp_gt_u32 vcc, 64, v12
  s_cbranch_vccnz ic_25
  s_mov_b32 s53, 1
ic_25:
  ds_read_b128 v[32:35], v6 offset:0
  ds_read_b128 v[36:39], v6 offset:32768
  ds_read_b128 v[40:43], v7 offset:0
  ds_read_b128 v[44:47], v7 offset:32768
  ds_read_b128 v[48:51], v6 offset:1024
  ds_read_b128 v[52:55], v6 offset:33792
  ds_read_b128 v[56:59], v7 offset:1024
  s_waitcnt lgkmcnt(5)
  v_mfma_f32_16x16x32_bf16 v[16:19], a[0:3], v[32:35], 0
  ds_read_b128 v[60:63], v7 offset:33792
  v_mfma_f32_16x16x32_bf16 v[20:23], a[4:7], v[32:35], 0
  s_add_u32 m0, s48, 0
  s_add_u32 s56, s46, 0
  v_mfma_f32_16x16x32_bf16 v[24:27], a[0:3], v[36:39], 0
  ds_read_b128 v[32:35], v6 offset:2048
  v_mfma_f32_16x16x32_bf16 v[28:31], a[4:7], v[36:39], 0
  buffer_load_dwordx4 v5, s[8:11], s56 offen offset:0 sc1 lds
  s_waitcnt lgkmcnt(5)
  v_mfma_f32_16x16x32_bf16 v[16:19], a[8:11], v[40:43], v[16:19]
  ds_read_b128 v[36:39], v6 offset:34816
  v_mfma_f32_16x16x32_bf16 v[20:23], a[12:15], v[40:43], v[20:23]
  v_mfma_f32_16x16x32_bf16 v[24:27], a[8:11], v[44:47], v[24:27]
  ds_read_b128 v[40:43], v7 offset:2048
  v_mfma_f32_16x16x32_bf16 v[28:31], a[12:15], v[44:47], v[28:31]
  buffer_load_dwordx4 v5, s[8:11], s56 offen offset:1024 sc1 lds
  s_waitcnt lgkmcnt(5)
  v_mfma_f32_16x16x32_bf16 v[16:19], a[16:19], v[48:51], v[16:19]
  ds_read_b128 v[44:47], v7 offset:34816
  v_mfma_f32_16x16x32_bf16 v[20:23], a[20:23], v[48:51], v[20:23]
  v_mfma_f32_16x16x32_bf16 v[24:27], a[16:19], v[52:55], v[24:27]
  ds_read_b128 v[48:51], v6 offset:3072
  v_mfma_f32_16x16x32_bf16 v[28:31], a[20:23], v[52:55], v[28:31]
  buffer_load_dwordx4 v5, s[8:11], s56 offen offset:2048 sc1 lds
  s_waitcnt lgkmcnt(5)
  v_mfma_f32_16x16x32_bf16 v[16:19], a[24:27], v[56:59], v[16:19]
  ds_read_b128 v[52:55], v6 offset:35840
  v_mfma_f32_16x16x32_bf16 v[20:23], a[28:31], v[56:59], v[20:23]
  v_mfma_f32_16x16x32_bf16 v[24:27], a[24:27], v[60:63], v[24:27]
  ds_read_b128 v[56:59], v7 offset:3072
  v_mfma_f32_16x16x32_bf16 v[28:31], a[28:31], v[60:63], v[28:31]
  buffer_load_dwordx4 v5, s[8:11], s56 offen offset:3072 sc1 lds
  s_waitcnt lgkmcnt(5)
  v_mfma_f32_16x16x32_bf16 v[16:19], a[32:35], v[32:35], v[16:19]
  ds_read_b128 v[60:63], v7 offset:35840
  v_mfma_f32_16x16x32_bf16 v[20:23], a[36:39], v[32:35], v[20:23]
  s_add_u32 m0, s48, 4096
  s_add_u32 s56, s46, 4096
  v_mfma_f32_16x16x32_bf16 v[24:27], a[32:35], v[36:39], v[24:27]
  ds_read_b128 v[32:35], v6 offset:4096
  v_mfma_f32_16x16x32_bf16 v[28:31], a[36:39], v[36:39], v[28:31]
  buffer_load_dwordx4 v5, s[8:11], s56 offen offset:0 sc1 lds
  s_waitcnt lgkmcnt(5)
  v_mfma_f32_16x16x32_bf16 v[16:19], a[40:43], v[40:43], v[16:19]
  ds_read_b128 v[36:39], v6 offset:36864
  v_mfma_f32_16x16x32_bf16 v[20:23], a[44:47], v[40:43], v[20:23]
  v_mfma_f32_16x16x32_bf16 v[24:27], a[40:43], v[44:47], v[24:27]
  ds_read_b128 v[40:43], v7 offset:4096
  v_mfma_f32_16x16x32_bf16 v[28:31], a[44:47], v[44:47], v[28:31]
  buffer_load_dwordx4 v5, s[8:11], s56 offen offset:1024 sc1 lds
  s_waitcnt lgkmcnt(5)
  v_mfma_f32_16x16x32_bf16 v[16:19], a[48:51], v[48:51], v[16:19]
  ds_read_b128 v[44:47], v7 offset:36864
  v_mfma_f32_16x16x32_bf16 v[20:23], a[52:55], v[48:51], v[20:23]
  v_mfma_f32_16x16x32_bf16 v[24:27], a[48:51], v[52:55], v[24:27]
  ds_read_b128 v[48:51], v6 offset:5120
  v_mfma_f32_16x16x32_bf16 v[28:31], a[52:55], v[52:55], v[28:31]
  buffer_load_dwordx4 v5, s[8:11], s56 offen offset:2048 sc1 lds
  s_waitcnt lgkmcnt(5)
  v_mfma_f32_16x16x32_bf16 v[16:19], a[56:59], v[56:59], v[16:19]
  ds_read_b128 v[52:55], v6 offset:37888
  v_mfma_f32_16x16x32_bf16 v[20:23], a[60:63], v[56:59], v[20:23]
  v_mfma_f32_16x16x32_bf16 v[24:27], a[56:59], v[60:63], v[24:27]
  ds_read_b128 v[56:59], v7 offset:5120
  v_mfma_f32_16x16x32_bf16 v[28:31], a[60:63], v[60:63], v[28:31]
  buffer_load_dwordx4 v5, s[8:11], s56 offen offset:3072 sc1 lds
  s_waitcnt lgkmcnt(5)
  v_mfma_f32_16x16x32_bf16 v[16:19], a[64:67], v[32:35], v[16:19]
  ds_read_b128 v[60:63], v7 offset:37888
  v_mfma_f32_16x16x32_bf16 v[20:23], a[68:71], v[32:35], v[20:23]
  s_add_u32 m0, s48, 8192
  s_add_u32 s56, s46, 8192
  v_mfma_f32_16x16x32_bf16 v[24:27], a[64:67], v[36:39], v[24:27]
  ds_read_b128 v[32:35], v6 offset:6144
  v_mfma_f32_16x16x32_bf16 v[28:31], a[68:71], v[36:39], v[28:31]
  buffer_load_dwordx4 v5, s[8:11], s56 offen offset:0 sc1 lds
  s_waitcnt lgkmcnt(5)
  v_mfma_f32_16x16x32_bf16 v[16:19], a[72:75], v[40:43], v[16:19]
  ds_read_b128 v[36:39], v6 offset:38912
  v_mfma_f32_16x16x32_bf16 v[20:23], a[76:79], v[40:43], v[20:23]
  v_mfma_f32_16x16x32_bf16 v[24:27], a[72:75], v[44:47], v[24:27]
  ds_read_b128 v[40:43], v7 offset:6144
  v_mfma_f32_16x16x32_bf16 v[28:31], a[76:79], v[44:47], v[28:31]
  buffer_load_dwordx4 v5, s[8:11], s56 offen offset:1024 sc1 lds
  s_waitcnt lgkmcnt(5)
  v_mfma_f32_16x16x32_bf16 v[16:19], a[80:83], v[48:51], v[16:19]
  ds_read_b128 v[44:47], v7 offset:38912
  v_mfma_f32_16x16x32_bf16 v[20:23], a[84:87], v[48:51], v[20:23]
  v_mfma_f32_16x16x32_bf16 v[24:27], a[80:83], v[52:55], v[24:27]
  ds_read_b128 v[48:51], v6 offset:7168
  v_mfma_f32_16x16x32_bf16 v[28:31], a[84:87], v[52:55], v[28:31]
  buffer_load_dwordx4 v5, s[8:11], s56 offen offset:2048 sc1 lds
  s_waitcnt lgkmcnt(5)
  v_mfma_f32_16x16x32_bf16 v[16:19], a[88:91], v[56:59], v[16:19]
  ds_read_b128 v[52:55], v6 offset:39936
  v_mfma_f32_16x16x32_bf16 v[20:23], a[92:95], v[56:59], v[20:23]
  v_mfma_f32_16x16x32_bf16 v[24:27], a[88:91], v[60:63], v[24:27]
  ds_read_b128 v[56:59], v7 offset:7168
  v_mfma_f32_16x16x32_bf16 v[28:31], a[92:95], v[60:63], v[28:31]
  buffer_load_dwordx4 v5, s[8:11], s56 offen offset:3072 sc1 lds
  s_waitcnt lgkmcnt(5)
  v_mfma_f32_16x16x32_bf16 v[16:19], a[96:99], v[32:35], v[16:19]
  ds_read_b128 v[60:63], v7 offset:39936
  v_mfma_f32_16x16x32_bf16 v[20:23], a[100:103], v[32:35], v[20:23]
  s_add_u32 m0, s48, 12288
  s_add_u32 s56, s46, 12288
  v_mfma_f32_16x16x32_bf16 v[24:27], a[96:99], v[36:39], v[24:27]
  ds_read_b128 v[32:35], v6 offset:8192
  v_mfma_f32_16x16x32_bf16 v[28:31], a[100:103], v[36:39], v[28:31]
  buffer_load_dwordx4 v5, s[8:11], s56 offen offset:0 sc1 lds
  s_waitcnt lgkmcnt(5)
  v_mfma_f32_16x16x32_bf16 v[16:19], a[104:107], v[40:43], v[16:19]
  ds_read_b128 v[36:39], v6 offset:40960
  v_mfma_f32_16x16x32_bf16 v[20:23], a[108:111], v[40:43], v[20:23]
  v_mfma_f32_16x16x32_bf16 v[24:27], a[104:107], v[44:47], v[24:27]
  ds_read_b128 v[40:43], v7 offset:8192
  v_mfma_f32_16x16x32_bf16 v[28:31], a[108:111], v[44:47], v[28:31]
  buffer_load_dwordx4 v5, s[8:11], s56 offen offset:1024 sc1 lds
  s_waitcnt lgkmcnt(5)
  v_mfma_f32_16x16x32_bf16 v[16:19], a[112:115], v[48:51], v[16:19]
  ds_read_b128 v[44:47], v7 offset:40960
  v_mfma_f32_16x16x32_bf16 v[20:23], a[116:119], v[48:51], v[20:23]
  v_mfma_f32_16x16x32_bf16 v[24:27], a[112:115], v[52:55], v[24:27]
  ds_read_b128 v[48:51], v6 offset:9216
  v_mfma_f32_16x16x32_bf16 v[28:31], a[116:119], v[52:55], v[28:31]
  s_waitcnt lgkmcnt(5)
  v_mfma_f32_16x16x32_bf16 v[16:19], a[120:123], v[56:59], v[16:19]
  ds_read_b128 v[52:55], v6 offset:41984
  v_mfma_f32_16x16x32_bf16 v[20:23], a[124:127], v[56:59], v[20:23]
  v_mfma_f32_16x16x32_bf16 v[24:27], a[120:123], v[60:63], v[24:27]
  ds_read_b128 v[56:59], v7 offset:9216
  v_mfma_f32_16x16x32_bf16 v[28:31], a[124:127], v[60:63], v[28:31]
  s_waitcnt lgkmcnt(5)
  v_mfma_f32_16x16x32_bf16 v[16:19], a[128:131], v[32:35], v[16:19]
  ds_read_b128 v[60:63], v7 offset:41984
  v_mfma_f32_16x16x32_bf16 v[20:23], a[132:135], v[32:35], v[20:23]
  v_mfma_f32_16x16x32_bf16 v[24:27], a[128:131], v[36:39], v[24:27]
  ds_read_b128 v[32:35], v6 offset:10240
  v_mfma_f32_16x16x32_bf16 v[28:31], a[132:135], v[36:39], v[28:31]
  s_waitcnt lgkmcnt(5)
  v_mfma_f32_16x16x32_bf16 v[16:19], a[136:139], v[40:43], v[16:19]
  ds_read_b128 v[36:39], v6 offset:43008
  v_mfma_f32_16x16x32_bf16 v[20:23], a[140:143], v[40:43], v[20:23]
  v_mfma_f32_16x16x32_bf16 v[24:27], a[136:139], v[44:47], v[24:27]
  ds_read_b128 v[40:43], v7 offset:10240
  v_mfma_f32_16x16x32_bf16 v[28:31], a[140:143], v[44:47], v[28:31]
  s_waitcnt lgkmcnt(5)
  v_mfma_f32_16x16x32_bf16 v[16:19], a[144:147], v[48:51], v[16:19]
  ds_read_b128 v[44:47], v7 offset:43008
  v_mfma_f32_16x16x32_bf16 v[20:23], a[148:151], v[48:51], v[20:23]
  v_mfma_f32_16x16x32_bf16 v[24:27], a[144:147], v[52:55], v[24:27]
  ds_read_b128 v[48:51], v6 offset:11264
  v_mfma_f32_16x16x32_bf16 v[28:31], a[148:151], v[52:55], v[28:31]
  s_waitcnt lgkmcnt(5)
  v_mfma_f32_16x16x32_bf16 v[16:19], a[152:155], v[56:59], v[16:19]
  ds_read_b128 v[52:55], v6 offset:44032
  v_mfma_f32_16x16x32_bf16 v[20:23], a[156:159], v[56:59], v[20:23]
  v_mfma_f32_16x16x32_bf16 v[24:27], a[152:155], v[60:63], v[24:27]
  ds_read_b128 v[56:59], v7 offset:11264
  v_mfma_f32_16x16x32_bf16 v[28:31], a[156:159], v[60:63], v[28:31]
  s_waitcnt lgkmcnt(5)
  v_mfma_f32_16x16x32_bf16 v[16:19], a[160:163], v[32:35], v[16:19]
  ds_read_b128 v[60:63], v7 offset:44032
  v_mfma_f32_16x16x32_bf16 v[20:23], a[164:167], v[32:35], v[20:23]
  v_mfma_f32_16x16x32_bf16 v[24:27], a[160:163], v[36:39], v[24:27]
  ds_read_b128 v[32:35], v6 offset:12288
  v_mfma_f32_16x16x32_bf16 v[28:31], a[164:167], v[36:39], v[28:31]
  s_waitcnt lgkmcnt(5)
  v_mfma_f32_16x16x32_bf16 v[16:19], a[168:171], v[40:43], v[16:19]
  ds_read_b128 v[36:39], v6 offset:45056
  v_mfma_f32_16x16x32_bf16 v[20:23], a[172:175], v[40:43], v[20:23]
  v_mfma_f32_16x16x32_bf16 v[24:27], a[168:171], v[44:47], v[24:27]
  ds_read_b128 v[40:43], v7 offset:12288
  v_mfma_f32_16x16x32_bf16 v[28:31], a[172:175], v[44:47], v[28:31]
  s_waitcnt lgkmcnt(5)
  v_mfma_f32_16x16x32_bf16 v[16:19], a[176:179], v[48:51], v[16:19]
  ds_read_b128 v[44:47], v7 offset:45056
  v_mfma_f32_16x16x32_bf16 v[20:23], a[180:183], v[48:51], v[20:23]
  v_mfma_f32_16x16x32_bf16 v[24:27], a[176:179], v[52:55], v[24:27]
  ds_read_b128 v[48:51], v6 offset:13312
  v_mfma_f32_16x16x32_bf16 v[28:31], a[180:183], v[52:55], v[28:31]
  s_waitcnt lgkmcnt(5)
  v_mfma_f32_16x16x32_bf16 v[16:19], a[184:187], v[56:59], v[16:19]
  ds_read_b128 v[52:55], v6 offset:46080
  v_mfma_f32_16x16x32_bf16 v[20:23], a[188:191], v[56:59], v[20:23]
  v_mfma_f32_16x16x32_bf16 v[24:27], a[184:187], v[60:63], v[24:27]
  ds_read_b128 v[56:59], v7 offset:13312
  v_mfma_f32_16x16x32_bf16 v[28:31], a[188:191], v[60:63], v[28:31]
  s_waitcnt lgkmcnt(5)
  v_mfma_f32_16x16x32_bf16 v[16:19], a[192:195], v[32:35], v[16:19]
  ds_read_b128 v[60:63], v7 offset:46080
  v_mfma_f32_16x16x32_bf16 v[20:23], a[196:199], v[32:35], v[20:23]
  v_mfma_f32_16x16x32_bf16 v[24:27], a[192:195], v[36:39], v[24:27]
  v_mfma_f32_16x16x32_bf16 v[28:31], a[196:199], v[36:39], v[28:31]
  s_waitcnt lgkmcnt(4)
  v_mfma_f32_16x16x32_bf16 v[16:19], a[200:203], v[40:43], v[16:19]
  v_mfma_f32_16x16x32_bf16 v[20:23], a[204:207], v[40:43], v[20:23]
  v_mfma_f32_16x16x32_bf16 v[24:27], a[200:203], v[44:47], v[24:27]
  v_mfma_f32_16x16x32_bf16 v[28:31], a[204:207], v[44:47], v[28:31]
  s_waitcnt lgkmcnt(2)
  v_mfma_f32_16x16x32_bf16 v[16:19], a[208:211], v[48:51], v[16:19]
  v_mfma_f32_16x16x32_bf16 v[20:23], a[212:215], v[48:51], v[20:23]
  v_mfma_f32_16x16x32_bf16 v[24:27], a[208:211], v[52:55], v[24:27]
  v_mfma_f32_16x16x32_bf16 v[28:31], a[212:215], v[52:55], v[28:31]
  s_waitcnt lgkmcnt(0)
  v_mfma_f32_16x16x32_bf16 v[16:19], a[216:219], v[56:59], v[16:19]
  v_mfma_f32_16x16x32_bf16 v[20:23], a[220:223], v[56:59], v[20:23]
  v_mfma_f32_16x16x32_bf16 v[24:27], a[216:219], v[60:63], v[24:27]
  v_mfma_f32_16x16x32_bf16 v[28:31], a[220:223], v[60:63], v[28:31]
  s_nop 4
  v_cvt_pk_bf16_f32 v64, v16, v17
  v_cvt_pk_bf16_f32 v65, v18, v19
  v_cvt_pk_bf16_f32 v66, v20, v21
  v_cvt_pk_bf16_f32 v67, v22, v23
  buffer_store_dwordx4 v[64:67], v8, s[8:11], s49 offen sc1
  v_cvt_pk_bf16_f32 v68, v24, v25
  v_cvt_pk_bf16_f32 v69, v26, v27
  v_cvt_pk_bf16_f32 v70, v28, v29
  v_cvt_pk_bf16_f32 v71, v30, v31
  s_add_u32 s54, s49, s50
  buffer_store_dwordx4 v[68:71], v8, s[8:11], s54 offen sc1
  v_xor_b32 v6, 0x10000, v6
  v_xor_b32 v7, 0x10000, v7
  s_add_u32 s49, s49, s51
  s_add_u32 s42, s42, s43
  s_add_u32 s44, s44, 1
  s_cmp_lt_u32 s44, s45
  s_cbranch_scc1 L_F2_loop
  s_waitcnt vmcnt(0)
  s_barrier
  s_cmp_lg_u32 s30, 0
  s_cbranch_scc1 w0_28
  s_mov_b64 s[96:97], exec
  s_mov_b64 exec, 1
  v_mov_b32 v10, s52
  v_mov_b32 v11, s45
  buffer_store_dword v11, v10, s[8:11], 0 offen sc1
  s_mov_b64 exec, s[96:97]
w0_28:
  s_cmp_eq_u32 s38, 0
  s_cbranch_scc1 L_role_WO2
  s_endpgm
L_role_Q:
  s_load_dwordx2 s[4:5], s[0:1], 0
  s_waitcnt lgkmcnt(0)
  s_mov_b32 s16, s4
  s_mov_b32 s17, s5
  s_mov_b32 s18, 4194304
  s_mov_b32 s19, 0x20000
  s_load_dwordx2 s[4:5], s[0:1], 16
  s_waitcnt lgkmcnt(0)
  s_mov_b32 s20, s4
  s_mov_b32 s21, s5
  s_mov_b32 s22, 8388608
  s_mov_b32 s23, 0x20000
  s_cmp_lg_u32 s30, 0
  s_cbranch_scc1 w0_29
  s_lshl_b32 s33, s29, 7
  s_add_u32 s33, s33, 40960
  s_mov_b64 s[96:97], exec
  s_mov_b64 exec, 1
  v_mov_b32 v10, s33
  v_mov_b32 v11, 0
  buffer_store_dword v11, v10, s[8:11], 0 offen sc1
  s_mov_b64 exec, s[96:97]
w0_29:
  s_lshl_b32 s52, s29, 7
  s_add_u32 s52, s52, 40960
  s_mov_b32 s41, 32768
  s_lshl_b32 s33, s29, 13
  s_lshl_b32 s34, s30, 10
  s_add_u32 s49, s33, s34
  s_add_u32 s49, s49, 16777216
  s_mov_b32 s50, 4096
  v_lshrrev_b32 v10, 4, v1
  v_and_b32 v11, 15, v1
  s_lshr_b32 s33, s41, 2
  v_mul_lo_u32 v2, v10, s33
  v_lshlrev_b32 v12, 2, v10
  v_xor_b32 v12, v12, v11
  v_lshl_add_u32 v2, v12, 4, v2
  v_bfe_u32 v12, v1, 2, 2
  v_lshl_add_u32 v13, v10, 3, v12
  v_lshlrev_b32 v3, 8, v13
  v_and_b32 v13, 3, v1
  s_lshl_b32 s33, s30, 2
  v_add_u32 v13, s33, v13
  v_lshlrev_b32 v12, 2, v12
  v_xor_b32 v13, v13, v12
  v_lshl_add_u32 v3, v13, 4, v3
  v_add_u32 v4, 0x10000, v3
  v_lshlrev_b32 v8, 4, v1
  v_lshrrev_b32 v12, 3, v1
  v_and_b32 v13, 7, v1
  v_xor_b32 v13, v13, v12
  v_lshlrev_b32 v5, 11, v12
  v_lshl_add_u32 v5, v13, 4, v5
  v_and_b32 v12, 7, v1
  v_bfe_u32 v13, v1, 3, 1
  v_lshlrev_b32 v6, 14, v13
  v_lshl_add_u32 v6, v12, 7, v6
  v_xor_b32 v13, v10, v12
  v_lshl_add_u32 v6, v13, 4, v6
  v_xor_b32 v7, 64, v6
  s_lshl_b32 s40, s29, 8
  s_waitcnt vmcnt(0)
  s_barrier
  s_cmp_lg_u32 s30, 0
  s_cbranch_scc1 ar_30
  s_mov_b64 s[96:97], exec
  s_mov_b64 exec, 1
  v_mov_b32 v10, 64
  v_mov_b32 v11, 1
  buffer_atomic_add v11, v10, s[12:15], 0 offen
  s_mov_b64 exec, s[96:97]
ar_30:
  s_cmp_lg_u32 s30, 0
  s_cbranch_scc1 w0_32
  v_mov_b32 v10, 64
  s_mov_b32 s32, 0
wf_33:
  buffer_load_dword v11, v10, s[12:15], 0 offen sc1
  s_waitcnt vmcnt(0)
  v_cmp_gt_u32 vcc, 256, v11
  s_cbranch_vccz wfd_34
  s_sleep 24
  s_add_u32 s32, s32, 1
  s_cmp_lt_u32 s32, s31
  s_cbranch_scc1 wf_33
  s_mov_b32 s31, 0
wfd_34:
w0_32:
  s_barrier
  s_lshl_b32 s33, s41, 3
  s_mul_i32 s33, s33, s30
  s_add_u32 s40, s40, s33
  s_mul_i32 s34, s41, 24
  s_lshl_b32 s35, s30, 13
  v_add_u32 v13, s35, v8
  buffer_load_dwordx4 a[0:3], v2, s[20:23], s40 offen nt
  s_add_u32 s40, s40, s41
  buffer_load_dwordx4 a[4:7], v2, s[20:23], s40 offen nt
  s_add_u32 s40, s40, s41
  buffer_load_dwordx4 a[8:11], v2, s[20:23], s40 offen nt
  s_add_u32 s40, s40, s41
  buffer_load_dwordx4 a[12:15], v2, s[20:23], s40 offen nt
  s_add_u32 s40, s40, s41
  buffer_load_dwordx4 a[16:19], v2, s[20:23], s40 offen nt
  s_add_u32 s40, s40, s41
  buffer_load_dwordx4 a[20:23], v2, s[20:23], s40 offen nt
  s_add_u32 s40, s40, s41
  buffer_load_dwordx4 a[24:27], v2, s[20:23], s40 offen nt
  s_add_u32 s40, s40, s41
  buffer_load_dwordx4 a[28:31], v2, s[20:23], s40 offen nt
  s_add_u32 s40, s40, s41
  s_add_u32 s40, s40, s34
  buffer_load_dwordx4 a[32:35], v2, s[20:23], s40 offen nt
  s_add_u32 s40, s40, s41
  buffer_load_dwordx4 a[36:39], v2, s[20:23], s40 offen nt
  s_add_u32 s40, s40, s41
  buffer_load_dwordx4 a[40:43], v2, s[20:23], s40 offen nt
  s_add_u32 s40, s40, s41
  buffer_load_dwordx4 a[44:47], v2, s[20:23], s40 offen nt
  s_add_u32 s40, s40, s41
  buffer_load_dwordx4 a[48:51], v2, s[20:23], s40 offen nt
  s_add_u32 s40, s40, s41
  buffer_load_dwordx4 a[52:55], v2, s[20:23], s40 offen nt
  s_add_u32 s40, s40, s41
  buffer_load_dwordx4 a[56:59], v2, s[20:23], s40 offen nt
  s_add_u32 s40, s40, s41
  buffer_load_dwordx4 a[60:63], v2, s[20:23], s40 offen nt
  s_add_u32 s40, s40, s41
  s_add_u32 s40, s40, s34
  buffer_load_dwordx4 a[64:67], v2, s[20:23], s40 offen nt
  s_add_u32 s40, s40, s41
  buffer_load_dwordx4 a[68:71], v2, s[20:23], s40 offen nt
  s_add_u32 s40, s40, s41
  buffer_load_dwordx4 a[72:75], v2, s[20:23], s40 offen nt
  s_add_u32 s40, s40, s41
  buffer_load_dwordx4 a[76:79], v2, s[20:23], s40 offen nt
  s_add_u32 s40, s40, s41
  buffer_load_dwordx4 a[80:83], v2, s[20:23], s40 offen nt
  s_add_u32 s40, s40, s41
  buffer_load_dwordx4 a[84:87], v2, s[20:23], s40 offen nt
  s_add_u32 s40, s40, s41
  buffer_load_dwordx4 a[88:91], v2, s[20:23], s40 offen nt
  s_add_u32 s40, s40, s41
  buffer_load_dwordx4 a[92:95], v2, s[20:23], s40 offen nt
  s_add_u32 s40, s40, s41
  s_add_u32 s40, s40, s34
  buffer_load_dwordx4 a[96:99], v2, s[20:23], s40 offen nt
  s_add_u32 s40, s40, s41
  buffer_load_dwordx4 a[100:103], v2, s[20:23], s40 offen nt
  s_add_u32 s40, s40, s41
  buffer_load_dwordx4 a[104:107], v2, s[20:23], s40 offen nt
  s_add_u32 s40, s40, s41
  buffer_load_dwordx4 a[108:111], v2, s[20:23], s40 offen nt
  s_add_u32 s40, s40, s41
  buffer_load_dwordx4 a[112:115], v2, s[20:23], s40 offen nt
  s_add_u32 s40, s40, s41
  buffer_load_dwordx4 a[116:119], v2, s[20:23], s40 offen nt
  s_add_u32 s40, s40, s41
  buffer_load_dwordx4 a[120:123], v2, s[20:23], s40 offen nt
  s_add_u32 s40, s40, s41
  buffer_load_dwordx4 a[124:127], v2, s[20:23], s40 offen nt
  s_add_u32 s40, s40, s41
  s_add_u32 s40, s40, s34
  buffer_load_dwordx4 a[128:131], v2, s[20:23], s40 offen nt
  s_add_u32 s40, s40, s41
  buffer_load_dwordx4 a[132:135], v2, s[20:23], s40 offen nt
  s_add_u32 s40, s40, s41
  buffer_load_dwordx4 a[136:139], v2, s[20:23], s40 offen nt
  s_add_u32 s40, s40, s41
  buffer_load_dwordx4 a[140:143], v2, s[20:23], s40 offen nt
  s_add_u32 s40, s40, s41
  buffer_load_dwordx4 a[144:147], v2, s[20:23], s40 offen nt
  s_add_u32 s40, s40, s41
  buffer_load_dwordx4 a[148:151], v2, s[20:23], s40 offen nt
  s_add_u32 s40, s40, s41
  buffer_load_dwordx4 a[152:155], v2, s[20:23], s40 offen nt
  s_add_u32 s40, s40, s41
  buffer_load_dwordx4 a[156:159], v2, s[20:23], s40 offen nt
  s_add_u32 s40, s40, s41
  s_add_u32 s40, s40, s34
  buffer_load_dwordx4 a[160:163], v2, s[20:23], s40 offen nt
  s_add_u32 s40, s40, s41
  buffer_load_dwordx4 a[164:167], v2, s[20:23], s40 offen nt
  s_add_u32 s40, s40, s41
  buffer_load_dwordx4 a[168:171], v2, s[20:23], s40 offen nt
  s_add_u32 s40, s40, s41
  buffer_load_dwordx4 a[172:175], v2, s[20:23], s40 offen nt
  s_add_u32 s40, s40, s41
  buffer_load_dwordx4 a[176:179], v2, s[20:23], s40 offen nt
  s_add_u32 s40, s40, s41
  buffer_load_dwordx4 a[180:183], v2, s[20:23], s40 offen nt
  s_add_u32 s40, s40, s41
  buffer_load_dwordx4 a[184:187], v2, s[20:23], s40 offen nt
  s_add_u32 s40, s40, s41
  buffer_load_dwordx4 a[188:191], v2, s[20:23], s40 offen nt
  s_add_u32 s40, s40, s41
  s_add_u32 s40, s40, s34
  buffer_load_dwordx4 a[192:195], v2, s[20:23], s40 offen nt
  s_add_u32 s40, s40, s41
  buffer_load_dwordx4 a[196:199], v2, s[20:23], s40 offen nt
  s_add_u32 s40, s40, s41
  buffer_load_dwordx4 a[200:203], v2, s[20:23], s40 offen nt
  s_add_u32 s40, s40, s41
  buffer_load_dwordx4 a[204:207], v2, s[20:23], s40 offen nt
  s_add_u32 s40, s40, s41
  buffer_load_dwordx4 a[208:211], v2, s[20:23], s40 offen nt
  s_add_u32 s40, s40, s41
  buffer_load_dwordx4 a[212:215], v2, s[20:23], s40 offen nt
  s_add_u32 s40, s40, s41
  buffer_load_dwordx4 a[216:219], v2, s[20:23], s40 offen nt
  s_add_u32 s40, s40, s41
  buffer_load_dwordx4 a[220:223], v2, s[20:23], s40 offen nt
  s_add_u32 s40, s40, s41
  s_add_u32 s40, s40, s34
  s_waitcnt vmcnt(48)
  ds_write_b128 v13, a[0:3] offset:0
  ds_write_b128 v13, a[4:7] offset:1024
  ds_write_b128 v13, a[8:11] offset:2048
  ds_write_b128 v13, a[12:15] offset:3072
  ds_write_b128 v13, a[16:19] offset:4096
  ds_write_b128 v13, a[20:23] offset:5120
  ds_write_b128 v13, a[24:27] offset:6144
  ds_write_b128 v13, a[28:31] offset:7168
  s_waitcnt lgkmcnt(0)
  s_barrier
  ds_read_b64_tr_b16 a[0:1], v3 offset:0
  ds_read_b64_tr_b16 a[2:3], v3 offset:1024
  ds_read_b64_tr_b16 a[4:5], v3 offset:8
  ds_read_b64_tr_b16 a[6:7], v3 offset:1032
  ds_read_b64_tr_b16 a[8:9], v3 offset:8192
  ds_read_b64_tr_b16 a[10:11], v3 offset:9216
  ds_read_b64_tr_b16 a[12:13], v3 offset:8200
  ds_read_b64_tr_b16 a[14:15], v3 offset:9224
  ds_read_b64_tr_b16 a[16:17], v3 offset:16384
  ds_read_b64_tr_b16 a[18:19], v3 offset:17408
  ds_read_b64_tr_b16 a[20:21], v3 offset:16392
  ds_read_b64_tr_b16 a[22:23], v3 offset:17416
  ds_read_b64_tr_b16 a[24:25], v3 offset:24576
  ds_read_b64_tr_b16 a[26:27], v3 offset:25600
  ds_read_b64_tr_b16 a[28:29], v3 offset:24584
  ds_read_b64_tr_b16 a[30:31], v3 offset:25608
  s_waitcnt lgkmcnt(0)
  buffer_load_dwordx4 a[224:227], v2, s[20:23], s40 offen nt
  s_add_u32 s40, s40, s41
  buffer_load_dwordx4 a[228:231], v2, s[20:23], s40 offen nt
  s_add_u32 s40, s40, s41
  buffer_load_dwordx4 a[232:235], v2, s[20:23], s40 offen nt
  s_add_u32 s40, s40, s41
  buffer_load_dwordx4 a[236:239], v2, s[20:23], s40 offen nt
  s_add_u32 s40, s40, s41
  buffer_load_dwordx4 a[240:243], v2, s[20:23], s40 offen nt
  s_add_u32 s40, s40, s41
  buffer_load_dwordx4 a[244:247], v2, s[20:23], s40 offen nt
  s_add_u32 s40, s40, s41
  buffer_load_dwordx4 a[248:251], v2, s[20:23], s40 offen nt
  s_add_u32 s40, s40, s41
  buffer_load_dwordx4 a[252:255], v2, s[20:23], s40 offen nt
  s_add_u32 s40, s40, s41
  s_add_u32 s40, s40, s34
  s_waitcnt vmcnt(48)
  ds_write_b128 v13, a[32:35] offset:32768
  ds_write_b128 v13, a[36:39] offset:33792
  ds_write_b128 v13, a[40:43] offset:34816
  ds_write_b128 v13, a[44:47] offset:35840
  ds_write_b128 v13, a[48:51] offset:36864
  ds_write_b128 v13, a[52:55] offset:37888
  ds_write_b128 v13, a[56:59] offset:38912
  ds_write_b128 v13, a[60:63] offset:39936
  s_waitcnt lgkmcnt(0)
  s_barrier
  ds_read_b64_tr_b16 a[32:33], v3 offset:32768
  ds_read_b64_tr_b16 a[34:35], v3 offset:33792
  ds_read_b64_tr_b16 a[36:37], v3 offset:32776
  ds_read_b64_tr_b16 a[38:39], v3 offset:33800
  ds_read_b64_tr_b16 a[40:41], v3 offset:40960
  ds_read_b64_tr_b16 a[42:43], v3 offset:41984
  ds_read_b64_tr_b16 a[44:45], v3 offset:40968
  ds_read_b64_tr_b16 a[46:47], v3 offset:41992
  ds_read_b64_tr_b16 a[48:49], v3 offset:49152
  ds_read_b64_tr_b16 a[50:51], v3 offset:50176
  ds_read_b64_tr_b16 a[52:53], v3 offset:49160
  ds_read_b64_tr_b16 a[54:55], v3 offset:50184
  ds_read_b64_tr_b16 a[56:57], v3 offset:57344
  ds_read_b64_tr_b16 a[58:59], v3 offset:58368
  ds_read_b64_tr_b16 a[60:61], v3 offset:57352
  ds_read_b64_tr_b16 a[62:63], v3 offset:58376
  s_waitcnt lgkmcnt(0)
  s_waitcnt vmcnt(40)
  ds_write_b128 v13, a[64:67] offset:0
  ds_write_b128 v13, a[68:71] offset:1024
  ds_write_b128 v13, a[72:75] offset:2048
  ds_write_b128 v13, a[76:79] offset:3072
  ds_write_b128 v13, a[80:83] offset:4096
  ds_write_b128 v13, a[84:87] offset:5120
  ds_write_b128 v13, a[88:91] offset:6144
  ds_write_b128 v13, a[92:95] offset:7168
  s_waitcnt lgkmcnt(0)
  s_barrier
  ds_read_b64_tr_b16 a[64:65], v3 offset:0
  ds_read_b64_tr_b16 a[66:67], v3 offset:1024
  ds_read_b64_tr_b16 a[68:69], v3 offset:8
  ds_read_b64_tr_b16 a[70:71], v3 offset:1032
  ds_read_b64_tr_b16 a[72:73], v3 offset:8192
  ds_read_b64_tr_b16 a[74:75], v3 offset:9216
  ds_read_b64_tr_b16 a[76:77], v3 offset:8200
  ds_read_b64_tr_b16 a[78:79], v3 offset:9224
  ds_read_b64_tr_b16 a[80:81], v3 offset:16384
  ds_read_b64_tr_b16 a[82:83], v3 offset:17408
  ds_read_b64_tr_b16 a[84:85], v3 offset:16392
  ds_read_b64_tr_b16 a[86:87], v3 offset:17416
  ds_read_b64_tr_b16 a[88:89], v3 offset:24576
  ds_read_b64_tr_b16 a[90:91], v3 offset:25600
  ds_read_b64_tr_b16 a[92:93], v3 offset:24584
  ds_read_b64_tr_b16 a[94:95], v3 offset:25608
  s_waitcnt lgkmcnt(0)
  s_waitcnt vmcnt(32)
  ds_write_b128 v13, a[96:99] offset:32768
  ds_write_b128 v13, a[100:103] offset:33792
  ds_write_b128 v13, a[104:107] offset:34816
  ds_write_b128 v13, a[108:111] offset:35840
  ds_write_b128 v13, a[112:115] offset:36864
  ds_write_b128 v13, a[116:119] offset:37888
  ds_write_b128 v13, a[120:123] offset:38912
  ds_write_b128 v13, a[124:127] offset:39936
  s_waitcnt lgkmcnt(0)
  s_barrier
  ds_read_b64_tr_b16 a[96:97], v3 offset:32768
  ds_read_b64_tr_b16 a[98:99], v3 offset:33792
  ds_read_b64_tr_b16 a[100:101], v3 offset:32776
  ds_read_b64_tr_b16 a[102:103], v3 offset:33800
  ds_read_b64_tr_b16 a[104:105], v3 offset:40960
  ds_read_b64_tr_b16 a[106:107], v3 offset:41984
  ds_read_b64_tr_b16 a[108:109], v3 offset:40968
  ds_read_b64_tr_b16 a[110:111], v3 offset:41992
  ds_read_b64_tr_b16 a[112:113], v3 offset:49152
  ds_read_b64_tr_b16 a[114:115], v3 offset:50176
  ds_read_b64_tr_b16 a[116:117], v3 offset:49160
  ds_read_b64_tr_b16 a[118:119], v3 offset:50184
  ds_read_b64_tr_b16 a[120:121], v3 offset:57344
  ds_read_b64_tr_b16 a[122:123], v3 offset:58368
  ds_read_b64_tr_b16 a[124:125], v3 offset:57352
  ds_read_b64_tr_b16 a[126:127], v3 offset:58376
  s_waitcnt lgkmcnt(0)
  s_waitcnt vmcnt(24)
  ds_write_b128 v13, a[128:131] offset:0
  ds_write_b128 v13, a[132:135] offset:1024
  ds_write_b128 v13, a[136:139] offset:2048
  ds_write_b128 v13, a[140:143] offset:3072
  ds_write_b128 v13, a[144:147] offset:4096
  ds_write_b128 v13, a[148:151] offset:5120
  ds_write_b128 v13, a[152:155] offset:6144
  ds_write_b128 v13, a[156:159] offset:7168
  s_waitcnt lgkmcnt(0)
  s_barrier
  ds_read_b64_tr_b16 a[128:129], v3 offset:0
  ds_read_b64_tr_b16 a[130:131], v3 offset:1024
  ds_read_b64_tr_b16 a[132:133], v3 offset:8
  ds_read_b64_tr_b16 a[134:135], v3 offset:1032
  ds_read_b64_tr_b16 a[136:137], v3 offset:8192
  ds_read_b64_tr_b16 a[138:139], v3 offset:9216
  ds_read_b64_tr_b16 a[140:141], v3 offset:8200
  ds_read_b64_tr_b16 a[142:143], v3 offset:9224
  ds_read_b64_tr_b16 a[144:145], v3 offset:16384
  ds_read_b64_tr_b16 a[146:147], v3 offset:17408
  ds_read_b64_tr_b16 a[148:149], v3 offset:16392
  ds_read_b64_tr_b16 a[150:151], v3 offset:17416
  ds_read_b64_tr_b16 a[152:153], v3 offset:24576
  ds_read_b64_tr_b16 a[154:155], v3 offset:25600
  ds_read_b64_tr_b16 a[156:157], v3 offset:24584
  ds_read_b64_tr_b16 a[158:159], v3 offset:25608
  s_waitcnt lgkmcnt(0)
  s_waitcnt vmcnt(16)
  ds_write_b128 v13, a[160:163] offset:32768
  ds_write_b128 v13, a[164:167] offset:33792
  ds_write_b128 v13, a[168:171] offset:34816
  ds_write_b128 v13, a[172:175] offset:35840
  ds_write_b128 v13, a[176:179] offset:36864
  ds_write_b128 v13, a[180:183] offset:37888
  ds_write_b128 v13, a[184:187] offset:38912
  ds_write_b128 v13, a[188:191] offset:39936
  s_waitcnt lgkmcnt(0)
  s_barrier
  ds_read_b64_tr_b16 a[160:161], v3 offset:32768
  ds_read_b64_tr_b16 a[162:163], v3 offset:33792
  ds_read_b64_tr_b16 a[164:165], v3 offset:32776
  ds_read_b64_tr_b16 a[166:167], v3 offset:33800
  ds_read_b64_tr_b16 a[168:169], v3 offset:40960
  ds_read_b64_tr_b16 a[170:171], v3 offset:41984
  ds_read_b64_tr_b16 a[172:173], v3 offset:40968
  ds_read_b64_tr_b16 a[174:175], v3 offset:41992
  ds_read_b64_tr_b16 a[176:177], v3 offset:49152
  ds_read_b64_tr_b16 a[178:179], v3 offset:50176
  ds_read_b64_tr_b16 a[180:181], v3 offset:49160
  ds_read_b64_tr_b16 a[182:183], v3 offset:50184
  ds_read_b64_tr_b16 a[184:185], v3 offset:57344
  ds_read_b64_tr_b16 a[186:187], v3 offset:58368
  ds_read_b64_tr_b16 a[188:189], v3 offset:57352
  ds_read_b64_tr_b16 a[190:191], v3 offset:58376
  s_waitcnt lgkmcnt(0)
  s_waitcnt vmcnt(8)
  ds_write_b128 v13, a[192:195] offset:0
  ds_write_b128 v13, a[196:199] offset:1024
  ds_write_b128 v13, a[200:203] offset:2048
  ds_write_b128 v13, a[204:207] offset:3072
  ds_write_b128 v13, a[208:211] offset:4096
  ds_write_b128 v13, a[212:215] offset:5120
  ds_write_b128 v13, a[216:219] offset:6144
  ds_write_b128 v13, a[220:223] offset:7168
  s_waitcnt lgkmcnt(0)
  s_barrier
  ds_read_b64_tr_b16 a[192:193], v3 offset:0
  ds_read_b64_tr_b16 a[194:195], v3 offset:1024
  ds_read_b64_tr_b16 a[196:197], v3 offset:8
  ds_read_b64_tr_b16 a[198:199], v3 offset:1032
  ds_read_b64_tr_b16 a[200:201], v3 offset:8192
  ds_read_b64_tr_b16 a[202:203], v3 offset:9216
  ds_read_b64_tr_b16 a[204:205], v3 offset:8200
  ds_read_b64_tr_b16 a[206:207], v3 offset:9224
  ds_read_b64_tr_b16 a[208:209], v3 offset:16384
  ds_read_b64_tr_b16 a[210:211], v3 offset:17408
  ds_read_b64_tr_b16 a[212:213], v3 offset:16392
  ds_read_b64_tr_b16 a[214:215], v3 offset:17416
  ds_read_b64_tr_b16 a[216:217], v3 offset:24576
  ds_read_b64_tr_b16 a[218:219], v3 offset:25600
  ds_read_b64_tr_b16 a[220:221], v3 offset:24584
  ds_read_b64_tr_b16 a[222:223], v3 offset:25608
  s_waitcnt lgkmcnt(0)
  s_waitcnt vmcnt(0)
  ds_write_b128 v13, a[224:227] offset:32768
  ds_write_b128 v13, a[228:231] offset:33792
  ds_write_b128 v13, a[232:235] offset:34816
  ds_write_b128 v13, a[236:239] offset:35840
  ds_write_b128 v13, a[240:243] offset:36864
  ds_write_b128 v13, a[244:247] offset:37888
  ds_write_b128 v13, a[248:251] offset:38912
  ds_write_b128 v13, a[252:255] offset:39936
  s_waitcnt lgkmcnt(0)
  s_barrier
  ds_read_b64_tr_b16 a[224:225], v3 offset:32768
  ds_read_b64_tr_b16 a[226:227], v3 offset:33792
  ds_read_b64_tr_b16 a[228:229], v3 offset:32776
  ds_read_b64_tr_b16 a[230:231], v3 offset:33800
  ds_read_b64_tr_b16 a[232:233], v3 offset:40960
  ds_read_b64_tr_b16 a[234:235], v3 offset:41984
  ds_read_b64_tr_b16 a[236:237], v3 offset:40968
  ds_read_b64_tr_b16 a[238:239], v3 offset:41992
  ds_read_b64_tr_b16 a[240:241], v3 offset:49152
  ds_read_b64_tr_b16 a[242:243], v3 offset:50176
  ds_read_b64_tr_b16 a[244:245], v3 offset:49160
  ds_read_b64_tr_b16 a[246:247], v3 offset:50184
  ds_read_b64_tr_b16 a[248:249], v3 offset:57344
  ds_read_b64_tr_b16 a[250:251], v3 offset:58368
  ds_read_b64_tr_b16 a[252:253], v3 offset:57352
  ds_read_b64_tr_b16 a[254:255], v3 offset:58376
  s_waitcnt lgkmcnt(0)
  s_barrier
  s_lshl_b32 s46, s30, 14
  s_mov_b32 s47, 65536
  s_mov_b32 s51, 262144
  s_mov_b32 s45, 64
  s_mov_b32 s42, 0
  s_mov_b32 s43, 1
  s_mov_b32 s73, 0x3e0293ee
  s_lshr_b32 s34, s30, 1
  s_and_b32 s35, s30, 1
  s_lshl_b32 s74, s29, 13
  s_lshl_b32 s75, s29, 12
  s_add_u32 s75, s75, 134217728
  s_lshl_b32 s76, s29, 11
  s_lshl_b32 s33, s34, 10
  s_add_u32 s76, s76, s33
  s_add_u32 s76, s76, 142606336
  s_lshr_b32 s77, s29, 3
  s_lshl_b32 s77, s77, 16
  s_add_u32 s77, s77, s33
  s_and_b32 s33, s29, 7
  s_lshl_b32 s33, s33, 11
  s_add_u32 s77, s77, s33
  s_lshl_b32 s33, s35, 15
  s_add_u32 s77, s77, s33
  s_add_u32 s77, s77, 83886080
  s_lshl_b32 s80, s34, 12
  s_add_u32 s80, s80, 50331648
  v_lshlrev_b32 v206, 2, v1
  v_and_b32 v10, 1, v1
  v_lshlrev_b32 v10, 12, v10
  s_lshl_b32 s33, s29, 7
  v_add_u32 v204, s33, v10
  v_and_b32 v10, 3, v1
  v_min_u32 v10, 2, v10
  v_lshlrev_b32 v11, 7, v10
  s_lshl_b32 s34, s33, 1
  s_add_u32 s34, s34, 32640
  v_add_u32 v205, s34, v11
  s_add_u32 s33, s33, 28672
  v_mov_b32 v11, s33
  v_cmp_eq_u32 vcc, 0, v10
  s_nop 1
  v_cndmask_b32 v205, v205, v11, vcc
  s_lshl_b32 s33, s30, 10
  s_add_u32 s33, s33, 131072
  v_add_u32 v207, s33, v8
  s_lshl_b32 s33, s35, 12
  s_add_u32 s33, s33, 131072
  v_add_u32 v208, s33, v8
  v_and_b32 v10, 15, v1
  v_lshrrev_b32 v11, 4, v1
  v_lshlrev_b32 v11, 2, v11
  s_lshl_b32 s33, s35, 4
  v_add_u32 v10, s33, v10
  v_mov_b32 v209, 0xff800000
  v_cmp_le_u32 s[82:83], 32, v1
  v_lshrrev_b32 v13, 4, v1
  v_lshrrev_b32 v12, 1, v13
  v_and_b32 v204, 1, v13
  v_lshl_or_b32 v12, v204, 1, v12
  v_sub_u32 v12, v12, v13
  v_lshlrev_b32 v12, 6, v12
  v_add_u32 v206, v206, v12
  v_and_b32 v12, 1, v1
  v_lshlrev_b32 v12, 12, v12
  s_lshl_b32 s33, s29, 7
  v_add_u32 v204, s33, v12
  v_add_u32 v12, 0, v11
  v_cmp_le_u32 s[56:57], v12, v10
  v_add_u32 v12, 16, v12
  v_cmp_le_u32 s[64:65], v12, v10
  v_add_u32 v12, 1, v11
  v_cmp_le_u32 s[58:59], v12, v10
  v_add_u32 v12, 16, v12
  v_cmp_le_u32 s[66:67], v12, v10
  v_add_u32 v12, 2, v11
  v_cmp_le_u32 s[60:61], v12, v10
  v_add_u32 v12, 16, v12
  v_cmp_le_u32 s[68:69], v12, v10
  v_add_u32 v12, 3, v11
  v_cmp_le_u32 s[62:63], v12, v10
  v_add_u32 v12, 16, v12
  v_cmp_le_u32 s[70:71], v12, v10
  v_mov_b32 v168, 0x3f803f80
  v_mov_b32 v169, 0x3f803f80
  v_mov_b32 v170, 0x3f803f80
  v_mov_b32 v171, 0x3f803f80
  v_mov_b32 v177, 0
  v_mov_b32 v178, 0
  s_mov_b32 s72, 0
  s_mov_b32 s81, 0
  s_lshl_b32 s48, s30, 14
  s_mov_b32 s44, 0
  s_mov_b32 m0, s48
  s_nop 0
  buffer_load_dwordx4 v5, s[16:19], s46 offen offset:0 lds
  s_add_u32 m0, m0, 896
  s_nop 0
  buffer_load_dwordx4 v5, s[16:19], s46 offen offset:128 lds
  s_add_u32 m0, m0, 896
  s_nop 0
  buffer_load_dwordx4 v5, s[16:19], s46 offen offset:256 lds
  s_add_u32 m0, m0, 896
  s_nop 0
  buffer_load_dwordx4 v5, s[16:19], s46 offen offset:384 lds
  s_add_u32 m0, m0, 896
  s_nop 0
  buffer_load_dwordx4 v5, s[16:19], s46 offen offset:512 lds
  s_add_u32 m0, m0, 896
  s_nop 0
  buffer_load_dwordx4 v5, s[16:19], s46 offen offset:640 lds
  s_add_u32 m0, m0, 896
  s_nop 0
  buffer_load_dwordx4 v5, s[16:19], s46 offen offset:768 lds
  s_add_u32 m0, m0, 896
  s_nop 0
  buffer_load_dwordx4 v5, s[16:19], s46 offen offset:896 lds
  s_add_u32 m0, m0, 896
  s_nop 0
  buffer_load_dwordx4 v5, s[16:19], s46 offen offset:1024 lds
  s_add_u32 m0, m0, 896
  s_nop 0
  buffer_load_dwordx4 v5, s[16:19], s46 offen offset:1152 lds
  s_add_u32 m0, m0, 896
  s_nop 0
  buffer_load_dwordx4 v5, s[16:19], s46 offen offset:1280 lds
  s_add_u32 m0, m0, 896
  s_nop 0
  buffer_load_dwordx4 v5, s[16:19], s46 offen offset:1408 lds
  s_add_u32 m0, m0, 896
  s_nop 0
  buffer_load_dwordx4 v5, s[16:19], s46 offen offset:1536 lds
  s_add_u32 m0, m0, 896
  s_nop 0
  buffer_load_dwordx4 v5, s[16:19], s46 offen offset:1664 lds
  s_add_u32 m0, m0, 896
  s_nop 0
  buffer_load_dwordx4 v5, s[16:19], s46 offen offset:1792 lds
  s_add_u32 m0, m0, 896
  s_nop 0
  buffer_load_dwordx4 v5, s[16:19], s46 offen offset:1920 lds
  s_waitcnt vmcnt(0)
  s_barrier
  s_add_u32 s46, s46, s47
  s_xor_b32 s48, s48, 0x10000
  ds_read_b128 v[32:35], v6 offset:0
  ds_read_b128 v[36:39], v6 offset:32768
  ds_read_b128 v[40:43], v7 offset:0
  ds_read_b128 v[44:47], v7 offset:32768
  ds_read_b128 v[48:51], v6 offset:1024
  ds_read_b128 v[52:55], v6 offset:33792
  ds_read_b128 v[56:59], v7 offset:1024
  s_waitcnt lgkmcnt(5)
  v_mfma_f32_16x16x32_bf16 v[16:19], a[0:3], v[32:35], 0
  ds_read_b128 v[60:63], v7 offset:33792
  v_mfma_f32_16x16x32_bf16 v[20:23], a[4:7], v[32:35], 0
  s_mov_b32 m0, s48
  v_mfma_f32_16x16x32_bf16 v[24:27], a[0:3], v[36:39], 0
  ds_read_b128 v[32:35], v6 offset:2048
  v_mfma_f32_16x16x32_bf16 v[28:31], a[4:7], v[36:39], 0
  buffer_load_dwordx4 v5, s[16:19], s46 offen offset:0 lds
  s_waitcnt lgkmcnt(5)
  v_mfma_f32_16x16x32_bf16 v[16:19], a[8:11], v[40:43], v[16:19]
  ds_read_b128 v[36:39], v6 offset:34816
  v_mfma_f32_16x16x32_bf16 v[20:23], a[12:15], v[40:43], v[20:23]
  s_add_u32 m0, m0, 896
  v_mfma_f32_16x16x32_bf16 v[24:27], a[8:11], v[44:47], v[24:27]
  ds_read_b128 v[40:43], v7 offset:2048
  v_mfma_f32_16x16x32_bf16 v[28:31], a[12:15], v[44:47], v[28:31]
  buffer_load_dwordx4 v5, s[16:19], s46 offen offset:128 lds
  s_waitcnt lgkmcnt(5)
  v_mfma_f32_16x16x32_bf16 v[16:19], a[16:19], v[48:51], v[16:19]
  ds_read_b128 v[44:47], v7 offset:34816
  v_mfma_f32_16x16x32_bf16 v[20:23], a[20:23], v[48:51], v[20:23]
  s_add_u32 m0, m0, 896
  v_mfma_f32_16x16x32_bf16 v[24:27], a[16:19], v[52:55], v[24:27]
  ds_read_b128 v[48:51], v6 offset:3072
  v_mfma_f32_16x16x32_bf16 v[28:31], a[20:23], v[52:55], v[28:31]
  buffer_load_dwordx4 v5, s[16:19], s46 offen offset:256 lds
  s_waitcnt lgkmcnt(5)
  v_mfma_f32_16x16x32_bf16 v[16:19], a[24:27], v[56:59], v[16:19]
  ds_read_b128 v[52:55], v6 offset:35840
  v_mfma_f32_16x16x32_bf16 v[20:23], a[28:31], v[56:59], v[20:23]
  s_add_u32 m0, m0, 896
  v_mfma_f32_16x16x32_bf16 v[24:27], a[24:27], v[60:63], v[24:27]
  ds_read_b128 v[56:59], v7 offset:3072
  v_mfma_f32_16x16x32_bf16 v[28:31], a[28:31], v[60:63], v[28:31]
  buffer_load_dwordx4 v5, s[16:19], s46 offen offset:384 lds
  s_waitcnt lgkmcnt(5)
  v_mfma_f32_16x16x32_bf16 v[16:19], a[32:35], v[32:35], v[16:19]
  ds_read_b128 v[60:63], v7 offset:35840
  v_mfma_f32_16x16x32_bf16 v[20:23], a[36:39], v[32:35], v[20:23]
  s_add_u32 m0, m0, 896
  v_mfma_f32_16x16x32_bf16 v[24:27], a[32:35], v[36:39], v[24:27]
  ds_read_b128 v[32:35], v6 offset:4096
  v_mfma_f32_16x16x32_bf16 v[28:31], a[36:39], v[36:39], v[28:31]
  buffer_load_dwordx4 v5, s[16:19], s46 offen offset:512 lds
  s_waitcnt lgkmcnt(5)
  v_mfma_f32_16x16x32_bf16 v[16:19], a[40:43], v[40:43], v[16:19]
  ds_read_b128 v[36:39], v6 offset:36864
  v_mfma_f32_16x16x32_bf16 v[20:23], a[44:47], v[40:43], v[20:23]
  s_add_u32 m0, m0, 896
  v_mfma_f32_16x16x32_bf16 v[24:27], a[40:43], v[44:47], v[24:27]
  ds_read_b128 v[40:43], v7 offset:4096
  v_mfma_f32_16x16x32_bf16 v[28:31], a[44:47], v[44:47], v[28:31]
  buffer_load_dwordx4 v5, s[16:19], s46 offen offset:640 lds
  s_waitcnt lgkmcnt(5)
  v_mfma_f32_16x16x32_bf16 v[16:19], a[48:51], v[48:51], v[16:19]
  ds_read_b128 v[44:47], v7 offset:36864
  v_mfma_f32_16x16x32_bf16 v[20:23], a[52:55], v[48:51], v[20:23]
  s_add_u32 m0, m0, 896
  v_mfma_f32_16x16x32_bf16 v[24:27], a[48:51], v[52:55], v[24:27]
  ds_read_b128 v[48:51], v6 offset:5120
  v_mfma_f32_16x16x32_bf16 v[28:31], a[52:55], v[52:55], v[28:31]
  buffer_load_dwordx4 v5, s[16:19], s46 offen offset:768 lds
  s_waitcnt lgkmcnt(5)
  v_mfma_f32_16x16x32_bf16 v[16:19], a[56:59], v[56:59], v[16:19]
  ds_read_b128 v[52:55], v6 offset:37888
  v_mfma_f32_16x16x32_bf16 v[20:23], a[60:63], v[56:59], v[20:23]
  s_add_u32 m0, m0, 896
  v_mfma_f32_16x16x32_bf16 v[24:27], a[56:59], v[60:63], v[24:27]
  ds_read_b128 v[56:59], v7 offset:5120
  v_mfma_f32_16x16x32_bf16 v[28:31], a[60:63], v[60:63], v[28:31]
  buffer_load_dwordx4 v5, s[16:19], s46 offen offset:896 lds
  s_waitcnt lgkmcnt(5)
  v_mfma_f32_16x16x32_bf16 v[16:19], a[64:67], v[32:35], v[16:19]
  ds_read_b128 v[60:63], v7 offset:37888
  v_mfma_f32_16x16x32_bf16 v[20:23], a[68:71], v[32:35], v[20:23]
  s_add_u32 m0, m0, 896
  v_mfma_f32_16x16x32_bf16 v[24:27], a[64:67], v[36:39], v[24:27]
  ds_read_b128 v[32:35], v6 offset:6144
  v_mfma_f32_16x16x32_bf16 v[28:31], a[68:71], v[36:39], v[28:31]
  buffer_load_dwordx4 v5, s[16:19], s46 offen offset:1024 lds
  s_waitcnt lgkmcnt(5)
  v_mfma_f32_16x16x32_bf16 v[16:19], a[72:75], v[40:43], v[16:19]
  ds_read_b128 v[36:39], v6 offset:38912
  v_mfma_f32_16x16x32_bf16 v[20:23], a[76:79], v[40:43], v[20:23]
  s_add_u32 m0, m0, 896
  v_mfma_f32_16x16x32_bf16 v[24:27], a[72:75], v[44:47], v[24:27]
  ds_read_b128 v[40:43], v7 offset:6144
  v_mfma_f32_16x16x32_bf16 v[28:31], a[76:79], v[44:47], v[28:31]
  buffer_load_dwordx4 v5, s[16:19], s46 offen offset:1152 lds
  s_waitcnt lgkmcnt(5)
  v_mfma_f32_16x16x32_bf16 v[16:19], a[80:83], v[48:51], v[16:19]
  ds_read_b128 v[44:47], v7 offset:38912
  v_mfma_f32_16x16x32_bf16 v[20:23], a[84:87], v[48:51], v[20:23]
  s_add_u32 m0, m0, 896
  v_mfma_f32_16x16x32_bf16 v[24:27], a[80:83], v[52:55], v[24:27]
  ds_read_b128 v[48:51], v6 offset:7168
  v_mfma_f32_16x16x32_bf16 v[28:31], a[84:87], v[52:55], v[28:31]
  buffer_load_dwordx4 v5, s[16:19], s46 offen offset:1280 lds
  s_waitcnt lgkmcnt(5)
  v_mfma_f32_16x16x32_bf16 v[16:19], a[88:91], v[56:59], v[16:19]
  ds_read_b128 v[52:55], v6 offset:39936
  v_mfma_f32_16x16x32_bf16 v[20:23], a[92:95], v[56:59], v[20:23]
  s_add_u32 m0, m0, 896
  v_mfma_f32_16x16x32_bf16 v[24:27], a[88:91], v[60:63], v[24:27]
  ds_read_b128 v[56:59], v7 offset:7168
  v_mfma_f32_16x16x32_bf16 v[28:31], a[92:95], v[60:63], v[28:31]
  buffer_load_dwordx4 v5, s[16:19], s46 offen offset:1408 lds
  s_waitcnt lgkmcnt(5)
  v_mfma_f32_16x16x32_bf16 v[16:19], a[96:99], v[32:35], v[16:19]
  ds_read_b128 v[60:63], v7 offset:39936
  v_mfma_f32_16x16x32_bf16 v[20:23], a[100:103], v[32:35], v[20:23]
  s_add_u32 m0, m0, 896
  v_mfma_f32_16x16x32_bf16 v[24:27], a[96:99], v[36:39], v[24:27]
  ds_read_b128 v[32:35], v6 offset:8192
  v_mfma_f32_16x16x32_bf16 v[28:31], a[100:103], v[36:39], v[28:31]
  buffer_load_dwordx4 v5, s[16:19], s46 offen offset:1536 lds
  s_waitcnt lgkmcnt(5)
  v_mfma_f32_16x16x32_bf16 v[16:19], a[104:107], v[40:43], v[16:19]
  ds_read_b128 v[36:39], v6 offset:40960
  v_mfma_f32_16x16x32_bf16 v[20:23], a[108:111], v[40:43], v[20:23]
  s_add_u32 m0, m0, 896
  v_mfma_f32_16x16x32_bf16 v[24:27], a[104:107], v[44:47], v[24:27]
  ds_read_b128 v[40:43], v7 offset:8192
  v_mfma_f32_16x16x32_bf16 v[28:31], a[108:111], v[44:47], v[28:31]
  buffer_load_dwordx4 v5, s[16:19], s46 offen offset:1664 lds
  s_waitcnt lgkmcnt(5)
  v_mfma_f32_16x16x32_bf16 v[16:19], a[112:115], v[48:51], v[16:19]
  ds_read_b128 v[44:47], v7 offset:40960
  v_mfma_f32_16x16x32_bf16 v[20:23], a[116:119], v[48:51], v[20:23]
  s_add_u32 m0, m0, 896
  v_mfma_f32_16x16x32_bf16 v[24:27], a[112:115], v[52:55], v[24:27]
  ds_read_b128 v[48:51], v6 offset:9216
  v_mfma_f32_16x16x32_bf16 v[28:31], a[116:119], v[52:55], v[28:31]
  buffer_load_dwordx4 v5, s[16:19], s46 offen offset:1792 lds
  s_waitcnt lgkmcnt(5)
  v_mfma_f32_16x16x32_bf16 v[16:19], a[120:123], v[56:59], v[16:19]
  ds_read_b128 v[52:55], v6 offset:41984
  v_mfma_f32_16x16x32_bf16 v[20:23], a[124:127], v[56:59], v[20:23]
  s_add_u32 m0, m0, 896
  v_mfma_f32_16x16x32_bf16 v[24:27], a[120:123], v[60:63], v[24:27]
  ds_read_b128 v[56:59], v7 offset:9216
  v_mfma_f32_16x16x32_bf16 v[28:31], a[124:127], v[60:63], v[28:31]
  buffer_load_dwordx4 v5, s[16:19], s46 offen offset:1920 lds
  s_waitcnt lgkmcnt(5)
  v_mfma_f32_16x16x32_bf16 v[16:19], a[128:131], v[32:35], v[16:19]
  ds_read_b128 v[60:63], v7 offset:41984
  v_mfma_f32_16x16x32_bf16 v[20:23], a[132:135], v[32:35], v[20:23]
  v_mfma_f32_16x16x32_bf16 v[24:27], a[128:131], v[36:39], v[24:27]
  ds_read_b128 v[32:35], v6 offset:10240
  v_mfma_f32_16x16x32_bf16 v[28:31], a[132:135], v[36:39], v[28:31]
  s_waitcnt lgkmcnt(5)
  v_mfma_f32_16x16x32_bf16 v[16:19], a[136:139], v[40:43], v[16:19]
  ds_read_b128 v[36:39], v6 offset:43008
  v_mfma_f32_16x16x32_bf16 v[20:23], a[140:143], v[40:43], v[20:23]
  v_mfma_f32_16x16x32_bf16 v[24:27], a[136:139], v[44:47], v[24:27]
  ds_read_b128 v[40:43], v7 offset:10240
  v_mfma_f32_16x16x32_bf16 v[28:31], a[140:143], v[44:47], v[28:31]
  s_waitcnt lgkmcnt(5)
  v_mfma_f32_16x16x32_bf16 v[16:19], a[144:147], v[48:51], v[16:19]
  ds_read_b128 v[44:47], v7 offset:43008
  v_mfma_f32_16x16x32_bf16 v[20:23], a[148:151], v[48:51], v[20:23]
  v_mfma_f32_16x16x32_bf16 v[24:27], a[144:147], v[52:55], v[24:27]
  ds_read_b128 v[48:51], v6 offset:11264
  v_mfma_f32_16x16x32_bf16 v[28:31], a[148:151], v[52:55], v[28:31]
  s_waitcnt lgkmcnt(5)
  v_mfma_f32_16x16x32_bf16 v[16:19], a[152:155], v[56:59], v[16:19]
  ds_read_b128 v[52:55], v6 offset:44032
  v_mfma_f32_16x16x32_bf16 v[20:23], a[156:159], v[56:59], v[20:23]
  v_mfma_f32_16x16x32_bf16 v[24:27], a[152:155], v[60:63], v[24:27]
  ds_read_b128 v[56:59], v7 offset:11264
  v_mfma_f32_16x16x32_bf16 v[28:31], a[156:159], v[60:63], v[28:31]
  s_waitcnt lgkmcnt(5)
  v_mfma_f32_16x16x32_bf16 v[16:19], a[160:163], v[32:35], v[16:19]
  ds_read_b128 v[60:63], v7 offset:44032
  v_mfma_f32_16x16x32_bf16 v[20:23], a[164:167], v[32:35], v[20:23]
  v_mfma_f32_16x16x32_bf16 v[24:27], a[160:163], v[36:39], v[24:27]
  ds_read_b128 v[32:35], v6 offset:12288
  v_mfma_f32_16x16x32_bf16 v[28:31], a[164:167], v[36:39], v[28:31]
  s_waitcnt lgkmcnt(5)
  v_mfma_f32_16x16x32_bf16 v[16:19], a[168:171], v[40:43], v[16:19]
  ds_read_b128 v[36:39], v6 offset:45056
  v_mfma_f32_16x16x32_bf16 v[20:23], a[172:175], v[40:43], v[20:23]
  v_mfma_f32_16x16x32_bf16 v[24:27], a[168:171], v[44:47], v[24:27]
  ds_read_b128 v[40:43], v7 offset:12288
  v_mfma_f32_16x16x32_bf16 v[28:31], a[172:175], v[44:47], v[28:31]
  s_waitcnt lgkmcnt(5)
  v_mfma_f32_16x16x32_bf16 v[16:19], a[176:179], v[48:51], v[16:19]
  ds_read_b128 v[44:47], v7 offset:45056
  v_mfma_f32_16x16x32_bf16 v[20:23], a[180:183], v[48:51], v[20:23]
  v_mfma_f32_16x16x32_bf16 v[24:27], a[176:179], v[52:55], v[24:27]
  ds_read_b128 v[48:51], v6 offset:13312
  v_mfma_f32_16x16x32_bf16 v[28:31], a[180:183], v[52:55], v[28:31]
  s_waitcnt lgkmcnt(5)
  v_mfma_f32_16x16x32_bf16 v[16:19], a[184:187], v[56:59], v[16:19]
  ds_read_b128 v[52:55], v6 offset:46080
  v_mfma_f32_16x16x32_bf16 v[20:23], a[188:191], v[56:59], v[20:23]
  v_mfma_f32_16x16x32_bf16 v[24:27], a[184:187], v[60:63], v[24:27]
  ds_read_b128 v[56:59], v7 offset:13312
  v_mfma_f32_16x16x32_bf16 v[28:31], a[188:191], v[60:63], v[28:31]
  s_waitcnt lgkmcnt(5)
  v_mfma_f32_16x16x32_bf16 v[16:19], a[192:195], v[32:35], v[16:19]
  ds_read_b128 v[60:63], v7 offset:46080
  v_mfma_f32_16x16x32_bf16 v[20:23], a[196:199], v[32:35], v[20:23]
  v_mfma_f32_16x16x32_bf16 v[24:27], a[192:195], v[36:39], v[24:27]
  ds_read_b128 v[32:35], v6 offset:14336
  v_mfma_f32_16x16x32_bf16 v[28:31], a[196:199], v[36:39], v[28:31]
  s_waitcnt lgkmcnt(5)
  v_mfma_f32_16x16x32_bf16 v[16:19], a[200:203], v[40:43], v[16:19]
  ds_read_b128 v[36:39], v6 offset:47104
  v_mfma_f32_16x16x32_bf16 v[20:23], a[204:207], v[40:43], v[20:23]
  v_mfma_f32_16x16x32_bf16 v[24:27], a[200:203], v[44:47], v[24:27]
  ds_read_b128 v[40:43], v7 offset:14336
  v_mfma_f32_16x16x32_bf16 v[28:31], a[204:207], v[44:47], v[28:31]
  s_waitcnt lgkmcnt(5)
  v_mfma_f32_16x16x32_bf16 v[16:19], a[208:211], v[48:51], v[16:19]
  ds_read_b128 v[44:47], v7 offset:47104
  v_mfma_f32_16x16x32_bf16 v[20:23], a[212:215], v[48:51], v[20:23]
  v_mfma_f32_16x16x32_bf16 v[24:27], a[208:211], v[52:55], v[24:27]
  ds_read_b128 v[48:51], v6 offset:15360
  v_mfma_f32_16x16x32_bf16 v[28:31], a[212:215], v[52:55], v[28:31]
  s_waitcnt lgkmcnt(5)
  v_mfma_f32_16x16x32_bf16 v[16:19], a[216:219], v[56:59], v[16:19]
  ds_read_b128 v[52:55], v6 offset:48128
  v_mfma_f32_16x16x32_bf16 v[20:23], a[220:223], v[56:59], v[20:23]
  v_mfma_f32_16x16x32_bf16 v[24:27], a[216:219], v[60:63], v[24:27]
  ds_read_b128 v[56:59], v7 offset:15360
  v_mfma_f32_16x16x32_bf16 v[28:31], a[220:223], v[60:63], v[28:31]
  s_waitcnt lgkmcnt(5)
  v_mfma_f32_16x16x32_bf16 v[16:19], a[224:227], v[32:35], v[16:19]
  ds_read_b128 v[60:63], v7 offset:48128
  v_mfma_f32_16x16x32_bf16 v[20:23], a[228:231], v[32:35], v[20:23]
  v_mfma_f32_16x16x32_bf16 v[24:27], a[224:227], v[36:39], v[24:27]
  v_mfma_f32_16x16x32_bf16 v[28:31], a[228:231], v[36:39], v[28:31]
  s_waitcnt lgkmcnt(4)
  v_mfma_f32_16x16x32_bf16 v[16:19], a[232:235], v[40:43], v[16:19]
  v_mfma_f32_16x16x32_bf16 v[20:23], a[236:239], v[40:43], v[20:23]
  v_mfma_f32_16x16x32_bf16 v[24:27], a[232:235], v[44:47], v[24:27]
  v_mfma_f32_16x16x32_bf16 v[28:31], a[236:239], v[44:47], v[28:31]
  s_waitcnt lgkmcnt(2)
  v_mfma_f32_16x16x32_bf16 v[16:19], a[240:243], v[48:51], v[16:19]
  v_mfma_f32_16x16x32_bf16 v[20:23], a[244:247], v[48:51], v[20:23]
  v_mfma_f32_16x16x32_bf16 v[24:27], a[240:243], v[52:55], v[24:27]
  v_mfma_f32_16x16x32_bf16 v[28:31], a[244:247], v[52:55], v[28:31]
  s_waitcnt lgkmcnt(0)
  v_mfma_f32_16x16x32_bf16 v[16:19], a[248:251], v[56:59], v[16:19]
  v_mfma_f32_16x16x32_bf16 v[20:23], a[252:255], v[56:59], v[20:23]
  v_mfma_f32_16x16x32_bf16 v[24:27], a[248:251], v[60:63], v[24:27]
  v_mfma_f32_16x16x32_bf16 v[28:31], a[252:255], v[60:63], v[28:31]
  s_nop 4
  v_cvt_pk_bf16_f32 v64, v16, v17
  v_cvt_pk_bf16_f32 v65, v18, v19
  v_cvt_pk_bf16_f32 v66, v20, v21
  v_cvt_pk_bf16_f32 v67, v22, v23
  ds_write_b128 v207, v[64:67] offset:0
  v_cvt_pk_bf16_f32 v68, v24, v25
  v_cvt_pk_bf16_f32 v69, v26, v27
  v_cvt_pk_bf16_f32 v70, v28, v29
  v_cvt_pk_bf16_f32 v71, v30, v31
  ds_write_b128 v207, v[68:71] offset:4096
  v_xor_b32 v207, 0x2000, v207
  v_xor_b32 v6, 0x10000, v6
  v_xor_b32 v7, 0x10000, v7
  s_waitcnt vmcnt(0)
L_QA_loop:
  s_waitcnt lgkmcnt(0)
  s_barrier
  s_add_u32 s55, s42, 1
  s_cmp_le_u32 s55, s72
  s_cbranch_scc1 rdy_35
  s_mov_b32 s32, 0
wf_36:
  buffer_load_dword v10, v204, s[8:11], 0 offen sc1
  s_waitcnt vmcnt(0)
  v_cmp_gt_u32 vcc, s55, v10
  s_cbranch_vccz wfd_37
  s_sleep 4
  s_add_u32 s32, s32, 1
  s_cmp_lt_u32 s32, s31
  s_cbranch_scc1 wf_36
  s_mov_b32 s31, 0
wfd_37:
  v_min_u32_dpp v10, v10, v10 row_ror:1 row_mask:0xf bank_mask:0xf
  s_nop 0
  v_readfirstlane_b32 s72, v10
  s_nop 3
rdy_35:
  s_cmp_gt_u32 s55, s81
  s_cbranch_scc1 early_38
  s_lshl_b32 s54, s42, 17
  s_add_u32 s54, s54, s75
  s_lshl_b32 s79, s42, 16
  s_add_u32 s79, s79, s76
  buffer_load_dwordx4 v[120:123], v8, s[8:11], s54 offen offset:0 sc1
  buffer_load_dwordx4 v[124:127], v8, s[8:11], s54 offen offset:1024 sc1
  buffer_load_dwordx4 v[128:131], v8, s[8:11], s54 offen offset:2048 sc1
  buffer_load_dwordx4 v[132:135], v8, s[8:11], s54 offen offset:3072 sc1
  buffer_load_dword v136, v206, s[8:11], s79 offen offset:0 sc1
  buffer_load_dword v137, v206, s[8:11], s79 offen offset:256 sc1
  buffer_load_dword v138, v206, s[8:11], s79 offen offset:512 sc1
  buffer_load_dword v139, v206, s[8:11], s79 offen offset:768 sc1
early_38:
  s_cmp_eq_u32 s42, 63
  s_cbranch_scc1 L_QA_nogemm
  s_add_u32 s46, s46, s47
  s_xor_b32 s48, s48, 0x10000
  ds_read_b128 v[32:35], v6 offset:0
  ds_read_b128 v[36:39], v6 offset:32768
  ds_read_b128 v[40:43], v7 offset:0
  ds_read_b128 v[44:47], v7 offset:32768
  ds_read_b128 v[48:51], v6 offset:1024
  ds_read_b128 v[52:55], v6 offset:33792
  ds_read_b128 v[56:59], v7 offset:1024
  s_waitcnt lgkmcnt(5)
  v_mfma_f32_16x16x32_bf16 v[16:19], a[0:3], v[32:35], 0
  ds_read_b128 v[60:63], v7 offset:33792
  v_mfma_f32_16x16x32_bf16 v[20:23], a[4:7], v[32:35], 0
  s_mov_b32 m0, s48
  v_mfma_f32_16x16x32_bf16 v[24:27], a[0:3], v[36:39], 0
  ds_read_b128 v[32:35], v6 offset:2048
  v_mfma_f32_16x16x32_bf16 v[28:31], a[4:7], v[36:39], 0
  buffer_load_dwordx4 v5, s[16:19], s46 offen offset:0 lds
  s_waitcnt lgkmcnt(5)
  v_mfma_f32_16x16x32_bf16 v[16:19], a[8:11], v[40:43], v[16:19]
  ds_read_b128 v[36:39], v6 offset:34816
  v_mfma_f32_16x16x32_bf16 v[20:23], a[12:15], v[40:43], v[20:23]
  s_add_u32 m0, m0, 896
  v_mfma_f32_16x16x32_bf16 v[24:27], a[8:11], v[44:47], v[24:27]
  ds_read_b128 v[40:43], v7 offset:2048
  v_mfma_f32_16x16x32_bf16 v[28:31], a[12:15], v[44:47], v[28:31]
  buffer_load_dwordx4 v5, s[16:19], s46 offen offset:128 lds
  s_waitcnt lgkmcnt(5)
  v_mfma_f32_16x16x32_bf16 v[16:19], a[16:19], v[48:51], v[16:19]
  ds_read_b128 v[44:47], v7 offset:34816
  v_mfma_f32_16x16x32_bf16 v[20:23], a[20:23], v[48:51], v[20:23]
  s_add_u32 m0, m0, 896
  v_mfma_f32_16x16x32_bf16 v[24:27], a[16:19], v[52:55], v[24:27]
  ds_read_b128 v[48:51], v6 offset:3072
  v_mfma_f32_16x16x32_bf16 v[28:31], a[20:23], v[52:55], v[28:31]
  buffer_load_dwordx4 v5, s[16:19], s46 offen offset:256 lds
  s_waitcnt lgkmcnt(5)
  v_mfma_f32_16x16x32_bf16 v[16:19], a[24:27], v[56:59], v[16:19]
  ds_read_b128 v[52:55], v6 offset:35840
  v_mfma_f32_16x16x32_bf16 v[20:23], a[28:31], v[56:59], v[20:23]
  s_add_u32 m0, m0, 896
  v_mfma_f32_16x16x32_bf16 v[24:27], a[24:27], v[60:63], v[24:27]
  ds_read_b128 v[56:59], v7 offset:3072
  v_mfma_f32_16x16x32_bf16 v[28:31], a[28:31], v[60:63], v[28:31]
  buffer_load_dwordx4 v5, s[16:19], s46 offen offset:384 lds
  s_waitcnt lgkmcnt(5)
  v_mfma_f32_16x16x32_bf16 v[16:19], a[32:35], v[32:35], v[16:19]
  ds_read_b128 v[60:63], v7 offset:35840
  v_mfma_f32_16x16x32_bf16 v[20:23], a[36:39], v[32:35], v[20:23]
  s_add_u32 m0, m0, 896
  v_mfma_f32_16x16x32_bf16 v[24:27], a[32:35], v[36:39], v[24:27]
  ds_read_b128 v[32:35], v6 offset:4096
  v_mfma_f32_16x16x32_bf16 v[28:31], a[36:39], v[36:39], v[28:31]
  buffer_load_dwordx4 v5, s[16:19], s46 offen offset:512 lds
  s_waitcnt lgkmcnt(5)
  v_mfma_f32_16x16x32_bf16 v[16:19], a[40:43], v[40:43], v[16:19]
  ds_read_b128 v[36:39], v6 offset:36864
  v_mfma_f32_16x16x32_bf16 v[20:23], a[44:47], v[40:43], v[20:23]
  s_add_u32 m0, m0, 896
  v_mfma_f32_16x16x32_bf16 v[24:27], a[40:43], v[44:47], v[24:27]
  ds_read_b128 v[40:43], v7 offset:4096
  v_mfma_f32_16x16x32_bf16 v[28:31], a[44:47], v[44:47], v[28:31]
  buffer_load_dwordx4 v5, s[16:19], s46 offen offset:640 lds
  s_waitcnt lgkmcnt(5)
  v_mfma_f32_16x16x32_bf16 v[16:19], a[48:51], v[48:51], v[16:19]
  ds_read_b128 v[44:47], v7 offset:36864
  v_mfma_f32_16x16x32_bf16 v[20:23], a[52:55], v[48:51], v[20:23]
  s_add_u32 m0, m0, 896
  v_mfma_f32_16x16x32_bf16 v[24:27], a[48:51], v[52:55], v[24:27]
  ds_read_b128 v[48:51], v6 offset:5120
  v_mfma_f32_16x16x32_bf16 v[28:31], a[52:55], v[52:55], v[28:31]
  buffer_load_dwordx4 v5, s[16:19], s46 offen offset:768 lds
  s_waitcnt lgkmcnt(5)
  v_mfma_f32_16x16x32_bf16 v[16:19], a[56:59], v[56:59], v[16:19]
  ds_read_b128 v[52:55], v6 offset:37888
  v_mfma_f32_16x16x32_bf16 v[20:23], a[60:63], v[56:59], v[20:23]
  s_add_u32 m0, m0, 896
  v_mfma_f32_16x16x32_bf16 v[24:27], a[56:59], v[60:63], v[24:27]
  ds_read_b128 v[56:59], v7 offset:5120
  v_mfma_f32_16x16x32_bf16 v[28:31], a[60:63], v[60:63], v[28:31]
  buffer_load_dwordx4 v5, s[16:19], s46 offen offset:896 lds
  s_waitcnt lgkmcnt(5)
  v_mfma_f32_16x16x32_bf16 v[16:19], a[64:67], v[32:35], v[16:19]
  ds_read_b128 v[60:63], v7 offset:37888
  v_mfma_f32_16x16x32_bf16 v[20:23], a[68:71], v[32:35], v[20:23]
  s_add_u32 m0, m0, 896
  v_mfma_f32_16x16x32_bf16 v[24:27], a[64:67], v[36:39], v[24:27]
  ds_read_b128 v[32:35], v6 offset:6144
  v_mfma_f32_16x16x32_bf16 v[28:31], a[68:71], v[36:39], v[28:31]
  buffer_load_dwordx4 v5, s[16:19], s46 offen offset:1024 lds
  s_waitcnt lgkmcnt(5)
  v_mfma_f32_16x16x32_bf16 v[16:19], a[72:75], v[40:43], v[16:19]
  ds_read_b128 v[36:39], v6 offset:38912
  v_mfma_f32_16x16x32_bf16 v[20:23], a[76:79], v[40:43], v[20:23]
  s_add_u32 m0, m0, 896
  v_mfma_f32_16x16x32_bf16 v[24:27], a[72:75], v[44:47], v[24:27]
  ds_read_b128 v[40:43], v7 offset:6144
  v_mfma_f32_16x16x32_bf16 v[28:31], a[76:79], v[44:47], v[28:31]
  buffer_load_dwordx4 v5, s[16:19], s46 offen offset:1152 lds
  s_waitcnt lgkmcnt(5)
  v_mfma_f32_16x16x32_bf16 v[16:19], a[80:83], v[48:51], v[16:19]
  ds_read_b128 v[44:47], v7 offset:38912
  v_mfma_f32_16x16x32_bf16 v[20:23], a[84:87], v[48:51], v[20:23]
  s_add_u32 m0, m0, 896
  v_mfma_f32_16x16x32_bf16 v[24:27], a[80:83], v[52:55], v[24:27]
  ds_read_b128 v[48:51], v6 offset:7168
  v_mfma_f32_16x16x32_bf16 v[28:31], a[84:87], v[52:55], v[28:31]
  buffer_load_dwordx4 v5, s[16:19], s46 offen offset:1280 lds
  s_waitcnt lgkmcnt(5)
  v_mfma_f32_16x16x32_bf16 v[16:19], a[88:91], v[56:59], v[16:19]
  ds_read_b128 v[52:55], v6 offset:39936
  v_mfma_f32_16x16x32_bf16 v[20:23], a[92:95], v[56:59], v[20:23]
  s_add_u32 m0, m0, 896
  v_mfma_f32_16x16x32_bf16 v[24:27], a[88:91], v[60:63], v[24:27]
  ds_read_b128 v[56:59], v7 offset:7168
  v_mfma_f32_16x16x32_bf16 v[28:31], a[92:95], v[60:63], v[28:31]
  buffer_load_dwordx4 v5, s[16:19], s46 offen offset:1408 lds
  s_waitcnt lgkmcnt(5)
  v_mfma_f32_16x16x32_bf16 v[16:19], a[96:99], v[32:35], v[16:19]
  ds_read_b128 v[60:63], v7 offset:39936
  v_mfma_f32_16x16x32_bf16 v[20:23], a[100:103], v[32:35], v[20:23]
  s_add_u32 m0, m0, 896
  v_mfma_f32_16x16x32_bf16 v[24:27], a[96:99], v[36:39], v[24:27]
  ds_read_b128 v[32:35], v6 offset:8192
  v_mfma_f32_16x16x32_bf16 v[28:31], a[100:103], v[36:39], v[28:31]
  buffer_load_dwordx4 v5, s[16:19], s46 offen offset:1536 lds
  s_waitcnt lgkmcnt(5)
  v_mfma_f32_16x16x32_bf16 v[16:19], a[104:107], v[40:43], v[16:19]
  ds_read_b128 v[36:39], v6 offset:40960
  v_mfma_f32_16x16x32_bf16 v[20:23], a[108:111], v[40:43], v[20:23]
  s_add_u32 m0, m0, 896
  v_mfma_f32_16x16x32_bf16 v[24:27], a[104:107], v[44:47], v[24:27]
  ds_read_b128 v[40:43], v7 offset:8192
  v_mfma_f32_16x16x32_bf16 v[28:31], a[108:111], v[44:47], v[28:31]
  buffer_load_dwordx4 v5, s[16:19], s46 offen offset:1664 lds
  s_waitcnt lgkmcnt(5)
  v_mfma_f32_16x16x32_bf16 v[16:19], a[112:115], v[48:51], v[16:19]
  ds_read_b128 v[44:47], v7 offset:40960
  v_mfma_f32_16x16x32_bf16 v[20:23], a[116:119], v[48:51], v[20:23]
  s_add_u32 m0, m0, 896
  v_mfma_f32_16x16x32_bf16 v[24:27], a[112:115], v[52:55], v[24:27]
  ds_read_b128 v[48:51], v6 offset:9216
  v_mfma_f32_16x16x32_bf16 v[28:31], a[116:119], v[52:55], v[28:31]
  buffer_load_dwordx4 v5, s[16:19], s46 offen offset:1792 lds
  s_waitcnt lgkmcnt(5)
  v_mfma_f32_16x16x32_bf16 v[16:19], a[120:123], v[56:59], v[16:19]
  ds_read_b128 v[52:55], v6 offset:41984
  v_mfma_f32_16x16x32_bf16 v[20:23], a[124:127], v[56:59], v[20:23]
  s_add_u32 m0, m0, 896
  v_mfma_f32_16x16x32_bf16 v[24:27], a[120:123], v[60:63], v[24:27]
  ds_read_b128 v[56:59], v7 offset:9216
  v_mfma_f32_16x16x32_bf16 v[28:31], a[124:127], v[60:63], v[28:31]
  buffer_load_dwordx4 v5, s[16:19], s46 offen offset:1920 lds
  s_waitcnt lgkmcnt(5)
  v_mfma_f32_16x16x32_bf16 v[16:19], a[128:131], v[32:35], v[16:19]
  ds_read_b128 v[60:63], v7 offset:41984
  v_mfma_f32_16x16x32_bf16 v[20:23], a[132:135], v[32:35], v[20:23]
  s_waitcnt vmcnt(16)
  s_barrier
  s_cmp_eq_u32 s42, 0
  s_cbranch_scc1 fp_39
  s_cmp_lg_u32 s30, 0
  s_cbranch_scc1 w0_40
  s_mov_b64 s[96:97], exec
  s_mov_b64 exec, 1
  v_mov_b32 v10, s52
  v_mov_b32 v11, s42
  buffer_store_dword v11, v10, s[8:11], 0 offen sc1
  s_mov_b64 exec, s[96:97]
w0_40:
fp_39:
  v_mfma_f32_16x16x32_bf16 v[24:27], a[128:131], v[36:39], v[24:27]
  ds_read_b128 v[32:35], v6 offset:10240
  v_mfma_f32_16x16x32_bf16 v[28:31], a[132:135], v[36:39], v[28:31]
  buffer_load_dword v13, v205, s[8:11], 0 offen sc1
  s_waitcnt lgkmcnt(5)
  v_mfma_f32_16x16x32_bf16 v[16:19], a[136:139], v[40:43], v[16:19]
  ds_read_b128 v[36:39], v6 offset:43008
  v_mfma_f32_16x16x32_bf16 v[20:23], a[140:143], v[40:43], v[20:23]
  s_lshl_b32 s79, s42, 18
  s_add_u32 s79, s79, s74
  s_add_u32 s54, s79, 16777216
  v_mfma_f32_16x16x32_bf16 v[24:27], a[136:139], v[44:47], v[24:27]
  ds_read_b128 v[40:43], v7 offset:10240
  v_mfma_f32_16x16x32_bf16 v[28:31], a[140:143], v[44:47], v[28:31]
  buffer_load_dwordx4 v[72:75], v8, s[8:11], s54 offen offset:0 sc1
  s_waitcnt lgkmcnt(5)
  v_mfma_f32_16x16x32_bf16 v[16:19], a[144:147], v[48:51], v[16:19]
  ds_read_b128 v[44:47], v7 offset:43008
  v_mfma_f32_16x16x32_bf16 v[20:23], a[148:151], v[48:51], v[20:23]
  buffer_load_dwordx4 v[76:79], v8, s[8:11], s54 offen offset:1024 sc1
  v_mfma_f32_16x16x32_bf16 v[24:27], a[144:147], v[52:55], v[24:27]
  ds_read_b128 v[48:51], v6 offset:11264
  v_mfma_f32_16x16x32_bf16 v[28:31], a[148:151], v[52:55], v[28:31]
  buffer_load_dwordx4 v[80:83], v8, s[8:11], s54 offen offset:2048 sc1
  s_waitcnt lgkmcnt(5)
  v_mfma_f32_16x16x32_bf16 v[16:19], a[152:155], v[56:59], v[16:19]
  ds_read_b128 v[52:55], v6 offset:44032
  v_mfma_f32_16x16x32_bf16 v[20:23], a[156:159], v[56:59], v[20:23]
  buffer_load_dwordx4 v[84:87], v8, s[8:11], s54 offen offset:3072 sc1
  v_mfma_f32_16x16x32_bf16 v[24:27], a[152:155], v[60:63], v[24:27]
  ds_read_b128 v[56:59], v7 offset:11264
  v_mfma_f32_16x16x32_bf16 v[28:31], a[156:159], v[60:63], v[28:31]
  s_add_u32 s54, s54, 4096
  s_waitcnt lgkmcnt(5)
  v_mfma_f32_16x16x32_bf16 v[16:19], a[160:163], v[32:35], v[16:19]
  ds_read_b128 v[60:63], v7 offset:44032
  v_mfma_f32_16x16x32_bf16 v[20:23], a[164:167], v[32:35], v[20:23]
  buffer_load_dwordx4 v[88:91], v8, s[8:11], s54 offen offset:0 sc1
  v_mfma_f32_16x16x32_bf16 v[24:27], a[160:163], v[36:39], v[24:27]
  ds_read_b128 v[32:35], v6 offset:12288
  v_mfma_f32_16x16x32_bf16 v[28:31], a[164:167], v[36:39], v[28:31]
  buffer_load_dwordx4 v[92:95], v8, s[8:11], s54 offen offset:1024 sc1
  s_waitcnt lgkmcnt(5)
  v_mfma_f32_16x16x32_bf16 v[16:19], a[168:171], v[40:43], v[16:19]
  ds_read_b128 v[36:39], v6 offset:45056
  v_mfma_f32_16x16x32_bf16 v[20:23], a[172:175], v[40:43], v[20:23]
  buffer_load_dwordx4 v[96:99], v8, s[8:11], s54 offen offset:2048 sc1
  v_mfma_f32_16x16x32_bf16 v[24:27], a[168:171], v[44:47], v[24:27]
  ds_read_b128 v[40:43], v7 offset:12288
  v_mfma_f32_16x16x32_bf16 v[28:31], a[172:175], v[44:47], v[28:31]
  buffer_load_dwordx4 v[100:103], v8, s[8:11], s54 offen offset:3072 sc1
  s_waitcnt lgkmcnt(5)
  v_mfma_f32_16x16x32_bf16 v[16:19], a[176:179], v[48:51], v[16:19]
  ds_read_b128 v[44:47], v7 offset:45056
  v_mfma_f32_16x16x32_bf16 v[20:23], a[180:183], v[48:51], v[20:23]
  s_add_u32 s54, s79, s80
  v_mfma_f32_16x16x32_bf16 v[24:27], a[176:179], v[52:55], v[24:27]
  ds_read_b128 v[48:51], v6 offset:13312
  v_mfma_f32_16x16x32_bf16 v[28:31], a[180:183], v[52:55], v[28:31]
  buffer_load_dwordx4 v[104:107], v8, s[8:11], s54 offen offset:0 sc1
  s_waitcnt lgkmcnt(5)
  v_mfma_f32_16x16x32_bf16 v[16:19], a[184:187], v[56:59], v[16:19]
  ds_read_b128 v[52:55], v6 offset:46080
  v_mfma_f32_16x16x32_bf16 v[20:23], a[188:191], v[56:59], v[20:23]
  buffer_load_dwordx4 v[108:111], v8, s[8:11], s54 offen offset:1024 sc1
  v_mfma_f32_16x16x32_bf16 v[24:27], a[184:187], v[60:63], v[24:27]
  ds_read_b128 v[56:59], v7 offset:13312
  v_mfma_f32_16x16x32_bf16 v[28:31], a[188:191], v[60:63], v[28:31]
  buffer_load_dwordx4 v[112:115], v8, s[8:11], s54 offen offset:2048 sc1
  s_waitcnt lgkmcnt(5)
  v_mfma_f32_16x16x32_bf16 v[16:19], a[192:195], v[32:35], v[16:19]
  ds_read_b128 v[60:63], v7 offset:46080
  v_mfma_f32_16x16x32_bf16 v[20:23], a[196:199], v[32:35], v[20:23]
  buffer_load_dwordx4 v[116:119], v8, s[8:11], s54 offen offset:3072 sc1
  v_mfma_f32_16x16x32_bf16 v[24:27], a[192:195], v[36:39], v[24:27]
  ds_read_b128 v[32:35], v6 offset:14336
  v_mfma_f32_16x16x32_bf16 v[28:31], a[196:199], v[36:39], v[28:31]
  s_waitcnt lgkmcnt(5)
  v_mfma_f32_16x16x32_bf16 v[16:19], a[200:203], v[40:43], v[16:19]
  ds_read_b128 v[36:39], v6 offset:47104
  v_mfma_f32_16x16x32_bf16 v[20:23], a[204:207], v[40:43], v[20:23]
  v_mfma_f32_16x16x32_bf16 v[24:27], a[200:203], v[44:47], v[24:27]
  ds_read_b128 v[40:43], v7 offset:14336
  v_mfma_f32_16x16x32_bf16 v[28:31], a[204:207], v[44:47], v[28:31]
  s_waitcnt lgkmcnt(5)
  v_mfma_f32_16x16x32_bf16 v[16:19], a[208:211], v[48:51], v[16:19]
  ds_read_b128 v[44:47], v7 offset:47104
  v_mfma_f32_16x16x32_bf16 v[20:23], a[212:215], v[48:51], v[20:23]
  v_mfma_f32_16x16x32_bf16 v[24:27], a[208:211], v[52:55], v[24:27]
  ds_read_b128 v[48:51], v6 offset:15360
  v_mfma_f32_16x16x32_bf16 v[28:31], a[212:215], v[52:55], v[28:31]
  s_waitcnt lgkmcnt(5)
  v_mfma_f32_16x16x32_bf16 v[16:19], a[216:219], v[56:59], v[16:19]
  ds_read_b128 v[52:55], v6 offset:48128
  v_mfma_f32_16x16x32_bf16 v[20:23], a[220:223], v[56:59], v[20:23]
  s_cmp_le_u32 s55, s81
  s_cbranch_scc1 seen_41
  s_waitcnt vmcnt(12)
  v_min_u32_dpp v13, v13, v13 row_ror:1 row_mask:0xf bank_mask:0xf
  s_nop 1
  v_min_u32_dpp v13, v13, v13 row_ror:2 row_mask:0xf bank_mask:0xf
  s_nop 0
  v_readfirstlane_b32 s81, v13
  s_nop 3
  s_cmp_gt_u32 s55, s81
  s_cbranch_scc1 seen_41
  s_lshl_b32 s54, s42, 17
  s_add_u32 s54, s54, s75
  s_lshl_b32 s79, s42, 16
  s_add_u32 s79, s79, s76
  buffer_load_dwordx4 v[120:123], v8, s[8:11], s54 offen offset:0 sc1
  buffer_load_dwordx4 v[124:127], v8, s[8:11], s54 offen offset:1024 sc1
  buffer_load_dwordx4 v[128:131], v8, s[8:11], s54 offen offset:2048 sc1
  buffer_load_dwordx4 v[132:135], v8, s[8:11], s54 offen offset:3072 sc1
  buffer_load_dword v136, v206, s[8:11], s79 offen offset:0 sc1
  buffer_load_dword v137, v206, s[8:11], s79 offen offset:256 sc1
  buffer_load_dword v138, v206, s[8:11], s79 offen offset:512 sc1
  buffer_load_dword v139, v206, s[8:11], s79 offen offset:768 sc1
seen_41:
  v_mfma_f32_16x16x32_bf16 v[24:27], a[216:219], v[60:63], v[24:27]
  ds_read_b128 v[56:59], v7 offset:15360
  v_mfma_f32_16x16x32_bf16 v[28:31], a[220:223], v[60:63], v[28:31]
  s_waitcnt lgkmcnt(5)
  v_mfma_f32_16x16x32_bf16 v[16:19], a[224:227], v[32:35], v[16:19]
  ds_read_b128 v[60:63], v7 offset:48128
  v_mfma_f32_16x16x32_bf16 v[20:23], a[228:231], v[32:35], v[20:23]
  v_mfma_f32_16x16x32_bf16 v[24:27], a[224:227], v[36:39], v[24:27]
  v_mfma_f32_16x16x32_bf16 v[28:31], a[228:231], v[36:39], v[28:31]
  s_waitcnt lgkmcnt(4)
  v_mfma_f32_16x16x32_bf16 v[16:19], a[232:235], v[40:43], v[16:19]
  v_mfma_f32_16x16x32_bf16 v[20:23], a[236:239], v[40:43], v[20:23]
  v_mfma_f32_16x16x32_bf16 v[24:27], a[232:235], v[44:47], v[24:27]
  v_mfma_f32_16x16x32_bf16 v[28:31], a[236:239], v[44:47], v[28:31]
  s_waitcnt lgkmcnt(2)
  v_mfma_f32_16x16x32_bf16 v[16:19], a[240:243], v[48:51], v[16:19]
  v_mfma_f32_16x16x32_bf16 v[20:23], a[244:247], v[48:51], v[20:23]
  v_mfma_f32_16x16x32_bf16 v[24:27], a[240:243], v[52:55], v[24:27]
  v_mfma_f32_16x16x32_bf16 v[28:31], a[244:247], v[52:55], v[28:31]
  s_waitcnt lgkmcnt(0)
  v_mfma_f32_16x16x32_bf16 v[16:19], a[248:251], v[56:59], v[16:19]
  v_mfma_f32_16x16x32_bf16 v[20:23], a[252:255], v[56:59], v[20:23]
  v_mfma_f32_16x16x32_bf16 v[24:27], a[248:251], v[60:63], v[24:27]
  v_mfma_f32_16x16x32_bf16 v[28:31], a[252:255], v[60:63], v[28:31]
  s_nop 4
  v_cvt_pk_bf16_f32 v64, v16, v17
  v_cvt_pk_bf16_f32 v65, v18, v19
  v_cvt_pk_bf16_f32 v66, v20, v21
  v_cvt_pk_bf16_f32 v67, v22, v23
  ds_write_b128 v207, v[64:67] offset:0
  v_cvt_pk_bf16_f32 v68, v24, v25
  v_cvt_pk_bf16_f32 v69, v26, v27
  v_cvt_pk_bf16_f32 v70, v28, v29
  v_cvt_pk_bf16_f32 v71, v30, v31
  ds_write_b128 v207, v[68:71] offset:4096
  v_xor_b32 v207, 0x2000, v207
  v_xor_b32 v6, 0x10000, v6
  v_xor_b32 v7, 0x10000, v7
  s_branch L_QA_att
L_QA_nogemm:
  s_lshl_b32 s79, s42, 18
  s_add_u32 s79, s79, s74
  s_add_u32 s54, s79, 16777216
  buffer_load_dwordx4 v[72:75], v8, s[8:11], s54 offen offset:0 sc1
  buffer_load_dwordx4 v[76:79], v8, s[8:11], s54 offen offset:1024 sc1
  buffer_load_dwordx4 v[80:83], v8, s[8:11], s54 offen offset:2048 sc1
  buffer_load_dwordx4 v[84:87], v8, s[8:11], s54 offen offset:3072 sc1
  s_add_u32 s54, s54, 4096
  buffer_load_dwordx4 v[88:91], v8, s[8:11], s54 offen offset:0 sc1
  buffer_load_dwordx4 v[92:95], v8, s[8:11], s54 offen offset:1024 sc1
  buffer_load_dwordx4 v[96:99], v8, s[8:11], s54 offen offset:2048 sc1
  buffer_load_dwordx4 v[100:103], v8, s[8:11], s54 offen offset:3072 sc1
  s_add_u32 s54, s79, s80
  buffer_load_dwordx4 v[104:107], v8, s[8:11], s54 offen offset:0 sc1
  buffer_load_dwordx4 v[108:111], v8, s[8:11], s54 offen offset:1024 sc1
  buffer_load_dwordx4 v[112:115], v8, s[8:11], s54 offen offset:2048 sc1
  buffer_load_dwordx4 v[116:119], v8, s[8:11], s54 offen offset:3072 sc1
  s_waitcnt vmcnt(12)
  s_barrier
  s_cmp_eq_u32 s42, 0
  s_cbranch_scc1 fp_42
  s_cmp_lg_u32 s30, 0
  s_cbranch_scc1 w0_43
  s_mov_b64 s[96:97], exec
  s_mov_b64 exec, 1
  v_mov_b32 v10, s52
  v_mov_b32 v11, s42
  buffer_store_dword v11, v10, s[8:11], 0 offen sc1
  s_mov_b64 exec, s[96:97]
w0_43:
fp_42:
L_QA_att:
  ds_read_b128 v[140:143], v208 offset:0
  ds_read_b128 v[144:147], v208 offset:1024
  ds_read_b128 v[148:151], v208 offset:2048
  ds_read_b128 v[152:155], v208 offset:3072
  s_waitcnt vmcnt(0) lgkmcnt(0)
  v_xor_b32 v208, 0x2000, v208
  v_mfma_f32_16x16x32_bf16 v[156:159], v[72:75], v[140:143], 0
  v_mfma_f32_16x16x32_bf16 v[156:159], v[76:79], v[144:147], v[156:159]
  v_mfma_f32_16x16x32_bf16 v[156:159], v[80:83], v[148:151], v[156:159]
  v_mfma_f32_16x16x32_bf16 v[156:159], v[84:87], v[152:155], v[156:159]
  v_mfma_f32_16x16x32_bf16 v[160:163], v[88:91], v[140:143], 0
  v_mfma_f32_16x16x32_bf16 v[160:163], v[92:95], v[144:147], v[160:163]
  v_mfma_f32_16x16x32_bf16 v[160:163], v[96:99], v[148:151], v[160:163]
  v_mfma_f32_16x16x32_bf16 v[160:163], v[100:103], v[152:155], v[160:163]
  s_cmp_le_u32 s55, s81
  s_cbranch_scc1 have_44
  s_mov_b32 s32, 0
wf_45:
  buffer_load_dword v10, v205, s[8:11], 0 offen sc1
  s_waitcnt vmcnt(0)
  v_cmp_gt_u32 vcc, s55, v10
  s_cbranch_vccz wfd_46
  s_add_u32 s32, s32, 1
  s_cmp_lt_u32 s32, s31
  s_cbranch_scc1 wf_45
  s_mov_b32 s31, 0
wfd_46:
  s_lshl_b32 s54, s42, 17
  s_add_u32 s54, s54, s75
  s_lshl_b32 s79, s42, 16
  s_add_u32 s79, s79, s76
  buffer_load_dwordx4 v[120:123], v8, s[8:11], s54 offen offset:0 sc1
  buffer_load_dwordx4 v[124:127], v8, s[8:11], s54 offen offset:1024 sc1
  buffer_load_dwordx4 v[128:131], v8, s[8:11], s54 offen offset:2048 sc1
  buffer_load_dwordx4 v[132:135], v8, s[8:11], s54 offen offset:3072 sc1
  buffer_load_dword v136, v206, s[8:11], s79 offen offset:0 sc1
  buffer_load_dword v137, v206, s[8:11], s79 offen offset:256 sc1
  buffer_load_dword v138, v206, s[8:11], s79 offen offset:512 sc1
  buffer_load_dword v139, v206, s[8:11], s79 offen offset:768 sc1
  v_min_u32_dpp v10, v10, v10 row_ror:1 row_mask:0xf bank_mask:0xf
  s_nop 1
  v_min_u32_dpp v10, v10, v10 row_ror:2 row_mask:0xf bank_mask:0xf
  s_nop 0
  v_readfirstlane_b32 s81, v10
  s_nop 3
have_44:
  v_cndmask_b32 v156, v209, v156, s[56:57]
  v_cndmask_b32 v160, v209, v160, s[64:65]
  v_cndmask_b32 v157, v209, v157, s[58:59]
  v_cndmask_b32 v161, v209, v161, s[66:67]
  v_cndmask_b32 v158, v209, v158, s[60:61]
  v_cndmask_b32 v162, v209, v162, s[68:69]
  v_cndmask_b32 v159, v209, v159, s[62:63]
  v_cndmask_b32 v163, v209, v163, s[70:71]
  v_max3_f32 v200, v156, v157, v158
  v_max3_f32 v200, v200, v159, v160
  v_max3_f32 v200, v200, v161, v162
  v_max_f32 v200, v200, v163
  s_waitcnt vmcnt(7)
  v_mfma_f32_16x16x32_bf16 v[164:167], v[120:123], v[140:143], 0
  s_waitcnt vmcnt(6)
  v_mfma_f32_16x16x32_bf16 v[164:167], v[124:127], v[144:147], v[164:167]
  s_waitcnt vmcnt(5)
  v_mfma_f32_16x16x32_bf16 v[164:167], v[128:131], v[148:151], v[164:167]
  s_waitcnt vmcnt(4)
  v_mfma_f32_16x16x32_bf16 v[164:167], v[132:135], v[152:155], v[164:167]
  s_lshl_b32 s79, s42, 18
  s_add_u32 s79, s79, s77
  s_add_u32 s54, s79, 16384
  s_nop 4
  v_cndmask_b32 v164, v164, v166, s[82:83]
  v_cndmask_b32 v165, v165, v167, s[82:83]
  v_max3_f32 v200, v200, v164, v165
  v_mov_b32 v10, v200
  s_nop 1
  v_permlane16_swap_b32 v200, v10
  v_max_f32 v200, v200, v10
  v_mov_b32 v10, v200
  s_nop 1
  v_permlane32_swap_b32 v200, v10
  v_max_f32 v200, v200, v10
  v_mul_f32 v200, s73, v200
  v_fma_f32 v156, v156, s73, -v200
  v_fma_f32 v157, v157, s73, -v200
  v_fma_f32 v158, v158, s73, -v200
  v_fma_f32 v159, v159, s73, -v200
  v_fma_f32 v160, v160, s73, -v200
  v_fma_f32 v161, v161, s73, -v200
  v_fma_f32 v162, v162, s73, -v200
  v_fma_f32 v163, v163, s73, -v200
  v_fma_f32 v164, v164, s73, -v200
  v_fma_f32 v165, v165, s73, -v200
  v_exp_f32 v156, v156
  v_exp_f32 v157, v157
  v_exp_f32 v158, v158
  v_exp_f32 v159, v159
  v_exp_f32 v160, v160
  v_exp_f32 v161, v161
  v_exp_f32 v162, v162
  v_exp_f32 v163, v163
  v_exp_f32 v164, v164
  v_exp_f32 v165, v165
  v_cvt_pk_bf16_f32 v172, v156, v157
  v_cvt_pk_bf16_f32 v173, v158, v159
  v_cvt_pk_bf16_f32 v174, v160, v161
  v_cvt_pk_bf16_f32 v175, v162, v163
  v_cvt_pk_bf16_f32 v176, v164, v165
  v_cvt_pk_bf16_f32 v179, v164, v165
  s_waitcnt vmcnt(0)
  v_mfma_f32_16x16x32_bf16 v[180:183], v[168:171], v[172:175], 0
  v_mfma_f32_16x16x32_bf16 v[184:187], v[104:107], v[172:175], 0
  v_mfma_f32_16x16x32_bf16 v[188:191], v[108:111], v[172:175], 0
  v_mfma_f32_16x16x32_bf16 v[192:195], v[112:115], v[172:175], 0
  v_mfma_f32_16x16x32_bf16 v[196:199], v[116:119], v[172:175], 0
  s_nop 3
  v_mfma_f32_16x16x16_bf16 v[180:183], v[168:169], v[176:177], v[180:183]
  v_mfma_f32_16x16x16_bf16 v[184:187], v[136:137], v[176:177], v[184:187]
  v_mfma_f32_16x16x16_bf16 v[188:191], v[136:137], v[178:179], v[188:191]
  v_mfma_f32_16x16x16_bf16 v[192:195], v[138:139], v[176:177], v[192:195]
  v_mfma_f32_16x16x16_bf16 v[196:199], v[138:139], v[178:179], v[196:199]
  s_nop 3
  v_rcp_f32 v202, v180
  s_nop 0
  v_pk_mul_f32 v[184:185], v[184:185], v[202:203] op_sel:[0,0] op_sel_hi:[1,0]
  v_pk_mul_f32 v[186:187], v[186:187], v[202:203] op_sel:[0,0] op_sel_hi:[1,0]
  v_pk_mul_f32 v[188:189], v[188:189], v[202:203] op_sel:[0,0] op_sel_hi:[1,0]
  v_pk_mul_f32 v[190:191], v[190:191], v[202:203] op_sel:[0,0] op_sel_hi:[1,0]
  v_cvt_pk_bf16_f32 v184, v184, v185
  v_cvt_pk_bf16_f32 v185, v186, v187
  v_cvt_pk_bf16_f32 v186, v188, v189
  v_cvt_pk_bf16_f32 v187, v190, v191
  buffer_store_dwordx4 v[184:187], v8, s[8:11], s79 offen sc1
  v_pk_mul_f32 v[192:193], v[192:193], v[202:203] op_sel:[0,0] op_sel_hi:[1,0]
  v_pk_mul_f32 v[194:195], v[194:195], v[202:203] op_sel:[0,0] op_sel_hi:[1,0]
  v_pk_mul_f32 v[196:197], v[196:197], v[202:203] op_sel:[0,0] op_sel_hi:[1,0]
  v_pk_mul_f32 v[198:199], v[198:199], v[202:203] op_sel:[0,0] op_sel_hi:[1,0]
  v_cvt_pk_bf16_f32 v192, v192, v193
  v_cvt_pk_bf16_f32 v193, v194, v195
  v_cvt_pk_bf16_f32 v194, v196, v197
  v_cvt_pk_bf16_f32 v195, v198, v199
  buffer_store_dwordx4 v[192:195], v8, s[8:11], s54 offen sc1
  s_add_u32 s42, s42, 1
  s_cmp_lt_u32 s42, 64
  s_cbranch_scc1 L_QA_loop
  s_waitcnt vmcnt(0)
  s_barrier
  s_cmp_lg_u32 s30, 0
  s_cbranch_scc1 w0_47
  s_mov_b64 s[96:97], exec
  s_mov_b64 exec, 1
  v_mov_b32 v10, s52
  v_mov_b32 v11, 64
  buffer_store_dword v11, v10, s[8:11], 0 offen sc1
  s_mov_b64 exec, s[96:97]
w0_47:
  s_endpgm
L_role_F1:
  s_load_dwordx2 s[4:5], s[0:1], 0
  s_waitcnt lgkmcnt(0)
  s_mov_b32 s16, s4
  s_mov_b32 s17, s5
  s_mov_b32 s18, 4194304
  s_mov_b32 s19, 0x20000
  s_load_dwordx2 s[4:5], s[0:1], 64
  s_waitcnt lgkmcnt(0)
  s_mov_b32 s20, s4
  s_mov_b32 s21, s5
  s_mov_b32 s22, 7340032
  s_mov_b32 s23, 0x20000
  s_cmp_lg_u32 s30, 0
  s_cbranch_scc1 w0_48
  s_lshl_b32 s33, s29, 7
  s_add_u32 s33, s33, 12288
  s_mov_b64 s[96:97], exec
  s_mov_b64 exec, 1
  v_mov_b32 v10, s33
  v_mov_b32 v11, 0
  buffer_store_dword v11, v10, s[8:11], 0 offen sc1
  s_mov_b64 exec, s[96:97]
w0_48:
  s_lshl_b32 s52, s29, 7
  s_add_u32 s52, s52, 12288
  s_mov_b32 s41, 28672
  s_mul_i32 s33, s29, 37
  s_lshr_b32 s33, s33, 8
  s_mul_i32 s34, s33, 7
  s_sub_u32 s34, s29, s34
  s_lshl_b32 s49, s33, 16
  s_lshl_b32 s34, s34, 11
  s_add_u32 s49, s49, s34
  s_and_b32 s34, s30, 1
  s_lshl_b32 s34, s34, 14
  s_add_u32 s49, s49, s34
  s_lshr_b32 s34, s30, 1
  s_lshl_b32 s34, s34, 10
  s_add_u32 s49, s49, s34
  s_add_u32 s49, s49, 67108864
  s_mov_b32 s50, 32768
  v_lshrrev_b32 v10, 4, v1
  v_and_b32 v11, 15, v1
  s_lshr_b32 s33, s41, 2
  v_mul_lo_u32 v2, v10, s33
  v_lshlrev_b32 v12, 2, v10
  v_xor_b32 v12, v12, v11
  v_lshl_add_u32 v2, v12, 4, v2
  v_bfe_u32 v12, v1, 2, 2
  v_lshl_add_u32 v13, v10, 3, v12
  v_lshlrev_b32 v3, 8, v13
  v_and_b32 v13, 3, v1
  s_lshl_b32 s33, s30, 2
  v_add_u32 v13, s33, v13
  v_lshlrev_b32 v12, 2, v12
  v_xor_b32 v13, v13, v12
  v_lshl_add_u32 v3, v13, 4, v3
  v_add_u32 v4, 0x10000, v3
  v_lshlrev_b32 v8, 4, v1
  v_lshrrev_b32 v12, 3, v1
  v_and_b32 v13, 7, v1
  v_xor_b32 v13, v13, v12
  v_lshlrev_b32 v5, 11, v12
  v_lshl_add_u32 v5, v13, 4, v5
  v_and_b32 v12, 7, v1
  v_bfe_u32 v13, v1, 3, 1
  v_lshlrev_b32 v6, 14, v13
  v_lshl_add_u32 v6, v12, 7, v6
  v_xor_b32 v13, v10, v12
  v_lshl_add_u32 v6, v13, 4, v6
  v_xor_b32 v7, 64, v6
  s_lshl_b32 s40, s29, 8
  s_waitcnt vmcnt(0)
  s_barrier
  s_cmp_lg_u32 s30, 0
  s_cbranch_scc1 ar_49
  s_mov_b64 s[96:97], exec
  s_mov_b64 exec, 1
  v_mov_b32 v10, 64
  v_mov_b32 v11, 1
  buffer_atomic_add v11, v10, s[12:15], 0 offen
  s_mov_b64 exec, s[96:97]
ar_49:
  s_cmp_lg_u32 s30, 0
  s_cbranch_scc1 w0_51
  v_mov_b32 v10, 64
  s_mov_b32 s32, 0
wf_52:
  buffer_load_dword v11, v10, s[12:15], 0 offen sc1
  s_waitcnt vmcnt(0)
  v_cmp_gt_u32 vcc, 256, v11
  s_cbranch_vccz wfd_53
  s_sleep 24
  s_add_u32 s32, s32, 1
  s_cmp_lt_u32 s32, s31
  s_cbranch_scc1 wf_52
  s_mov_b32 s31, 0
wfd_53:
w0_51:
  s_barrier
  s_lshl_b32 s33, s41, 3
  s_mul_i32 s33, s33, s30
  s_add_u32 s40, s40, s33
  s_mul_i32 s34, s41, 24
  s_lshl_b32 s35, s30, 13
  v_add_u32 v13, s35, v8
  buffer_load_dwordx4 a[0:3], v2, s[20:23], s40 offen nt
  s_add_u32 s40, s40, s41
  buffer_load_dwordx4 a[4:7], v2, s[20:23], s40 offen nt
  s_add_u32 s40, s40, s41
  buffer_load_dwordx4 a[8:11], v2, s[20:23], s40 offen nt
  s_add_u32 s40, s40, s41
  buffer_load_dwordx4 a[12:15], v2, s[20:23], s40 offen nt
  s_add_u32 s40, s40, s41
  buffer_load_dwordx4 a[16:19], v2, s[20:23], s40 offen nt
  s_add_u32 s40, s40, s41
  buffer_load_dwordx4 a[20:23], v2, s[20:23], s40 offen nt
  s_add_u32 s40, s40, s41
  buffer_load_dwordx4 a[24:27], v2, s[20:23], s40 offen nt
  s_add_u32 s40, s40, s41
  buffer_load_dwordx4 a[28:31], v2, s[20:23], s40 offen nt
  s_add_u32 s40, s40, s41
  s_add_u32 s40, s40, s34
  buffer_load_dwordx4 a[32:35], v2, s[20:23], s40 offen nt
  s_add_u32 s40, s40, s41
  buffer_load_dwordx4 a[36:39], v2, s[20:23], s40 offen nt
  s_add_u32 s40, s40, s41
  buffer_load_dwordx4 a[40:43], v2, s[20:23], s40 offen nt
  s_add_u32 s40, s40, s41
  buffer_load_dwordx4 a[44:47], v2, s[20:23], s40 offen nt
  s_add_u32 s40, s40, s41
  buffer_load_dwordx4 a[48:51], v2, s[20:23], s40 offen nt
  s_add_u32 s40, s40, s41
  buffer_load_dwordx4 a[52:55], v2, s[20:23], s40 offen nt
  s_add_u32 s40, s40, s41
  buffer_load_dwordx4 a[56:59], v2, s[20:23], s40 offen nt
  s_add_u32 s40, s40, s41
  buffer_load_dwordx4 a[60:63], v2, s[20:23], s40 offen nt
  s_add_u32 s40, s40, s41
  s_add_u32 s40, s40, s34
  buffer_load_dwordx4 a[64:67], v2, s[20:23], s40 offen nt
  s_add_u32 s40, s40, s41
  buffer_load_dwordx4 a[68:71], v2, s[20:23], s40 offen nt
  s_add_u32 s40, s40, s41
  buffer_load_dwordx4 a[72:75], v2, s[20:23], s40 offen nt
  s_add_u32 s40, s40, s41
  buffer_load_dwordx4 a[76:79], v2, s[20:23], s40 offen nt
  s_add_u32 s40, s40, s41
  buffer_load_dwordx4 a[80:83], v2, s[20:23], s40 offen nt
  s_add_u32 s40, s40, s41
  buffer_load_dwordx4 a[84:87], v2, s[20:23], s40 offen nt
  s_add_u32 s40, s40, s41
  buffer_load_dwordx4 a[88:91], v2, s[20:23], s40 offen nt
  s_add_u32 s40, s40, s41
  buffer_load_dwordx4 a[92:95], v2, s[20:23], s40 offen nt
  s_add_u32 s40, s40, s41
  s_add_u32 s40, s40, s34
  buffer_load_dwordx4 a[96:99], v2, s[20:23], s40 offen nt
  s_add_u32 s40, s40, s41
  buffer_load_dwordx4 a[100:103], v2, s[20:23], s40 offen nt
  s_add_u32 s40, s40, s41
  buffer_load_dwordx4 a[104:107], v2, s[20:23], s40 offen nt
  s_add_u32 s40, s40, s41
  buffer_load_dwordx4 a[108:111], v2, s[20:23], s40 offen nt
  s_add_u32 s40, s40, s41
  buffer_load_dwordx4 a[112:115], v2, s[20:23], s40 offen nt
  s_add_u32 s40, s40, s41
  buffer_load_dwordx4 a[116:119], v2, s[20:23], s40 offen nt
  s_add_u32 s40, s40, s41
  buffer_load_dwordx4 a[120:123], v2, s[20:23], s40 offen nt
  s_add_u32 s40, s40, s41
  buffer_load_dwordx4 a[124:127], v2, s[20:23], s40 offen nt
  s_add_u32 s40, s40, s41
  s_add_u32 s40, s40, s34
  buffer_load_dwordx4 a[128:131], v2, s[20:23], s40 offen nt
  s_add_u32 s40, s40, s41
  buffer_load_dwordx4 a[132:135], v2, s[20:23], s40 offen nt
  s_add_u32 s40, s40, s41
  buffer_load_dwordx4 a[136:139], v2, s[20:23], s40 offen nt
  s_add_u32 s40, s40, s41
  buffer_load_dwordx4 a[140:143], v2, s[20:23], s40 offen nt
  s_add_u32 s40, s40, s41
  buffer_load_dwordx4 a[144:147], v2, s[20:23], s40 offen nt
  s_add_u32 s40, s40, s41
  buffer_load_dwordx4 a[148:151], v2, s[20:23], s40 offen nt
  s_add_u32 s40, s40, s41
  buffer_load_dwordx4 a[152:155], v2, s[20:23], s40 offen nt
  s_add_u32 s40, s40, s41
  buffer_load_dwordx4 a[156:159], v2, s[20:23], s40 offen nt
  s_add_u32 s40, s40, s41
  s_add_u32 s40, s40, s34
  buffer_load_dwordx4 a[160:163], v2, s[20:23], s40 offen nt
  s_add_u32 s40, s40, s41
  buffer_load_dwordx4 a[164:167], v2, s[20:23], s40 offen nt
  s_add_u32 s40, s40, s41
  buffer_load_dwordx4 a[168:171], v2, s[20:23], s40 offen nt
  s_add_u32 s40, s40, s41
  buffer_load_dwordx4 a[172:175], v2, s[20:23], s40 offen nt
  s_add_u32 s40, s40, s41
  buffer_load_dwordx4 a[176:179], v2, s[20:23], s40 offen nt
  s_add_u32 s40, s40, s41
  buffer_load_dwordx4 a[180:183], v2, s[20:23], s40 offen nt
  s_add_u32 s40, s40, s41
  buffer_load_dwordx4 a[184:187], v2, s[20:23], s40 offen nt
  s_add_u32 s40, s40, s41
  buffer_load_dwordx4 a[188:191], v2, s[20:23], s40 offen nt
  s_add_u32 s40, s40, s41
  s_add_u32 s40, s40, s34
  buffer_load_dwordx4 a[192:195], v2, s[20:23], s40 offen nt
  s_add_u32 s40, s40, s41
  buffer_load_dwordx4 a[196:199], v2, s[20:23], s40 offen nt
  s_add_u32 s40, s40, s41
  buffer_load_dwordx4 a[200:203], v2, s[20:23], s40 offen nt
  s_add_u32 s40, s40, s41
  buffer_load_dwordx4 a[204:207], v2, s[20:23], s40 offen nt
  s_add_u32 s40, s40, s41
  buffer_load_dwordx4 a[208:211], v2, s[20:23], s40 offen nt
  s_add_u32 s40, s40, s41
  buffer_load_dwordx4 a[212:215], v2, s[20:23], s40 offen nt
  s_add_u32 s40, s40, s41
  buffer_load_dwordx4 a[216:219], v2, s[20:23], s40 offen nt
  s_add_u32 s40, s40, s41
  buffer_load_dwordx4 a[220:223], v2, s[20:23], s40 offen nt
  s_add_u32 s40, s40, s41
  s_add_u32 s40, s40, s34
  s_waitcnt vmcnt(48)
  ds_write_b128 v13, a[0:3] offset:0
  ds_write_b128 v13, a[4:7] offset:1024
  ds_write_b128 v13, a[8:11] offset:2048
  ds_write_b128 v13, a[12:15] offset:3072
  ds_write_b128 v13, a[16:19] offset:4096
  ds_write_b128 v13, a[20:23] offset:5120
  ds_write_b128 v13, a[24:27] offset:6144
  ds_write_b128 v13, a[28:31] offset:7168
  s_waitcnt lgkmcnt(0)
  s_barrier
  ds_read_b64_tr_b16 a[0:1], v3 offset:0
  ds_read_b64_tr_b16 a[2:3], v3 offset:1024
  ds_read_b64_tr_b16 a[4:5], v3 offset:8
  ds_read_b64_tr_b16 a[6:7], v3 offset:1032
  ds_read_b64_tr_b16 a[8:9], v3 offset:8192
  ds_read_b64_tr_b16 a[10:11], v3 offset:9216
  ds_read_b64_tr_b16 a[12:13], v3 offset:8200
  ds_read_b64_tr_b16 a[14:15], v3 offset:9224
  ds_read_b64_tr_b16 a[16:17], v3 offset:16384
  ds_read_b64_tr_b16 a[18:19], v3 offset:17408
  ds_read_b64_tr_b16 a[20:21], v3 offset:16392
  ds_read_b64_tr_b16 a[22:23], v3 offset:17416
  ds_read_b64_tr_b16 a[24:25], v3 offset:24576
  ds_read_b64_tr_b16 a[26:27], v3 offset:25600
  ds_read_b64_tr_b16 a[28:29], v3 offset:24584
  ds_read_b64_tr_b16 a[30:31], v3 offset:25608
  s_waitcnt lgkmcnt(0)
  buffer_load_dwordx4 a[224:227], v2, s[20:23], s40 offen nt
  s_add_u32 s40, s40, s41
  buffer_load_dwordx4 a[228:231], v2, s[20:23], s40 offen nt
  s_add_u32 s40, s40, s41
  buffer_load_dwordx4 a[232:235], v2, s[20:23], s40 offen nt
  s_add_u32 s40, s40, s41
  buffer_load_dwordx4 a[236:239], v2, s[20:23], s40 offen nt
  s_add_u32 s40, s40, s41
  buffer_load_dwordx4 a[240:243], v2, s[20:23], s40 offen nt
  s_add_u32 s40, s40, s41
  buffer_load_dwordx4 a[244:247], v2, s[20:23], s40 offen nt
  s_add_u32 s40, s40, s41
  buffer_load_dwordx4 a[248:251], v2, s[20:23], s40 offen nt
  s_add_u32 s40, s40, s41
  buffer_load_dwordx4 a[252:255], v2, s[20:23], s40 offen nt
  s_add_u32 s40, s40, s41
  s_add_u32 s40, s40, s34
  s_waitcnt vmcnt(48)
  ds_write_b128 v13, a[32:35] offset:32768
  ds_write_b128 v13, a[36:39] offset:33792
  ds_write_b128 v13, a[40:43] offset:34816
  ds_write_b128 v13, a[44:47] offset:35840
  ds_write_b128 v13, a[48:51] offset:36864
  ds_write_b128 v13, a[52:55] offset:37888
  ds_write_b128 v13, a[56:59] offset:38912
  ds_write_b128 v13, a[60:63] offset:39936
  s_waitcnt lgkmcnt(0)
  s_barrier
  ds_read_b64_tr_b16 a[32:33], v3 offset:32768
  ds_read_b64_tr_b16 a[34:35], v3 offset:33792
  ds_read_b64_tr_b16 a[36:37], v3 offset:32776
  ds_read_b64_tr_b16 a[38:39], v3 offset:33800
  ds_read_b64_tr_b16 a[40:41], v3 offset:40960
  ds_read_b64_tr_b16 a[42:43], v3 offset:41984
  ds_read_b64_tr_b16 a[44:45], v3 offset:40968
  ds_read_b64_tr_b16 a[46:47], v3 offset:41992
  ds_read_b64_tr_b16 a[48:49], v3 offset:49152
  ds_read_b64_tr_b16 a[50:51], v3 offset:50176
  ds_read_b64_tr_b16 a[52:53], v3 offset:49160
  ds_read_b64_tr_b16 a[54:55], v3 offset:50184
  ds_read_b64_tr_b16 a[56:57], v3 offset:57344
  ds_read_b64_tr_b16 a[58:59], v3 offset:58368
  ds_read_b64_tr_b16 a[60:61], v3 offset:57352
  ds_read_b64_tr_b16 a[62:63], v3 offset:58376
  s_waitcnt lgkmcnt(0)
  s_waitcnt vmcnt(40)
  ds_write_b128 v13, a[64:67] offset:0
  ds_write_b128 v13, a[68:71] offset:1024
  ds_write_b128 v13, a[72:75] offset:2048
  ds_write_b128 v13, a[76:79] offset:3072
  ds_write_b128 v13, a[80:83] offset:4096
  ds_write_b128 v13, a[84:87] offset:5120
  ds_write_b128 v13, a[88:91] offset:6144
  ds_write_b128 v13, a[92:95] offset:7168
  s_waitcnt lgkmcnt(0)
  s_barrier
  ds_read_b64_tr_b16 a[64:65], v3 offset:0
  ds_read_b64_tr_b16 a[66:67], v3 offset:1024
  ds_read_b64_tr_b16 a[68:69], v3 offset:8
  ds_read_b64_tr_b16 a[70:71], v3 offset:1032
  ds_read_b64_tr_b16 a[72:73], v3 offset:8192
  ds_read_b64_tr_b16 a[74:75], v3 offset:9216
  ds_read_b64_tr_b16 a[76:77], v3 offset:8200
  ds_read_b64_tr_b16 a[78:79], v3 offset:9224
  ds_read_b64_tr_b16 a[80:81], v3 offset:16384
  ds_read_b64_tr_b16 a[82:83], v3 offset:17408
  ds_read_b64_tr_b16 a[84:85], v3 offset:16392
  ds_read_b64_tr_b16 a[86:87], v3 offset:17416
  ds_read_b64_tr_b16 a[88:89], v3 offset:24576
  ds_read_b64_tr_b16 a[90:91], v3 offset:25600
  ds_read_b64_tr_b16 a[92:93], v3 offset:24584
  ds_read_b64_tr_b16 a[94:95], v3 offset:25608
  s_waitcnt lgkmcnt(0)
  s_waitcnt vmcnt(32)
  ds_write_b128 v13, a[96:99] offset:32768
  ds_write_b128 v13, a[100:103] offset:33792
  ds_write_b128 v13, a[104:107] offset:34816
  ds_write_b128 v13, a[108:111] offset:35840
  ds_write_b128 v13, a[112:115] offset:36864
  ds_write_b128 v13, a[116:119] offset:37888
  ds_write_b128 v13, a[120:123] offset:38912
  ds_write_b128 v13, a[124:127] offset:39936
  s_waitcnt lgkmcnt(0)
  s_barrier
  ds_read_b64_tr_b16 a[96:97], v3 offset:32768
  ds_read_b64_tr_b16 a[98:99], v3 offset:33792
  ds_read_b64_tr_b16 a[100:101], v3 offset:32776
  ds_read_b64_tr_b16 a[102:103], v3 offset:33800
  ds_read_b64_tr_b16 a[104:105], v3 offset:40960
  ds_read_b64_tr_b16 a[106:107], v3 offset:41984
  ds_read_b64_tr_b16 a[108:109], v3 offset:40968
  ds_read_b64_tr_b16 a[110:111], v3 offset:41992
  ds_read_b64_tr_b16 a[112:113], v3 offset:49152
  ds_read_b64_tr_b16 a[114:115], v3 offset:50176
  ds_read_b64_tr_b16 a[116:117], v3 offset:49160
  ds_read_b64_tr_b16 a[118:119], v3 offset:50184
  ds_read_b64_tr_b16 a[120:121], v3 offset:57344
  ds_read_b64_tr_b16 a[122:123], v3 offset:58368
  ds_read_b64_tr_b16 a[124:125], v3 offset:57352
  ds_read_b64_tr_b16 a[126:127], v3 offset:58376
  s_waitcnt lgkmcnt(0)
  s_waitcnt vmcnt(24)
  ds_write_b128 v13, a[128:131] offset:0
  ds_write_b128 v13, a[132:135] offset:1024
  ds_write_b128 v13, a[136:139] offset:2048
  ds_write_b128 v13, a[140:143] offset:3072
  ds_write_b128 v13, a[144:147] offset:4096
  ds_write_b128 v13, a[148:151] offset:5120
  ds_write_b128 v13, a[152:155] offset:6144
  ds_write_b128 v13, a[156:159] offset:7168
  s_waitcnt lgkmcnt(0)
  s_barrier
  ds_read_b64_tr_b16 a[128:129], v3 offset:0
  ds_read_b64_tr_b16 a[130:131], v3 offset:1024
  ds_read_b64_tr_b16 a[132:133], v3 offset:8
  ds_read_b64_tr_b16 a[134:135], v3 offset:1032
  ds_read_b64_tr_b16 a[136:137], v3 offset:8192
  ds_read_b64_tr_b16 a[138:139], v3 offset:9216
  ds_read_b64_tr_b16 a[140:141], v3 offset:8200
  ds_read_b64_tr_b16 a[142:143], v3 offset:9224
  ds_read_b64_tr_b16 a[144:145], v3 offset:16384
  ds_read_b64_tr_b16 a[146:147], v3 offset:17408
  ds_read_b64_tr_b16 a[148:149], v3 offset:16392
  ds_read_b64_tr_b16 a[150:151], v3 offset:17416
  ds_read_b64_tr_b16 a[152:153], v3 offset:24576
  ds_read_b64_tr_b16 a[154:155], v3 offset:25600
  ds_read_b64_tr_b16 a[156:157], v3 offset:24584
  ds_read_b64_tr_b16 a[158:159], v3 offset:25608
  s_waitcnt lgkmcnt(0)
  s_waitcnt vmcnt(16)
  ds_write_b128 v13, a[160:163] offset:32768
  ds_write_b128 v13, a[164:167] offset:33792
  ds_write_b128 v13, a[168:171] offset:34816
  ds_write_b128 v13, a[172:175] offset:35840
  ds_write_b128 v13, a[176:179] offset:36864
  ds_write_b128 v13, a[180:183] offset:37888
  ds_write_b128 v13, a[184:187] offset:38912
  ds_write_b128 v13, a[188:191] offset:39936
  s_waitcnt lgkmcnt(0)
  s_barrier
  ds_read_b64_tr_b16 a[160:161], v3 offset:32768
  ds_read_b64_tr_b16 a[162:163], v3 offset:33792
  ds_read_b64_tr_b16 a[164:165], v3 offset:32776
  ds_read_b64_tr_b16 a[166:167], v3 offset:33800
  ds_read_b64_tr_b16 a[168:169], v3 offset:40960
  ds_read_b64_tr_b16 a[170:171], v3 offset:41984
  ds_read_b64_tr_b16 a[172:173], v3 offset:40968
  ds_read_b64_tr_b16 a[174:175], v3 offset:41992
  ds_read_b64_tr_b16 a[176:177], v3 offset:49152
  ds_read_b64_tr_b16 a[178:179], v3 offset:50176
  ds_read_b64_tr_b16 a[180:181], v3 offset:49160
  ds_read_b64_tr_b16 a[182:183], v3 offset:50184
  ds_read_b64_tr_b16 a[184:185], v3 offset:57344
  ds_read_b64_tr_b16 a[186:187], v3 offset:58368
  ds_read_b64_tr_b16 a[188:189], v3 offset:57352
  ds_read_b64_tr_b16 a[190:191], v3 offset:58376
  s_waitcnt lgkmcnt(0)
  s_waitcnt vmcnt(8)
  ds_write_b128 v13, a[192:195] offset:0
  ds_write_b128 v13, a[196:199] offset:1024
  ds_write_b128 v13, a[200:203] offset:2048
  ds_write_b128 v13, a[204:207] offset:3072
  ds_write_b128 v13, a[208:211] offset:4096
  ds_write_b128 v13, a[212:215] offset:5120
  ds_write_b128 v13, a[216:219] offset:6144
  ds_write_b128 v13, a[220:223] offset:7168
  s_waitcnt lgkmcnt(0)
  s_barrier
  ds_read_b64_tr_b16 a[192:193], v3 offset:0
  ds_read_b64_tr_b16 a[194:195], v3 offset:1024
  ds_read_b64_tr_b16 a[196:197], v3 offset:8
  ds_read_b64_tr_b16 a[198:199], v3 offset:1032
  ds_read_b64_tr_b16 a[200:201], v3 offset:8192
  ds_read_b64_tr_b16 a[202:203], v3 offset:9216
  ds_read_b64_tr_b16 a[204:205], v3 offset:8200
  ds_read_b64_tr_b16 a[206:207], v3 offset:9224
  ds_read_b64_tr_b16 a[208:209], v3 offset:16384
  ds_read_b64_tr_b16 a[210:211], v3 offset:17408
  ds_read_b64_tr_b16 a[212:213], v3 offset:16392
  ds_read_b64_tr_b16 a[214:215], v3 offset:17416
  ds_read_b64_tr_b16 a[216:217], v3 offset:24576
  ds_read_b64_tr_b16 a[218:219], v3 offset:25600
  ds_read_b64_tr_b16 a[220:221], v3 offset:24584
  ds_read_b64_tr_b16 a[222:223], v3 offset:25608
  s_waitcnt lgkmcnt(0)
  s_waitcnt vmcnt(0)
  ds_write_b128 v13, a[224:227] offset:32768
  ds_write_b128 v13, a[228:231] offset:33792
  ds_write_b128 v13, a[232:235] offset:34816
  ds_write_b128 v13, a[236:239] offset:35840
  ds_write_b128 v13, a[240:243] offset:36864
  ds_write_b128 v13, a[244:247] offset:37888
  ds_write_b128 v13, a[248:251] offset:38912
  ds_write_b128 v13, a[252:255] offset:39936
  s_waitcnt lgkmcnt(0)
  s_barrier
  ds_read_b64_tr_b16 a[224:225], v3 offset:32768
  ds_read_b64_tr_b16 a[226:227], v3 offset:33792
  ds_read_b64_tr_b16 a[228:229], v3 offset:32776
  ds_read_b64_tr_b16 a[230:231], v3 offset:33800
  ds_read_b64_tr_b16 a[232:233], v3 offset:40960
  ds_read_b64_tr_b16 a[234:235], v3 offset:41984
  ds_read_b64_tr_b16 a[236:237], v3 offset:40968
  ds_read_b64_tr_b16 a[238:239], v3 offset:41992
  ds_read_b64_tr_b16 a[240:241], v3 offset:49152
  ds_read_b64_tr_b16 a[242:243], v3 offset:50176
  ds_read_b64_tr_b16 a[244:245], v3 offset:49160
  ds_read_b64_tr_b16 a[246:247], v3 offset:50184
  ds_read_b64_tr_b16 a[248:249], v3 offset:57344
  ds_read_b64_tr_b16 a[250:251], v3 offset:58368
  ds_read_b64_tr_b16 a[252:253], v3 offset:57352
  ds_read_b64_tr_b16 a[254:255], v3 offset:58376
  s_waitcnt lgkmcnt(0)
  s_barrier
  s_lshl_b32 s46, s30, 14
  s_mov_b32 s47, 65536
  s_mov_b32 s51, 262144
  s_mov_b32 s45, 64
  s_mov_b32 s42, 0
  s_mov_b32 s43, 1
  s_lshl_b32 s48, s30, 14
  s_mov_b32 s44, 0
  s_mov_b32 m0, s48
  s_nop 0
  buffer_load_dwordx4 v5, s[16:19], s46 offen offset:0 lds
  s_add_u32 m0, m0, 896
  s_nop 0
  buffer_load_dwordx4 v5, s[16:19], s46 offen offset:128 lds
  s_add_u32 m0, m0, 896
  s_nop 0
  buffer_load_dwordx4 v5, s[16:19], s46 offen offset:256 lds
  s_add_u32 m0, m0, 896
  s_nop 0
  buffer_load_dwordx4 v5, s[16:19], s46 offen offset:384 lds
  s_add_u32 m0, m0, 896
  s_nop 0
  buffer_load_dwordx4 v5, s[16:19], s46 offen offset:512 lds
  s_add_u32 m0, m0, 896
  s_nop 0
  buffer_load_dwordx4 v5, s[16:19], s46 offen offset:640 lds
  s_add_u32 m0, m0, 896
  s_nop 0
  buffer_load_dwordx4 v5, s[16:19], s46 offen offset:768 lds
  s_add_u32 m0, m0, 896
  s_nop 0
  buffer_load_dwordx4 v5, s[16:19], s46 offen offset:896 lds
  s_add_u32 m0, m0, 896
  s_nop 0
  buffer_load_dwordx4 v5, s[16:19], s46 offen offset:1024 lds
  s_add_u32 m0, m0, 896
  s_nop 0
  buffer_load_dwordx4 v5, s[16:19], s46 offen offset:1152 lds
  s_add_u32 m0, m0, 896
  s_nop 0
  buffer_load_dwordx4 v5, s[16:19], s46 offen offset:1280 lds
  s_add_u32 m0, m0, 896
  s_nop 0
  buffer_load_dwordx4 v5, s[16:19], s46 offen offset:1408 lds
  s_add_u32 m0, m0, 896
  s_nop 0
  buffer_load_dwordx4 v5, s[16:19], s46 offen offset:1536 lds
  s_add_u32 m0, m0, 896
  s_nop 0
  buffer_load_dwordx4 v5, s[16:19], s46 offen offset:1664 lds
  s_add_u32 m0, m0, 896
  s_nop 0
  buffer_load_dwordx4 v5, s[16:19], s46 offen offset:1792 lds
  s_add_u32 m0, m0, 896
  s_nop 0
  buffer_load_dwordx4 v5, s[16:19], s46 offen offset:1920 lds
  s_waitcnt vmcnt(0)
L_F1_loop:
  s_waitcnt vmcnt(2)
  s_barrier
  s_cmp_lg_u32 s44, 1
  s_cbranch_scc1 nf1_55
  s_waitcnt vmcnt(0)
  s_barrier
  s_cmp_lg_u32 s30, 0
  s_cbranch_scc1 w0_56
  s_mov_b64 s[96:97], exec
  s_mov_b64 exec, 1
  v_mov_b32 v10, s52
  v_mov_b32 v11, 1
  buffer_store_dword v11, v10, s[8:11], 0 offen sc1
  s_mov_b64 exec, s[96:97]
w0_56:
  s_branch nf_54
nf1_55:
  s_cmp_lt_u32 s44, 2
  s_cbranch_scc1 nf_54
  s_sub_u32 s34, s44, 1
  s_cmp_lg_u32 s30, 0
  s_cbranch_scc1 w0_57
  s_mov_b64 s[96:97], exec
  s_mov_b64 exec, 1
  v_mov_b32 v10, s52
  v_mov_b32 v11, s34
  buffer_store_dword v11, v10, s[8:11], 0 offen sc1
  s_mov_b64 exec, s[96:97]
w0_57:
nf_54:
  s_add_u32 s46, s46, s47
  s_add_u32 s33, s44, 1
  s_cmp_lt_u32 s33, s45
  s_cselect_b32 s46, s46, 0xf0000000
  s_xor_b32 s48, s48, 0x10000
  ds_read_b128 v[32:35], v6 offset:0
  ds_read_b128 v[36:39], v6 offset:32768
  ds_read_b128 v[40:43], v7 offset:0
  ds_read_b128 v[44:47], v7 offset:32768
  ds_read_b128 v[48:51], v6 offset:1024
  ds_read_b128 v[52:55], v6 offset:33792
  ds_read_b128 v[56:59], v7 offset:1024
  s_waitcnt lgkmcnt(5)
  v_mfma_f32_16x16x32_bf16 v[16:19], a[0:3], v[32:35], 0
  ds_read_b128 v[60:63], v7 offset:33792
  v_mfma_f32_16x16x32_bf16 v[20:23], a[4:7], v[32:35], 0
  s_mov_b32 m0, s48
  v_mfma_f32_16x16x32_bf16 v[24:27], a[0:3], v[36:39], 0
  ds_read_b128 v[32:35], v6 offset:2048
  v_mfma_f32_16x16x32_bf16 v[28:31], a[4:7], v[36:39], 0
  buffer_load_dwordx4 v5, s[16:19], s46 offen offset:0 lds
  s_waitcnt lgkmcnt(5)
  v_mfma_f32_16x16x32_bf16 v[16:19], a[8:11], v[40:43], v[16:19]
  ds_read_b128 v[36:39], v6 offset:34816
  v_mfma_f32_16x16x32_bf16 v[20:23], a[12:15], v[40:43], v[20:23]
  s_add_u32 m0, m0, 896
  v_mfma_f32_16x16x32_bf16 v[24:27], a[8:11], v[44:47], v[24:27]
  ds_read_b128 v[40:43], v7 offset:2048
  v_mfma_f32_16x16x32_bf16 v[28:31], a[12:15], v[44:47], v[28:31]
  buffer_load_dwordx4 v5, s[16:19], s46 offen offset:128 lds
  s_waitcnt lgkmcnt(5)
  v_mfma_f32_16x16x32_bf16 v[16:19], a[16:19], v[48:51], v[16:19]
  ds_read_b128 v[44:47], v7 offset:34816
  v_mfma_f32_16x16x32_bf16 v[20:23], a[20:23], v[48:51], v[20:23]
  s_add_u32 m0, m0, 896
  v_mfma_f32_16x16x32_bf16 v[24:27], a[16:19], v[52:55], v[24:27]
  ds_read_b128 v[48:51], v6 offset:3072
  v_mfma_f32_16x16x32_bf16 v[28:31], a[20:23], v[52:55], v[28:31]
  buffer_load_dwordx4 v5, s[16:19], s46 offen offset:256 lds
  s_waitcnt lgkmcnt(5)
  v_mfma_f32_16x16x32_bf16 v[16:19], a[24:27], v[56:59], v[16:19]
  ds_read_b128 v[52:55], v6 offset:35840
  v_mfma_f32_16x16x32_bf16 v[20:23], a[28:31], v[56:59], v[20:23]
  s_add_u32 m0, m0, 896
  v_mfma_f32_16x16x32_bf16 v[24:27], a[24:27], v[60:63], v[24:27]
  ds_read_b128 v[56:59], v7 offset:3072
  v_mfma_f32_16x16x32_bf16 v[28:31], a[28:31], v[60:63], v[28:31]
  buffer_load_dwordx4 v5, s[16:19], s46 offen offset:384 lds
  s_waitcnt lgkmcnt(5)
  v_mfma_f32_16x16x32_bf16 v[16:19], a[32:35], v[32:35], v[16:19]
  ds_read_b128 v[60:63], v7 offset:35840
  v_mfma_f32_16x16x32_bf16 v[20:23], a[36:39], v[32:35], v[20:23]
  s_add_u32 m0, m0, 896
  v_mfma_f32_16x16x32_bf16 v[24:27], a[32:35], v[36:39], v[24:27]
  ds_read_b128 v[32:35], v6 offset:4096
  v_mfma_f32_16x16x32_bf16 v[28:31], a[36:39], v[36:39], v[28:31]
  buffer_load_dwordx4 v5, s[16:19], s46 offen offset:512 lds
  s_waitcnt lgkmcnt(5)
  v_mfma_f32_16x16x32_bf16 v[16:19], a[40:43], v[40:43], v[16:19]
  ds_read_b128 v[36:39], v6 offset:36864
  v_mfma_f32_16x16x32_bf16 v[20:23], a[44:47], v[40:43], v[20:23]
  s_add_u32 m0, m0, 896
  v_mfma_f32_16x16x32_bf16 v[24:27], a[40:43], v[44:47], v[24:27]
  ds_read_b128 v[40:43], v7 offset:4096
  v_mfma_f32_16x16x32_bf16 v[28:31], a[44:47], v[44:47], v[28:31]
  buffer_load_dwordx4 v5, s[16:19], s46 offen offset:640 lds
  s_waitcnt lgkmcnt(5)
  v_mfma_f32_16x16x32_bf16 v[16:19], a[48:51], v[48:51], v[16:19]
  ds_read_b128 v[44:47], v7 offset:36864
  v_mfma_f32_16x16x32_bf16 v[20:23], a[52:55], v[48:51], v[20:23]
  s_add_u32 m0, m0, 896
  v_mfma_f32_16x16x32_bf16 v[24:27], a[48:51], v[52:55], v[24:27]
  ds_read_b128 v[48:51], v6 offset:5120
  v_mfma_f32_16x16x32_bf16 v[28:31], a[52:55], v[52:55], v[28:31]
  buffer_load_dwordx4 v5, s[16:19], s46 offen offset:768 lds
  s_waitcnt lgkmcnt(5)
  v_mfma_f32_16x16x32_bf16 v[16:19], a[56:59], v[56:59], v[16:19]
  ds_read_b128 v[52:55], v6 offset:37888
  v_mfma_f32_16x16x32_bf16 v[20:23], a[60:63], v[56:59], v[20:23]
  s_add_u32 m0, m0, 896
  v_mfma_f32_16x16x32_bf16 v[24:27], a[56:59], v[60:63], v[24:27]
  ds_read_b128 v[56:59], v7 offset:5120
  v_mfma_f32_16x16x32_bf16 v[28:31], a[60:63], v[60:63], v[28:31]
  buffer_load_dwordx4 v5, s[16:19], s46 offen offset:896 lds
  s_waitcnt lgkmcnt(5)
  v_mfma_f32_16x16x32_bf16 v[16:19], a[64:67], v[32:35], v[16:19]
  ds_read_b128 v[60:63], v7 offset:37888
  v_mfma_f32_16x16x32_bf16 v[20:23], a[68:71], v[32:35], v[20:23]
  s_add_u32 m0, m0, 896
  v_mfma_f32_16x16x32_bf16 v[24:27], a[64:67], v[36:39], v[24:27]
  ds_read_b128 v[32:35], v6 offset:6144
  v_mfma_f32_16x16x32_bf16 v[28:31], a[68:71], v[36:39], v[28:31]
  buffer_load_dwordx4 v5, s[16:19], s46 offen offset:1024 lds
  s_waitcnt lgkmcnt(5)
  v_mfma_f32_16x16x32_bf16 v[16:19], a[72:75], v[40:43], v[16:19]
  ds_read_b128 v[36:39], v6 offset:38912
  v_mfma_f32_16x16x32_bf16 v[20:23], a[76:79], v[40:43], v[20:23]
  s_add_u32 m0, m0, 896
  v_mfma_f32_16x16x32_bf16 v[24:27], a[72:75], v[44:47], v[24:27]
  ds_read_b128 v[40:43], v7 offset:6144
  v_mfma_f32_16x16x32_bf16 v[28:31], a[76:79], v[44:47], v[28:31]
  buffer_load_dwordx4 v5, s[16:19], s46 offen offset:1152 lds
  s_waitcnt lgkmcnt(5)
  v_mfma_f32_16x16x32_bf16 v[16:19], a[80:83], v[48:51], v[16:19]
  ds_read_b128 v[44:47], v7 offset:38912
  v_mfma_f32_16x16x32_bf16 v[20:23], a[84:87], v[48:51], v[20:23]
  s_add_u32 m0, m0, 896
  v_mfma_f32_16x16x32_bf16 v[24:27], a[80:83], v[52:55], v[24:27]
  ds_read_b128 v[48:51], v6 offset:7168
  v_mfma_f32_16x16x32_bf16 v[28:31], a[84:87], v[52:55], v[28:31]
  buffer_load_dwordx4 v5, s[16:19], s46 offen offset:1280 lds
  s_waitcnt lgkmcnt(5)
  v_mfma_f32_16x16x32_bf16 v[16:19], a[88:91], v[56:59], v[16:19]
  ds_read_b128 v[52:55], v6 offset:39936
  v_mfma_f32_16x16x32_bf16 v[20:23], a[92:95], v[56:59], v[20:23]
  s_add_u32 m0, m0, 896
  v_mfma_f32_16x16x32_bf16 v[24:27], a[88:91], v[60:63], v[24:27]
  ds_read_b128 v[56:59], v7 offset:7168
  v_mfma_f32_16x16x32_bf16 v[28:31], a[92:95], v[60:63], v[28:31]
  buffer_load_dwordx4 v5, s[16:19], s46 offen offset:1408 lds
  s_waitcnt lgkmcnt(5)
  v_mfma_f32_16x16x32_bf16 v[16:19], a[96:99], v[32:35], v[16:19]
  ds_read_b128 v[60:63], v7 offset:39936
  v_mfma_f32_16x16x32_bf16 v[20:23], a[100:103], v[32:35], v[20:23]
  s_add_u32 m0, m0, 896
  v_mfma_f32_16x16x32_bf16 v[24:27], a[96:99], v[36:39], v[24:27]
  ds_read_b128 v[32:35], v6 offset:8192
  v_mfma_f32_16x16x32_bf16 v[28:31], a[100:103], v[36:39], v[28:31]
  buffer_load_dwordx4 v5, s[16:19], s46 offen offset:1536 lds
  s_waitcnt lgkmcnt(5)
  v_mfma_f32_16x16x32_bf16 v[16:19], a[104:107], v[40:43], v[16:19]
  ds_read_b128 v[36:39], v6 offset:40960
  v_mfma_f32_16x16x32_bf16 v[20:23], a[108:111], v[40:43], v[20:23]
  s_add_u32 m0, m0, 896
  v_mfma_f32_16x16x32_bf16 v[24:27], a[104:107], v[44:47], v[24:27]
  ds_read_b128 v[40:43], v7 offset:8192
  v_mfma_f32_16x16x32_bf16 v[28:31], a[108:111], v[44:47], v[28:31]
  buffer_load_dwordx4 v5, s[16:19], s46 offen offset:1664 lds
  s_waitcnt lgkmcnt(5)
  v_mfma_f32_16x16x32_bf16 v[16:19], a[112:115], v[48:51], v[16:19]
  ds_read_b128 v[44:47], v7 offset:40960
  v_mfma_f32_16x16x32_bf16 v[20:23], a[116:119], v[48:51], v[20:23]
  s_add_u32 m0, m0, 896
  v_mfma_f32_16x16x32_bf16 v[24:27], a[112:115], v[52:55], v[24:27]
  ds_read_b128 v[48:51], v6 offset:9216
  v_mfma_f32_16x16x32_bf16 v[28:31], a[116:119], v[52:55], v[28:31]
  buffer_load_dwordx4 v5, s[16:19], s46 offen offset:1792 lds
  s_waitcnt lgkmcnt(5)
  v_mfma_f32_16x16x32_bf16 v[16:19], a[120:123], v[56:59], v[16:19]
  ds_read_b128 v[52:55], v6 offset:41984
  v_mfma_f32_16x16x32_bf16 v[20:23], a[124:127], v[56:59], v[20:23]
  s_add_u32 m0, m0, 896
  v_mfma_f32_16x16x32_bf16 v[24:27], a[120:123], v[60:63], v[24:27]
  ds_read_b128 v[56:59], v7 offset:9216
  v_mfma_f32_16x16x32_bf16 v[28:31], a[124:127], v[60:63], v[28:31]
  buffer_load_dwordx4 v5, s[16:19], s46 offen offset:1920 lds
  s_waitcnt lgkmcnt(5)
  v_mfma_f32_16x16x32_bf16 v[16:19], a[128:131], v[32:35], v[16:19]
  ds_read_b128 v[60:63], v7 offset:41984
  v_mfma_f32_16x16x32_bf16 v[20:23], a[132:135], v[32:35], v[20:23]
  v_mfma_f32_16x16x32_bf16 v[24:27], a[128:131], v[36:39], v[24:27]
  ds_read_b128 v[32:35], v6 offset:10240
  v_mfma_f32_16x16x32_bf16 v[28:31], a[132:135], v[36:39], v[28:31]
  s_waitcnt lgkmcnt(5)
  v_mfma_f32_16x16x32_bf16 v[16:19], a[136:139], v[40:43], v[16:19]
  ds_read_b128 v[36:39], v6 offset:43008
  v_mfma_f32_16x16x32_bf16 v[20:23], a[140:143], v[40:43], v[20:23]
  v_mfma_f32_16x16x32_bf16 v[24:27], a[136:139], v[44:47], v[24:27]
  ds_read_b128 v[40:43], v7 offset:10240
  v_mfma_f32_16x16x32_bf16 v[28:31], a[140:143], v[44:47], v[28:31]
  s_waitcnt lgkmcnt(5)
  v_mfma_f32_16x16x32_bf16 v[16:19], a[144:147], v[48:51], v[16:19]
  ds_read_b128 v[44:47], v7 offset:43008
  v_mfma_f32_16x16x32_bf16 v[20:23], a[148:151], v[48:51], v[20:23]
  v_mfma_f32_16x16x32_bf16 v[24:27], a[144:147], v[52:55], v[24:27]
  ds_read_b128 v[48:51], v6 offset:11264
  v_mfma_f32_16x16x32_bf16 v[28:31], a[148:151], v[52:55], v[28:31]
  s_waitcnt lgkmcnt(5)
  v_mfma_f32_16x16x32_bf16 v[16:19], a[152:155], v[56:59], v[16:19]
  ds_read_b128 v[52:55], v6 offset:44032
  v_mfma_f32_16x16x32_bf16 v[20:23], a[156:159], v[56:59], v[20:23]
  v_mfma_f32_16x16x32_bf16 v[24:27], a[152:155], v[60:63], v[24:27]
  ds_read_b128 v[56:59], v7 offset:11264
  v_mfma_f32_16x16x32_bf16 v[28:31], a[156:159], v[60:63], v[28:31]
  s_waitcnt lgkmcnt(5)
  v_mfma_f32_16x16x32_bf16 v[16:19], a[160:163], v[32:35], v[16:19]
  ds_read_b128 v[60:63], v7 offset:44032
  v_mfma_f32_16x16x32_bf16 v[20:23], a[164:167], v[32:35], v[20:23]
  v_mfma_f32_16x16x32_bf16 v[24:27], a[160:163], v[36:39], v[24:27]
  ds_read_b128 v[32:35], v6 offset:12288
  v_mfma_f32_16x16x32_bf16 v[28:31], a[164:167], v[36:39], v[28:31]
  s_waitcnt lgkmcnt(5)
  v_mfma_f32_16x16x32_bf16 v[16:19], a[168:171], v[40:43], v[16:19]
  ds_read_b128 v[36:39], v6 offset:45056
  v_mfma_f32_16x16x32_bf16 v[20:23], a[172:175], v[40:43], v[20:23]
  v_mfma_f32_16x16x32_bf16 v[24:27], a[168:171], v[44:47], v[24:27]
  ds_read_b128 v[40:43], v7 offset:12288
  v_mfma_f32_16x16x32_bf16 v[28:31], a[172:175], v[44:47], v[28:31]
  s_waitcnt lgkmcnt(5)
  v_mfma_f32_16x16x32_bf16 v[16:19], a[176:179], v[48:51], v[16:19]
  ds_read_b128 v[44:47], v7 offset:45056
  v_mfma_f32_16x16x32_bf16 v[20:23], a[180:183], v[48:51], v[20:23]
  v_mfma_f32_16x16x32_bf16 v[24:27], a[176:179], v[52:55], v[24:27]
  ds_read_b128 v[48:51], v6 offset:13312
  v_mfma_f32_16x16x32_bf16 v[28:31], a[180:183], v[52:55], v[28:31]
  s_waitcnt lgkmcnt(5)
  v_mfma_f32_16x16x32_bf16 v[16:19], a[184:187], v[56:59], v[16:19]
  ds_read_b128 v[52:55], v6 offset:46080
  v_mfma_f32_16x16x32_bf16 v[20:23], a[188:191], v[56:59], v[20:23]
  v_mfma_f32_16x16x32_bf16 v[24:27], a[184:187], v[60:63], v[24:27]
  ds_read_b128 v[56:59], v7 offset:13312
  v_mfma_f32_16x16x32_bf16 v[28:31], a[188:191], v[60:63], v[28:31]
  s_waitcnt lgkmcnt(5)
  v_mfma_f32_16x16x32_bf16 v[16:19], a[192:195], v[32:35], v[16:19]
  ds_read_b128 v[60:63], v7 offset:46080
  v_mfma_f32_16x16x32_bf16 v[20:23], a[196:199], v[32:35], v[20:23]
  v_mfma_f32_16x16x32_bf16 v[24:27], a[192:195], v[36:39], v[24:27]
  ds_read_b128 v[32:35], v6 offset:14336
  v_mfma_f32_16x16x32_bf16 v[28:31], a[196:199], v[36:39], v[28:31]
  s_waitcnt lgkmcnt(5)
  v_mfma_f32_16x16x32_bf16 v[16:19], a[200:203], v[40:43], v[16:19]
  ds_read_b128 v[36:39], v6 offset:47104
  v_mfma_f32_16x16x32_bf16 v[20:23], a[204:207], v[40:43], v[20:23]
  v_mfma_f32_16x16x32_bf16 v[24:27], a[200:203], v[44:47], v[24:27]
  ds_read_b128 v[40:43], v7 offset:14336
  v_mfma_f32_16x16x32_bf16 v[28:31], a[204:207], v[44:47], v[28:31]
  s_waitcnt lgkmcnt(5)
  v_mfma_f32_16x16x32_bf16 v[16:19], a[208:211], v[48:51], v[16:19]
  ds_read_b128 v[44:47], v7 offset:47104
  v_mfma_f32_16x16x32_bf16 v[20:23], a[212:215], v[48:51], v[20:23]
  v_mfma_f32_16x16x32_bf16 v[24:27], a[208:211], v[52:55], v[24:27]
  ds_read_b128 v[48:51], v6 offset:15360
  v_mfma_f32_16x16x32_bf16 v[28:31], a[212:215], v[52:55], v[28:31]
  s_waitcnt lgkmcnt(5)
  v_mfma_f32_16x16x32_bf16 v[16:19], a[216:219], v[56:59], v[16:19]
  ds_read_b128 v[52:55], v6 offset:48128
  v_mfma_f32_16x16x32_bf16 v[20:23], a[220:223], v[56:59], v[20:23]
  v_mfma_f32_16x16x32_bf16 v[24:27], a[216:219], v[60:63], v[24:27]
  ds_read_b128 v[56:59], v7 offset:15360
  v_mfma_f32_16x16x32_bf16 v[28:31], a[220:223], v[60:63], v[28:31]
  s_waitcnt lgkmcnt(5)
  v_mfma_f32_16x16x32_bf16 v[16:19], a[224:227], v[32:35], v[16:19]
  ds_read_b128 v[60:63], v7 offset:48128
  v_mfma_f32_16x16x32_bf16 v[20:23], a[228:231], v[32:35], v[20:23]
  v_mfma_f32_16x16x32_bf16 v[24:27], a[224:227], v[36:39], v[24:27]
  v_mfma_f32_16x16x32_bf16 v[28:31], a[228:231], v[36:39], v[28:31]
  s_waitcnt lgkmcnt(4)
  v_mfma_f32_16x16x32_bf16 v[16:19], a[232:235], v[40:43], v[16:19]
  v_mfma_f32_16x16x32_bf16 v[20:23], a[236:239], v[40:43], v[20:23]
  v_mfma_f32_16x16x32_bf16 v[24:27], a[232:235], v[44:47], v[24:27]
  v_mfma_f32_16x16x32_bf16 v[28:31], a[236:239], v[44:47], v[28:31]
  s_waitcnt lgkmcnt(2)
  v_mfma_f32_16x16x32_bf16 v[16:19], a[240:243], v[48:51], v[16:19]
  v_mfma_f32_16x16x32_bf16 v[20:23], a[244:247], v[48:51], v[20:23]
  v_mfma_f32_16x16x32_bf16 v[24:27], a[240:243], v[52:55], v[24:27]
  v_mfma_f32_16x16x32_bf16 v[28:31], a[244:247], v[52:55], v[28:31]
  s_waitcnt lgkmcnt(0)
  v_mfma_f32_16x16x32_bf16 v[16:19], a[248:251], v[56:59], v[16:19]
  v_mfma_f32_16x16x32_bf16 v[20:23], a[252:255], v[56:59], v[20:23]
  v_mfma_f32_16x16x32_bf16 v[24:27], a[248:251], v[60:63], v[24:27]
  v_mfma_f32_16x16x32_bf16 v[28:31], a[252:255], v[60:63], v[28:31]
  s_mov_b32 s33, 0xbfb8aa3b
  s_nop 3
  v_mul_f32 v72, s33, v16
  v_mul_f32 v73, s33, v17
  v_mul_f32 v74, s33, v18
  v_mul_f32 v75, s33, v19
  v_mul_f32 v76, s33, v20
  v_mul_f32 v77, s33, v21
  v_mul_f32 v78, s33, v22
  v_mul_f32 v79, s33, v23
  v_mul_f32 v80, s33, v24
  v_mul_f32 v81, s33, v25
  v_mul_f32 v82, s33, v26
  v_mul_f32 v83, s33, v27
  v_mul_f32 v84, s33, v28
  v_mul_f32 v85, s33, v29
  v_mul_f32 v86, s33, v30
  v_mul_f32 v87, s33, v31
  v_exp_f32 v72, v72
  v_exp_f32 v73, v73
  v_exp_f32 v74, v74
  v_exp_f32 v75, v75
  v_exp_f32 v76, v76
  v_exp_f32 v77, v77
  v_exp_f32 v78, v78
  v_exp_f32 v79, v79
  v_exp_f32 v80, v80
  v_exp_f32 v81, v81
  v_exp_f32 v82, v82
  v_exp_f32 v83, v83
  v_exp_f32 v84, v84
  v_exp_f32 v85, v85
  v_exp_f32 v86, v86
  v_exp_f32 v87, v87
  v_add_f32 v72, 1.0, v72
  v_add_f32 v73, 1.0, v73
  v_add_f32 v74, 1.0, v74
  v_add_f32 v75, 1.0, v75
  v_add_f32 v76, 1.0, v76
  v_add_f32 v77, 1.0, v77
  v_add_f32 v78, 1.0, v78
  v_add_f32 v79, 1.0, v79
  v_add_f32 v80, 1.0, v80
  v_add_f32 v81, 1.0, v81
  v_add_f32 v82, 1.0, v82
  v_add_f32 v83, 1.0, v83
  v_add_f32 v84, 1.0, v84
  v_add_f32 v85, 1.0, v85
  v_add_f32 v86, 1.0, v86
  v_add_f32 v87, 1.0, v87
  v_rcp_f32 v72, v72
  v_rcp_f32 v73, v73
  v_rcp_f32 v74, v74
  v_rcp_f32 v75, v75
  v_rcp_f32 v76, v76
  v_rcp_f32 v77, v77
  v_rcp_f32 v78, v78
  v_rcp_f32 v79, v79
  v_rcp_f32 v80, v80
  v_rcp_f32 v81, v81
  v_rcp_f32 v82, v82
  v_rcp_f32 v83, v83
  v_rcp_f32 v84, v84
  v_rcp_f32 v85, v85
  v_rcp_f32 v86, v86
  v_rcp_f32 v87, v87
  v_mul_f32 v16, v16, v72
  v_mul_f32 v17, v17, v73
  v_mul_f32 v18, v18, v74
  v_mul_f32 v19, v19, v75
  v_mul_f32 v20, v20, v76
  v_mul_f32 v21, v21, v77
  v_mul_f32 v22, v22, v78
  v_mul_f32 v23, v23, v79
  v_mul_f32 v24, v24, v80
  v_mul_f32 v25, v25, v81
  v_mul_f32 v26, v26, v82
  v_mul_f32 v27, v27, v83
  v_mul_f32 v28, v28, v84
  v_mul_f32 v29, v29, v85
  v_mul_f32 v30, v30, v86
  v_mul_f32 v31, v31, v87
  v_cvt_pk_bf16_f32 v64, v16, v17
  v_cvt_pk_bf16_f32 v65, v18, v19
  v_cvt_pk_bf16_f32 v66, v20, v21
  v_cvt_pk_bf16_f32 v67, v22, v23
  buffer_store_dwordx4 v[64:67], v8, s[8:11], s49 offen sc1
  v_cvt_pk_bf16_f32 v68, v24, v25
  v_cvt_pk_bf16_f32 v69, v26, v27
  v_cvt_pk_bf16_f32 v70, v28, v29
  v_cvt_pk_bf16_f32 v71, v30, v31
  s_add_u32 s54, s49, s50
  buffer_store_dwordx4 v[68:71], v8, s[8:11], s54 offen sc1
  v_xor_b32 v6, 0x10000, v6
  v_xor_b32 v7, 0x10000, v7
  s_add_u32 s49, s49, s51
  s_add_u32 s42, s42, s43
  s_add_u32 s44, s44, 1
  s_cmp_lt_u32 s44, s45
  s_cbranch_scc1 L_F1_loop
  s_waitcnt vmcnt(0)
  s_barrier
  s_cmp_lg_u32 s30, 0
  s_cbranch_scc1 w0_58
  s_mov_b64 s[96:97], exec
  s_mov_b64 exec, 1
  v_mov_b32 v10, s52
  v_mov_b32 v11, s45
  buffer_store_dword v11, v10, s[8:11], 0 offen sc1
  s_mov_b64 exec, s[96:97]
w0_58:
  s_branch L_role_MIX
L_role_WO2:
  s_mov_b32 s74, 63
  s_mov_b32 s52, 49152
  s_branch L_wo_common
L_role_WO:
  s_cmp_lg_u32 s30, 0
  s_cbranch_scc1 w0_59
  s_lshl_b32 s33, s29, 7
  s_add_u32 s33, s33, 24576
  s_mov_b64 s[96:97], exec
  s_mov_b64 exec, 1
  v_mov_b32 v10, s33
  v_mov_b32 v11, 0
  buffer_store_dword v11, v10, s[8:11], 0 offen sc1
  s_mov_b64 exec, s[96:97]
w0_59:
  s_mov_b32 s74, 64
  s_mov_b32 s52, 24576
L_wo_common:
  s_load_dwordx2 s[4:5], s[0:1], 40
  s_waitcnt lgkmcnt(0)
  s_mov_b32 s20, s4
  s_mov_b32 s21, s5
  s_mov_b32 s22, 8388608
  s_mov_b32 s23, 0x20000
  s_lshl_b32 s33, s29, 7
  s_add_u32 s52, s52, s33
  s_mov_b32 s41, 8192
  s_lshr_b32 s33, s29, 3
  s_and_b32 s34, s29, 7
  s_lshl_b32 s40, s33, 21
  s_lshl_b32 s34, s34, 8
  s_add_u32 s40, s40, s34
  s_lshl_b32 s46, s33, 16
  s_lshl_b32 s34, s30, 14
  s_add_u32 s46, s46, s34
  s_add_u32 s46, s46, 83886080
  s_lshl_b32 s49, s29, 13
  s_lshl_b32 s34, s30, 10
  s_add_u32 s49, s49, s34
  s_add_u32 s49, s49, 100663296
  s_mov_b32 s50, 4096
  s_lshl_b32 s33, s33, 3
  v_and_b32 v9, 7, v1
  v_add_u32 v9, s33, v9
  v_lshlrev_b32 v9, 7, v9
  v_add_u32 v9, 40960, v9
  v_lshrrev_b32 v10, 4, v1
  v_and_b32 v11, 15, v1
  s_lshr_b32 s33, s41, 2
  v_mul_lo_u32 v2, v10, s33
  v_lshlrev_b32 v12, 2, v10
  v_xor_b32 v12, v12, v11
  v_lshl_add_u32 v2, v12, 4, v2
  v_bfe_u32 v12, v1, 2, 2
  v_lshl_add_u32 v13, v10, 3, v12
  v_lshlrev_b32 v3, 8, v13
  v_and_b32 v13, 3, v1
  s_lshl_b32 s33, s30, 2
  v_add_u32 v13, s33, v13
  v_lshlrev_b32 v12, 2, v12
  v_xor_b32 v13, v13, v12
  v_lshl_add_u32 v3, v13, 4, v3
  v_add_u32 v4, 0x10000, v3
  v_lshlrev_b32 v8, 4, v1
  v_lshlrev_b32 v5, 4, v1
  v_lshlrev_b32 v6, 4, v1
  v_add_u32 v7, 0x4000, v6
  s_cmp_eq_u32 s74, 63
  s_cbranch_scc1 w2_60
  s_waitcnt vmcnt(0)
  s_barrier
  s_cmp_lg_u32 s30, 0
  s_cbranch_scc1 ar_61
  s_mov_b64 s[96:97], exec
  s_mov_b64 exec, 1
  v_mov_b32 v10, 64
  v_mov_b32 v11, 1
  buffer_atomic_add v11, v10, s[12:15], 0 offen
  s_mov_b64 exec, s[96:97]
ar_61:
  s_cmp_lg_u32 s30, 0
  s_cbranch_scc1 w0_63
  v_mov_b32 v10, 64
  s_mov_b32 s32, 0
wf_64:
  buffer_load_dword v11, v10, s[12:15], 0 offen sc1
  s_waitcnt vmcnt(0)
  v_cmp_gt_u32 vcc, 256, v11
  s_cbranch_vccz wfd_65
  s_sleep 24
  s_add_u32 s32, s32, 1
  s_cmp_lt_u32 s32, s31
  s_cbranch_scc1 wf_64
  s_mov_b32 s31, 0
wfd_65:
w0_63:
  s_barrier
  s_or_b32 s33, s29, s30
  s_cmp_lg_u32 s33, 0
  s_cbranch_scc1 noprobe_66
  s_add_u32 s70, s36, 8388607
  s_and_b32 s70, s70, 0xffe00000
  s_sub_u32 s70, s70, s36
  s_add_u32 s70, s70, 0x180000
  s_add_u32 s71, s70, 8192
  v_lshlrev_b32 v10, 2, v1
  s_mov_b32 s64, -1
  s_mov_b32 s65, -1
  s_mov_b32 s72, 0
  s_waitcnt vmcnt(0)
probe_67:
  s_memtime s[66:67]
  s_waitcnt lgkmcnt(0)
  buffer_store_dword v10, v10, s[8:11], s70 offen sc1
  s_waitcnt vmcnt(0)
  s_memtime s[68:69]
  s_waitcnt lgkmcnt(0)
  s_sub_u32 s66, s68, s66
  s_min_u32 s64, s64, s66
  s_memtime s[66:67]
  s_waitcnt lgkmcnt(0)
  buffer_store_dword v10, v10, s[8:11], s71 offen sc1
  s_waitcnt vmcnt(0)
  s_memtime s[68:69]
  s_waitcnt lgkmcnt(0)
  s_sub_u32 s66, s68, s66
  s_min_u32 s65, s65, s66
  s_add_u32 s72, s72, 1
  s_cmp_lt_u32 s72, 6
  s_cbranch_scc1 probe_67
  s_cmp_lt_u32 s65, s64
  s_cselect_b32 s33, 2, 1
  s_mov_b64 s[96:97], exec
  s_mov_b64 exec, 1
  v_mov_b32 v10, 68
  v_mov_b32 v11, s33
  buffer_store_dword v11, v10, s[12:15], 0 offen sc1
  s_mov_b64 exec, s[96:97]
noprobe_66:
w2_60:
  s_lshl_b32 s33, s41, 3
  s_mul_i32 s33, s33, s30
  s_add_u32 s40, s40, s33
  s_mul_i32 s34, s41, 24
  s_lshl_b32 s35, s30, 13
  v_add_u32 v13, s35, v8
  buffer_load_dwordx4 a[0:3], v2, s[20:23], s40 offen nt
  s_add_u32 s40, s40, s41
  buffer_load_dwordx4 a[4:7], v2, s[20:23], s40 offen nt
  s_add_u32 s40, s40, s41
  buffer_load_dwordx4 a[8:11], v2, s[20:23], s40 offen nt
  s_add_u32 s40, s40, s41
  buffer_load_dwordx4 a[12:15], v2, s[20:23], s40 offen nt
  s_add_u32 s40, s40, s41
  buffer_load_dwordx4 a[16:19], v2, s[20:23], s40 offen nt
  s_add_u32 s40, s40, s41
  buffer_load_dwordx4 a[20:23], v2, s[20:23], s40 offen nt
  s_add_u32 s40, s40, s41
  buffer_load_dwordx4 a[24:27], v2, s[20:23], s40 offen nt
  s_add_u32 s40, s40, s41
  buffer_load_dwordx4 a[28:31], v2, s[20:23], s40 offen nt
  s_add_u32 s40, s40, s41
  s_add_u32 s40, s40, s34
  buffer_load_dwordx4 a[32:35], v2, s[20:23], s40 offen nt
  s_add_u32 s40, s40, s41
  buffer_load_dwordx4 a[36:39], v2, s[20:23], s40 offen nt
  s_add_u32 s40, s40, s41
  buffer_load_dwordx4 a[40:43], v2, s[20:23], s40 offen nt
  s_add_u32 s40, s40, s41
  buffer_load_dwordx4 a[44:47], v2, s[20:23], s40 offen nt
  s_add_u32 s40, s40, s41
  buffer_load_dwordx4 a[48:51], v2, s[20:23], s40 offen nt
  s_add_u32 s40, s40, s41
  buffer_load_dwordx4 a[52:55], v2, s[20:23], s40 offen nt
  s_add_u32 s40, s40, s41
  buffer_load_dwordx4 a[56:59], v2, s[20:23], s40 offen nt
  s_add_u32 s40, s40, s41
  buffer_load_dwordx4 a[60:63], v2, s[20:23], s40 offen nt
  s_add_u32 s40, s40, s41
  s_add_u32 s40, s40, s34
  buffer_load_dwordx4 a[64:67], v2, s[20:23], s40 offen nt
  s_add_u32 s40, s40, s41
  buffer_load_dwordx4 a[68:71], v2, s[20:23], s40 offen nt
  s_add_u32 s40, s40, s41
  buffer_load_dwordx4 a[72:75], v2, s[20:23], s40 offen nt
  s_add_u32 s40, s40, s41
  buffer_load_dwordx4 a[76:79], v2, s[20:23], s40 offen nt
  s_add_u32 s40, s40, s41
  buffer_load_dwordx4 a[80:83], v2, s[20:23], s40 offen nt
  s_add_u32 s40, s40, s41
  buffer_load_dwordx4 a[84:87], v2, s[20:23], s40 offen nt
  s_add_u32 s40, s40, s41
  buffer_load_dwordx4 a[88:91], v2, s[20:23], s40 offen nt
  s_add_u32 s40, s40, s41
  buffer_load_dwordx4 a[92:95], v2, s[20:23], s40 offen nt
  s_add_u32 s40, s40, s41
  s_add_u32 s40, s40, s34
  buffer_load_dwordx4 a[96:99], v2, s[20:23], s40 offen nt
  s_add_u32 s40, s40, s41
  buffer_load_dwordx4 a[100:103], v2, s[20:23], s40 offen nt
  s_add_u32 s40, s40, s41
  buffer_load_dwordx4 a[104:107], v2, s[20:23], s40 offen nt
  s_add_u32 s40, s40, s41
  buffer_load_dwordx4 a[108:111], v2, s[20:23], s40 offen nt
  s_add_u32 s40, s40, s41
  buffer_load_dwordx4 a[112:115], v2, s[20:23], s40 offen nt
  s_add_u32 s40, s40, s41
  buffer_load_dwordx4 a[116:119], v2, s[20:23], s40 offen nt
  s_add_u32 s40, s40, s41
  buffer_load_dwordx4 a[120:123], v2, s[20:23], s40 offen nt
  s_add_u32 s40, s40, s41
  buffer_load_dwordx4 a[124:127], v2, s[20:23], s40 offen nt
  s_add_u32 s40, s40, s41
  s_add_u32 s40, s40, s34
  buffer_load_dwordx4 a[128:131], v2, s[20:23], s40 offen nt
  s_add_u32 s40, s40, s41
  buffer_load_dwordx4 a[132:135], v2, s[20:23], s40 offen nt
  s_add_u32 s40, s40, s41
  buffer_load_dwordx4 a[136:139], v2, s[20:23], s40 offen nt
  s_add_u32 s40, s40, s41
  buffer_load_dwordx4 a[140:143], v2, s[20:23], s40 offen nt
  s_add_u32 s40, s40, s41
  buffer_load_dwordx4 a[144:147], v2, s[20:23], s40 offen nt
  s_add_u32 s40, s40, s41
  buffer_load_dwordx4 a[148:151], v2, s[20:23], s40 offen nt
  s_add_u32 s40, s40, s41
  buffer_load_dwordx4 a[152:155], v2, s[20:23], s40 offen nt
  s_add_u32 s40, s40, s41
  buffer_load_dwordx4 a[156:159], v2, s[20:23], s40 offen nt
  s_add_u32 s40, s40, s41
  s_add_u32 s40, s40, s34
  buffer_load_dwordx4 a[160:163], v2, s[20:23], s40 offen nt
  s_add_u32 s40, s40, s41
  buffer_load_dwordx4 a[164:167], v2, s[20:23], s40 offen nt
  s_add_u32 s40, s40, s41
  buffer_load_dwordx4 a[168:171], v2, s[20:23], s40 offen nt
  s_add_u32 s40, s40, s41
  buffer_load_dwordx4 a[172:175], v2, s[20:23], s40 offen nt
  s_add_u32 s40, s40, s41
  buffer_load_dwordx4 a[176:179], v2, s[20:23], s40 offen nt
  s_add_u32 s40, s40, s41
  buffer_load_dwordx4 a[180:183], v2, s[20:23], s40 offen nt
  s_add_u32 s40, s40, s41
  buffer_load_dwordx4 a[184:187], v2, s[20:23], s40 offen nt
  s_add_u32 s40, s40, s41
  buffer_load_dwordx4 a[188:191], v2, s[20:23], s40 offen nt
  s_add_u32 s40, s40, s41
  s_add_u32 s40, s40, s34
  buffer_load_dwordx4 a[192:195], v2, s[20:23], s40 offen nt
  s_add_u32 s40, s40, s41
  buffer_load_dwordx4 a[196:199], v2, s[20:23], s40 offen nt
  s_add_u32 s40, s40, s41
  buffer_load_dwordx4 a[200:203], v2, s[20:23], s40 offen nt
  s_add_u32 s40, s40, s41
  buffer_load_dwordx4 a[204:207], v2, s[20:23], s40 offen nt
  s_add_u32 s40, s40, s41
  buffer_load_dwordx4 a[208:211], v2, s[20:23], s40 offen nt
  s_add_u32 s40, s40, s41
  buffer_load_dwordx4 a[212:215], v2, s[20:23], s40 offen nt
  s_add_u32 s40, s40, s41
  buffer_load_dwordx4 a[216:219], v2, s[20:23], s40 offen nt
  s_add_u32 s40, s40, s41
  buffer_load_dwordx4 a[220:223], v2, s[20:23], s40 offen nt
  s_add_u32 s40, s40, s41
  s_add_u32 s40, s40, s34
  s_waitcnt vmcnt(48)
  ds_write_b128 v13, a[0:3] offset:0
  ds_write_b128 v13, a[4:7] offset:1024
  ds_write_b128 v13, a[8:11] offset:2048
  ds_write_b128 v13, a[12:15] offset:3072
  ds_write_b128 v13, a[16:19] offset:4096
  ds_write_b128 v13, a[20:23] offset:5120
  ds_write_b128 v13, a[24:27] offset:6144
  ds_write_b128 v13, a[28:31] offset:7168
  s_waitcnt lgkmcnt(0)
  s_barrier
  ds_read_b64_tr_b16 a[0:1], v3 offset:0
  ds_read_b64_tr_b16 a[2:3], v3 offset:1024
  ds_read_b64_tr_b16 a[4:5], v3 offset:8
  ds_read_b64_tr_b16 a[6:7], v3 offset:1032
  ds_read_b64_tr_b16 a[8:9], v3 offset:8192
  ds_read_b64_tr_b16 a[10:11], v3 offset:9216
  ds_read_b64_tr_b16 a[12:13], v3 offset:8200
  ds_read_b64_tr_b16 a[14:15], v3 offset:9224
  ds_read_b64_tr_b16 a[16:17], v3 offset:16384
  ds_read_b64_tr_b16 a[18:19], v3 offset:17408
  ds_read_b64_tr_b16 a[20:21], v3 offset:16392
  ds_read_b64_tr_b16 a[22:23], v3 offset:17416
  ds_read_b64_tr_b16 a[24:25], v3 offset:24576
  ds_read_b64_tr_b16 a[26:27], v3 offset:25600
  ds_read_b64_tr_b16 a[28:29], v3 offset:24584
  ds_read_b64_tr_b16 a[30:31], v3 offset:25608
  s_waitcnt lgkmcnt(0)
  buffer_load_dwordx4 a[224:227], v2, s[20:23], s40 offen nt
  s_add_u32 s40, s40, s41
  buffer_load_dwordx4 a[228:231], v2, s[20:23], s40 offen nt
  s_add_u32 s40, s40, s41
  buffer_load_dwordx4 a[232:235], v2, s[20:23], s40 offen nt
  s_add_u32 s40, s40, s41
  buffer_load_dwordx4 a[236:239], v2, s[20:23], s40 offen nt
  s_add_u32 s40, s40, s41
  buffer_load_dwordx4 a[240:243], v2, s[20:23], s40 offen nt
  s_add_u32 s40, s40, s41
  buffer_load_dwordx4 a[244:247], v2, s[20:23], s40 offen nt
  s_add_u32 s40, s40, s41
  buffer_load_dwordx4 a[248:251], v2, s[20:23], s40 offen nt
  s_add_u32 s40, s40, s41
  buffer_load_dwordx4 a[252:255], v2, s[20:23], s40 offen nt
  s_add_u32 s40, s40, s41
  s_add_u32 s40, s40, s34
  s_waitcnt vmcnt(48)
  ds_write_b128 v13, a[32:35] offset:32768
  ds_write_b128 v13, a[36:39] offset:33792
  ds_write_b128 v13, a[40:43] offset:34816
  ds_write_b128 v13, a[44:47] offset:35840
  ds_write_b128 v13, a[48:51] offset:36864
  ds_write_b128 v13, a[52:55] offset:37888
  ds_write_b128 v13, a[56:59] offset:38912
  ds_write_b128 v13, a[60:63] offset:39936
  s_waitcnt lgkmcnt(0)
  s_barrier
  ds_read_b64_tr_b16 a[32:33], v3 offset:32768
  ds_read_b64_tr_b16 a[34:35], v3 offset:33792
  ds_read_b64_tr_b16 a[36:37], v3 offset:32776
  ds_read_b64_tr_b16 a[38:39], v3 offset:33800
  ds_read_b64_tr_b16 a[40:41], v3 offset:40960
  ds_read_b64_tr_b16 a[42:43], v3 offset:41984
  ds_read_b64_tr_b16 a[44:45], v3 offset:40968
  ds_read_b64_tr_b16 a[46:47], v3 offset:41992
  ds_read_b64_tr_b16 a[48:49], v3 offset:49152
  ds_read_b64_tr_b16 a[50:51], v3 offset:50176
  ds_read_b64_tr_b16 a[52:53], v3 offset:49160
  ds_read_b64_tr_b16 a[54:55], v3 offset:50184
  ds_read_b64_tr_b16 a[56:57], v3 offset:57344
  ds_read_b64_tr_b16 a[58:59], v3 offset:58368
  ds_read_b64_tr_b16 a[60:61], v3 offset:57352
  ds_read_b64_tr_b16 a[62:63], v3 offset:58376
  s_waitcnt lgkmcnt(0)
  s_waitcnt vmcnt(40)
  ds_write_b128 v13, a[64:67] offset:0
  ds_write_b128 v13, a[68:71] offset:1024
  ds_write_b128 v13, a[72:75] offset:2048
  ds_write_b128 v13, a[76:79] offset:3072
  ds_write_b128 v13, a[80:83] offset:4096
  ds_write_b128 v13, a[84:87] offset:5120
  ds_write_b128 v13, a[88:91] offset:6144
  ds_write_b128 v13, a[92:95] offset:7168
  s_waitcnt lgkmcnt(0)
  s_barrier
  ds_read_b64_tr_b16 a[64:65], v3 offset:0
  ds_read_b64_tr_b16 a[66:67], v3 offset:1024
  ds_read_b64_tr_b16 a[68:69], v3 offset:8
  ds_read_b64_tr_b16 a[70:71], v3 offset:1032
  ds_read_b64_tr_b16 a[72:73], v3 offset:8192
  ds_read_b64_tr_b16 a[74:75], v3 offset:9216
  ds_read_b64_tr_b16 a[76:77], v3 offset:8200
  ds_read_b64_tr_b16 a[78:79], v3 offset:9224
  ds_read_b64_tr_b16 a[80:81], v3 offset:16384
  ds_read_b64_tr_b16 a[82:83], v3 offset:17408
  ds_read_b64_tr_b16 a[84:85], v3 offset:16392
  ds_read_b64_tr_b16 a[86:87], v3 offset:17416
  ds_read_b64_tr_b16 a[88:89], v3 offset:24576
  ds_read_b64_tr_b16 a[90:91], v3 offset:25600
  ds_read_b64_tr_b16 a[92:93], v3 offset:24584
  ds_read_b64_tr_b16 a[94:95], v3 offset:25608
  s_waitcnt lgkmcnt(0)
  s_waitcnt vmcnt(32)
  ds_write_b128 v13, a[96:99] offset:32768
  ds_write_b128 v13, a[100:103] offset:33792
  ds_write_b128 v13, a[104:107] offset:34816
  ds_write_b128 v13, a[108:111] offset:35840
  ds_write_b128 v13, a[112:115] offset:36864
  ds_write_b128 v13, a[116:119] offset:37888
  ds_write_b128 v13, a[120:123] offset:38912
  ds_write_b128 v13, a[124:127] offset:39936
  s_waitcnt lgkmcnt(0)
  s_barrier
  ds_read_b64_tr_b16 a[96:97], v3 offset:32768
  ds_read_b64_tr_b16 a[98:99], v3 offset:33792
  ds_read_b64_tr_b16 a[100:101], v3 offset:32776
  ds_read_b64_tr_b16 a[102:103], v3 offset:33800
  ds_read_b64_tr_b16 a[104:105], v3 offset:40960
  ds_read_b64_tr_b16 a[106:107], v3 offset:41984
  ds_read_b64_tr_b16 a[108:109], v3 offset:40968
  ds_read_b64_tr_b16 a[110:111], v3 offset:41992
  ds_read_b64_tr_b16 a[112:113], v3 offset:49152
  ds_read_b64_tr_b16 a[114:115], v3 offset:50176
  ds_read_b64_tr_b16 a[116:117], v3 offset:49160
  ds_read_b64_tr_b16 a[118:119], v3 offset:50184
  ds_read_b64_tr_b16 a[120:121], v3 offset:57344
  ds_read_b64_tr_b16 a[122:123], v3 offset:58368
  ds_read_b64_tr_b16 a[124:125], v3 offset:57352
  ds_read_b64_tr_b16 a[126:127], v3 offset:58376
  s_waitcnt lgkmcnt(0)
  s_waitcnt vmcnt(24)
  ds_write_b128 v13, a[128:131] offset:0
  ds_write_b128 v13, a[132:135] offset:1024
  ds_write_b128 v13, a[136:139] offset:2048
  ds_write_b128 v13, a[140:143] offset:3072
  ds_write_b128 v13, a[144:147] offset:4096
  ds_write_b128 v13, a[148:151] offset:5120
  ds_write_b128 v13, a[152:155] offset:6144
  ds_write_b128 v13, a[156:159] offset:7168
  s_waitcnt lgkmcnt(0)
  s_barrier
  ds_read_b64_tr_b16 a[128:129], v3 offset:0
  ds_read_b64_tr_b16 a[130:131], v3 offset:1024
  ds_read_b64_tr_b16 a[132:133], v3 offset:8
  ds_read_b64_tr_b16 a[134:135], v3 offset:1032
  ds_read_b64_tr_b16 a[136:137], v3 offset:8192
  ds_read_b64_tr_b16 a[138:139], v3 offset:9216
  ds_read_b64_tr_b16 a[140:141], v3 offset:8200
  ds_read_b64_tr_b16 a[142:143], v3 offset:9224
  ds_read_b64_tr_b16 a[144:145], v3 offset:16384
  ds_read_b64_tr_b16 a[146:147], v3 offset:17408
  ds_read_b64_tr_b16 a[148:149], v3 offset:16392
  ds_read_b64_tr_b16 a[150:151], v3 offset:17416
  ds_read_b64_tr_b16 a[152:153], v3 offset:24576
  ds_read_b64_tr_b16 a[154:155], v3 offset:25600
  ds_read_b64_tr_b16 a[156:157], v3 offset:24584
  ds_read_b64_tr_b16 a[158:159], v3 offset:25608
  s_waitcnt lgkmcnt(0)
  s_waitcnt vmcnt(16)
  ds_write_b128 v13, a[160:163] offset:32768
  ds_write_b128 v13, a[164:167] offset:33792
  ds_write_b128 v13, a[168:171] offset:34816
  ds_write_b128 v13, a[172:175] offset:35840
  ds_write_b128 v13, a[176:179] offset:36864
  ds_write_b128 v13, a[180:183] offset:37888
  ds_write_b128 v13, a[184:187] offset:38912
  ds_write_b128 v13, a[188:191] offset:39936
  s_waitcnt lgkmcnt(0)
  s_barrier
  ds_read_b64_tr_b16 a[160:161], v3 offset:32768
  ds_read_b64_tr_b16 a[162:163], v3 offset:33792
  ds_read_b64_tr_b16 a[164:165], v3 offset:32776
  ds_read_b64_tr_b16 a[166:167], v3 offset:33800
  ds_read_b64_tr_b16 a[168:169], v3 offset:40960
  ds_read_b64_tr_b16 a[170:171], v3 offset:41984
  ds_read_b64_tr_b16 a[172:173], v3 offset:40968
  ds_read_b64_tr_b16 a[174:175], v3 offset:41992
  ds_read_b64_tr_b16 a[176:177], v3 offset:49152
  ds_read_b64_tr_b16 a[178:179], v3 offset:50176
  ds_read_b64_tr_b16 a[180:181], v3 offset:49160
  ds_read_b64_tr_b16 a[182:183], v3 offset:50184
  ds_read_b64_tr_b16 a[184:185], v3 offset:57344
  ds_read_b64_tr_b16 a[186:187], v3 offset:58368
  ds_read_b64_tr_b16 a[188:189], v3 offset:57352
  ds_read_b64_tr_b16 a[190:191], v3 offset:58376
  s_waitcnt lgkmcnt(0)
  s_waitcnt vmcnt(8)
  ds_write_b128 v13, a[192:195] offset:0
  ds_write_b128 v13, a[196:199] offset:1024
  ds_write_b128 v13, a[200:203] offset:2048
  ds_write_b128 v13, a[204:207] offset:3072
  ds_write_b128 v13, a[208:211] offset:4096
  ds_write_b128 v13, a[212:215] offset:5120
  ds_write_b128 v13, a[216:219] offset:6144
  ds_write_b128 v13, a[220:223] offset:7168
  s_waitcnt lgkmcnt(0)
  s_barrier
  ds_read_b64_tr_b16 a[192:193], v3 offset:0
  ds_read_b64_tr_b16 a[194:195], v3 offset:1024
  ds_read_b64_tr_b16 a[196:197], v3 offset:8
  ds_read_b64_tr_b16 a[198:199], v3 offset:1032
  ds_read_b64_tr_b16 a[200:201], v3 offset:8192
  ds_read_b64_tr_b16 a[202:203], v3 offset:9216
  ds_read_b64_tr_b16 a[204:205], v3 offset:8200
  ds_read_b64_tr_b16 a[206:207], v3 offset:9224
  ds_read_b64_tr_b16 a[208:209], v3 offset:16384
  ds_read_b64_tr_b16 a[210:211], v3 offset:17408
  ds_read_b64_tr_b16 a[212:213], v3 offset:16392
  ds_read_b64_tr_b16 a[214:215], v3 offset:17416
  ds_read_b64_tr_b16 a[216:217], v3 offset:24576
  ds_read_b64_tr_b16 a[218:219], v3 offset:25600
  ds_read_b64_tr_b16 a[220:221], v3 offset:24584
  ds_read_b64_tr_b16 a[222:223], v3 offset:25608
  s_waitcnt lgkmcnt(0)
  s_waitcnt vmcnt(0)
  ds_write_b128 v13, a[224:227] offset:32768
  ds_write_b128 v13, a[228:231] offset:33792
  ds_write_b128 v13, a[232:235] offset:34816
  ds_write_b128 v13, a[236:239] offset:35840
  ds_write_b128 v13, a[240:243] offset:36864
  ds_write_b128 v13, a[244:247] offset:37888
  ds_write_b128 v13, a[248:251] offset:38912
  ds_write_b128 v13, a[252:255] offset:39936
  s_waitcnt lgkmcnt(0)
  s_barrier
  ds_read_b64_tr_b16 a[224:225], v3 offset:32768
  ds_read_b64_tr_b16 a[226:227], v3 offset:33792
  ds_read_b64_tr_b16 a[228:229], v3 offset:32776
  ds_read_b64_tr_b16 a[230:231], v3 offset:33800
  ds_read_b64_tr_b16 a[232:233], v3 offset:40960
  ds_read_b64_tr_b16 a[234:235], v3 offset:41984
  ds_read_b64_tr_b16 a[236:237], v3 offset:40968
  ds_read_b64_tr_b16 a[238:239], v3 offset:41992
  ds_read_b64_tr_b16 a[240:241], v3 offset:49152
  ds_read_b64_tr_b16 a[242:243], v3 offset:50176
  ds_read_b64_tr_b16 a[244:245], v3 offset:49160
  ds_read_b64_tr_b16 a[246:247], v3 offset:50184
  ds_read_b64_tr_b16 a[248:249], v3 offset:57344
  ds_read_b64_tr_b16 a[250:251], v3 offset:58368
  ds_read_b64_tr_b16 a[252:253], v3 offset:57352
  ds_read_b64_tr_b16 a[254:255], v3 offset:58376
  s_waitcnt lgkmcnt(0)
  s_barrier
  s_lshl_b32 s48, s30, 14
  s_cmp_eq_u32 s74, 63
  s_cselect_b32 s44, 62, 0
  s_lshl_b32 s33, s44, 18
  s_add_u32 s46, s46, s33
  s_add_u32 s49, s49, s33
  v_mov_b32 v13, 163328
L_WO_paced:
  s_add_u32 s55, s44, 1
  s_mov_b32 s32, 0
wf_68:
  buffer_load_dword v12, v9, s[8:11], 0 offen sc1
  s_waitcnt vmcnt(0)
  v_cmp_gt_u32 vcc, s55, v12
  s_cbranch_vccz wfd_69
  s_sleep 1
  s_add_u32 s32, s32, 1
  s_cmp_lt_u32 s32, s31
  s_cbranch_scc1 wf_68
  s_mov_b32 s31, 0
wfd_69:
  s_add_u32 m0, s48, 0
  s_add_u32 s56, s46, 0
  buffer_load_dwordx4 v5, s[8:11], s56 offen offset:0 sc1 lds
  buffer_load_dwordx4 v5, s[8:11], s56 offen offset:1024 sc1 lds
  buffer_load_dwordx4 v5, s[8:11], s56 offen offset:2048 sc1 lds
  buffer_load_dwordx4 v5, s[8:11], s56 offen offset:3072 sc1 lds
  s_add_u32 m0, s48, 4096
  s_add_u32 s56, s46, 4096
  buffer_load_dwordx4 v5, s[8:11], s56 offen offset:0 sc1 lds
  buffer_load_dwordx4 v5, s[8:11], s56 offen offset:1024 sc1 lds
  buffer_load_dwordx4 v5, s[8:11], s56 offen offset:2048 sc1 lds
  buffer_load_dwordx4 v5, s[8:11], s56 offen offset:3072 sc1 lds
  s_add_u32 m0, s48, 8192
  s_add_u32 s56, s46, 8192
  buffer_load_dwordx4 v5, s[8:11], s56 offen offset:0 sc1 lds
  buffer_load_dwordx4 v5, s[8:11], s56 offen offset:1024 sc1 lds
  buffer_load_dwordx4 v5, s[8:11], s56 offen offset:2048 sc1 lds
  buffer_load_dwordx4 v5, s[8:11], s56 offen offset:3072 sc1 lds
  s_add_u32 m0, s48, 12288
  s_add_u32 s56, s46, 12288
  buffer_load_dwordx4 v5, s[8:11], s56 offen offset:0 sc1 lds
  buffer_load_dwordx4 v5, s[8:11], s56 offen offset:1024 sc1 lds
  buffer_load_dwordx4 v5, s[8:11], s56 offen offset:2048 sc1 lds
  buffer_load_dwordx4 v5, s[8:11], s56 offen offset:3072 sc1 lds
  s_mov_b32 s73, 0
  s_waitcnt vmcnt(12)
  s_branch L_WO_body
L_WO_got:
  s_waitcnt vmcnt(2)
L_WO_body:
  s_barrier
  s_cmp_eq_u32 s44, 61
  s_cselect_b32 s53, 2, 1
  s_lshl_b32 s33, s53, 18
  s_add_u32 s46, s46, s33
  s_xor_b32 s48, s48, 0x10000
  s_add_u32 s55, s44, s53
  s_add_u32 s55, s55, 1
  s_cmp_gt_u32 s55, s74
  s_cselect_b32 s55, 99, s55
  ds_read_b128 v[32:35], v6 offset:0
  ds_read_b128 v[36:39], v6 offset:32768
  ds_read_b128 v[40:43], v7 offset:0
  ds_read_b128 v[44:47], v7 offset:32768
  ds_read_b128 v[48:51], v6 offset:1024
  ds_read_b128 v[52:55], v6 offset:33792
  ds_read_b128 v[56:59], v7 offset:1024
  s_waitcnt lgkmcnt(5)
  v_mfma_f32_16x16x32_bf16 v[16:19], a[0:3], v[32:35], 0
  ds_read_b128 v[60:63], v7 offset:33792
  v_mfma_f32_16x16x32_bf16 v[20:23], a[4:7], v[32:35], 0
  v_mfma_f32_16x16x32_bf16 v[24:27], a[0:3], v[36:39], 0
  ds_read_b128 v[32:35], v6 offset:2048
  v_mfma_f32_16x16x32_bf16 v[28:31], a[4:7], v[36:39], 0
  s_waitcnt lgkmcnt(5)
  v_mfma_f32_16x16x32_bf16 v[16:19], a[8:11], v[40:43], v[16:19]
  ds_read_b128 v[36:39], v6 offset:34816
  v_mfma_f32_16x16x32_bf16 v[20:23], a[12:15], v[40:43], v[20:23]
  v_mfma_f32_16x16x32_bf16 v[24:27], a[8:11], v[44:47], v[24:27]
  ds_read_b128 v[40:43], v7 offset:2048
  v_mfma_f32_16x16x32_bf16 v[28:31], a[12:15], v[44:47], v[28:31]
  s_waitcnt lgkmcnt(5)
  v_mfma_f32_16x16x32_bf16 v[16:19], a[16:19], v[48:51], v[16:19]
  ds_read_b128 v[44:47], v7 offset:34816
  v_mfma_f32_16x16x32_bf16 v[20:23], a[20:23], v[48:51], v[20:23]
  v_mfma_f32_16x16x32_bf16 v[24:27], a[16:19], v[52:55], v[24:27]
  ds_read_b128 v[48:51], v6 offset:3072
  v_mfma_f32_16x16x32_bf16 v[28:31], a[20:23], v[52:55], v[28:31]
  s_waitcnt lgkmcnt(5)
  v_mfma_f32_16x16x32_bf16 v[16:19], a[24:27], v[56:59], v[16:19]
  ds_read_b128 v[52:55], v6 offset:35840
  v_mfma_f32_16x16x32_bf16 v[20:23], a[28:31], v[56:59], v[20:23]
  v_mfma_f32_16x16x32_bf16 v[24:27], a[24:27], v[60:63], v[24:27]
  ds_read_b128 v[56:59], v7 offset:3072
  v_mfma_f32_16x16x32_bf16 v[28:31], a[28:31], v[60:63], v[28:31]
  s_waitcnt lgkmcnt(5)
  v_mfma_f32_16x16x32_bf16 v[16:19], a[32:35], v[32:35], v[16:19]
  ds_read_b128 v[60:63], v7 offset:35840
  v_mfma_f32_16x16x32_bf16 v[20:23], a[36:39], v[32:35], v[20:23]
  v_mfma_f32_16x16x32_bf16 v[24:27], a[32:35], v[36:39], v[24:27]
  s_cmp_eq_u32 s73, 0
  s_cbranch_scc1 wo_70
  s_waitcnt vmcnt(0)
  s_barrier
  s_cmp_lg_u32 s30, 0
  s_cbranch_scc1 w0_72
  s_mov_b64 s[96:97], exec
  s_mov_b64 exec, 1
  v_mov_b32 v10, s52
  v_mov_b32 v11, s44
  buffer_store_dword v11, v10, s[8:11], 0 offen sc1
  s_mov_b64 exec, s[96:97]
w0_72:
  s_branch wo_71
wo_70:
  s_waitcnt vmcnt(8)
  s_barrier
wo_71:
  ds_read_b128 v[32:35], v6 offset:4096
  v_mfma_f32_16x16x32_bf16 v[28:31], a[36:39], v[36:39], v[28:31]
  s_waitcnt lgkmcnt(5)
  v_mfma_f32_16x16x32_bf16 v[16:19], a[40:43], v[40:43], v[16:19]
  ds_read_b128 v[36:39], v6 offset:36864
  v_mfma_f32_16x16x32_bf16 v[20:23], a[44:47], v[40:43], v[20:23]
  v_mfma_f32_16x16x32_bf16 v[24:27], a[40:43], v[44:47], v[24:27]
  ds_read_b128 v[40:43], v7 offset:4096
  v_mfma_f32_16x16x32_bf16 v[28:31], a[44:47], v[44:47], v[28:31]
  s_waitcnt lgkmcnt(5)
  v_mfma_f32_16x16x32_bf16 v[16:19], a[48:51], v[48:51], v[16:19]
  ds_read_b128 v[44:47], v7 offset:36864
  v_mfma_f32_16x16x32_bf16 v[20:23], a[52:55], v[48:51], v[20:23]
  v_mfma_f32_16x16x32_bf16 v[24:27], a[48:51], v[52:55], v[24:27]
  ds_read_b128 v[48:51], v6 offset:5120
  v_mfma_f32_16x16x32_bf16 v[28:31], a[52:55], v[52:55], v[28:31]
  s_waitcnt lgkmcnt(5)
  v_mfma_f32_16x16x32_bf16 v[16:19], a[56:59], v[56:59], v[16:19]
  ds_read_b128 v[52:55], v6 offset:37888
  v_mfma_f32_16x16x32_bf16 v[20:23], a[60:63], v[56:59], v[20:23]
  v_mfma_f32_16x16x32_bf16 v[24:27], a[56:59], v[60:63], v[24:27]
  ds_read_b128 v[56:59], v7 offset:5120
  v_mfma_f32_16x16x32_bf16 v[28:31], a[60:63], v[60:63], v[28:31]
  s_waitcnt lgkmcnt(5)
  v_mfma_f32_16x16x32_bf16 v[16:19], a[64:67], v[32:35], v[16:19]
  ds_read_b128 v[60:63], v7 offset:37888
  v_mfma_f32_16x16x32_bf16 v[20:23], a[68:71], v[32:35], v[20:23]
  v_mfma_f32_16x16x32_bf16 v[24:27], a[64:67], v[36:39], v[24:27]
  ds_read_b128 v[32:35], v6 offset:6144
  v_mfma_f32_16x16x32_bf16 v[28:31], a[68:71], v[36:39], v[28:31]
  s_waitcnt lgkmcnt(5)
  v_mfma_f32_16x16x32_bf16 v[16:19], a[72:75], v[40:43], v[16:19]
  ds_read_b128 v[36:39], v6 offset:38912
  v_mfma_f32_16x16x32_bf16 v[20:23], a[76:79], v[40:43], v[20:23]
  v_mfma_f32_16x16x32_bf16 v[24:27], a[72:75], v[44:47], v[24:27]
  ds_read_b128 v[40:43], v7 offset:6144
  v_mfma_f32_16x16x32_bf16 v[28:31], a[76:79], v[44:47], v[28:31]
  s_waitcnt lgkmcnt(5)
  v_mfma_f32_16x16x32_bf16 v[16:19], a[80:83], v[48:51], v[16:19]
  ds_read_b128 v[44:47], v7 offset:38912
  v_mfma_f32_16x16x32_bf16 v[20:23], a[84:87], v[48:51], v[20:23]
  v_mfma_f32_16x16x32_bf16 v[24:27], a[80:83], v[52:55], v[24:27]
  ds_read_b128 v[48:51], v6 offset:7168
  v_mfma_f32_16x16x32_bf16 v[28:31], a[84:87], v[52:55], v[28:31]
  s_waitcnt lgkmcnt(5)
  v_mfma_f32_16x16x32_bf16 v[16:19], a[88:91], v[56:59], v[16:19]
  ds_read_b128 v[52:55], v6 offset:39936
  v_mfma_f32_16x16x32_bf16 v[20:23], a[92:95], v[56:59], v[20:23]
  v_mfma_f32_16x16x32_bf16 v[24:27], a[88:91], v[60:63], v[24:27]
  ds_read_b128 v[56:59], v7 offset:7168
  v_mfma_f32_16x16x32_bf16 v[28:31], a[92:95], v[60:63], v[28:31]
  s_waitcnt lgkmcnt(5)
  v_mfma_f32_16x16x32_bf16 v[16:19], a[96:99], v[32:35], v[16:19]
  ds_read_b128 v[60:63], v7 offset:39936
  v_mfma_f32_16x16x32_bf16 v[20:23], a[100:103], v[32:35], v[20:23]
  v_mfma_f32_16x16x32_bf16 v[24:27], a[96:99], v[36:39], v[24:27]
  s_waitcnt vmcnt(4)
  s_barrier
  buffer_load_dword v12, v9, s[8:11], 0 offen sc1
  ds_read_b128 v[32:35], v6 offset:8192
  v_mfma_f32_16x16x32_bf16 v[28:31], a[100:103], v[36:39], v[28:31]
  s_waitcnt lgkmcnt(5)
  v_mfma_f32_16x16x32_bf16 v[16:19], a[104:107], v[40:43], v[16:19]
  ds_read_b128 v[36:39], v6 offset:40960
  v_mfma_f32_16x16x32_bf16 v[20:23], a[108:111], v[40:43], v[20:23]
  v_mfma_f32_16x16x32_bf16 v[24:27], a[104:107], v[44:47], v[24:27]
  ds_read_b128 v[40:43], v7 offset:8192
  v_mfma_f32_16x16x32_bf16 v[28:31], a[108:111], v[44:47], v[28:31]
  s_waitcnt lgkmcnt(5)
  v_mfma_f32_16x16x32_bf16 v[16:19], a[112:115], v[48:51], v[16:19]
  ds_read_b128 v[44:47], v7 offset:40960
  v_mfma_f32_16x16x32_bf16 v[20:23], a[116:119], v[48:51], v[20:23]
  v_mfma_f32_16x16x32_bf16 v[24:27], a[112:115], v[52:55], v[24:27]
  ds_read_b128 v[48:51], v6 offset:9216
  v_mfma_f32_16x16x32_bf16 v[28:31], a[116:119], v[52:55], v[28:31]
  s_waitcnt lgkmcnt(5)
  v_mfma_f32_16x16x32_bf16 v[16:19], a[120:123], v[56:59], v[16:19]
  ds_read_b128 v[52:55], v6 offset:41984
  v_mfma_f32_16x16x32_bf16 v[20:23], a[124:127], v[56:59], v[20:23]
  v_mfma_f32_16x16x32_bf16 v[24:27], a[120:123], v[60:63], v[24:27]
  ds_read_b128 v[56:59], v7 offset:9216
  v_mfma_f32_16x16x32_bf16 v[28:31], a[124:127], v[60:63], v[28:31]
  s_waitcnt lgkmcnt(5)
  v_mfma_f32_16x16x32_bf16 v[16:19], a[128:131], v[32:35], v[16:19]
  ds_read_b128 v[60:63], v7 offset:41984
  v_mfma_f32_16x16x32_bf16 v[20:23], a[132:135], v[32:35], v[20:23]
  v_mfma_f32_16x16x32_bf16 v[24:27], a[128:131], v[36:39], v[24:27]
  ds_read_b128 v[32:35], v6 offset:10240
  v_mfma_f32_16x16x32_bf16 v[28:31], a[132:135], v[36:39], v[28:31]
  s_waitcnt lgkmcnt(5)
  v_mfma_f32_16x16x32_bf16 v[16:19], a[136:139], v[40:43], v[16:19]
  ds_read_b128 v[36:39], v6 offset:43008
  v_mfma_f32_16x16x32_bf16 v[20:23], a[140:143], v[40:43], v[20:23]
  v_mfma_f32_16x16x32_bf16 v[24:27], a[136:139], v[44:47], v[24:27]
  ds_read_b128 v[40:43], v7 offset:10240
  v_mfma_f32_16x16x32_bf16 v[28:31], a[140:143], v[44:47], v[28:31]
  s_waitcnt lgkmcnt(5)
  v_mfma_f32_16x16x32_bf16 v[16:19], a[144:147], v[48:51], v[16:19]
  ds_read_b128 v[44:47], v7 offset:43008
  v_mfma_f32_16x16x32_bf16 v[20:23], a[148:151], v[48:51], v[20:23]
  v_mfma_f32_16x16x32_bf16 v[24:27], a[144:147], v[52:55], v[24:27]
  ds_read_b128 v[48:51], v6 offset:11264
  v_mfma_f32_16x16x32_bf16 v[28:31], a[148:151], v[52:55], v[28:31]
  s_waitcnt lgkmcnt(5)
  v_mfma_f32_16x16x32_bf16 v[16:19], a[152:155], v[56:59], v[16:19]
  ds_read_b128 v[52:55], v6 offset:44032
  v_mfma_f32_16x16x32_bf16 v[20:23], a[156:159], v[56:59], v[20:23]
  v_mfma_f32_16x16x32_bf16 v[24:27], a[152:155], v[60:63], v[24:27]
  ds_read_b128 v[56:59], v7 offset:11264
  v_mfma_f32_16x16x32_bf16 v[28:31], a[156:159], v[60:63], v[28:31]
  s_waitcnt lgkmcnt(5)
  v_mfma_f32_16x16x32_bf16 v[16:19], a[160:163], v[32:35], v[16:19]
  ds_read_b128 v[60:63], v7 offset:44032
  v_mfma_f32_16x16x32_bf16 v[20:23], a[164:167], v[32:35], v[20:23]
  v_mfma_f32_16x16x32_bf16 v[24:27], a[160:163], v[36:39], v[24:27]
  v_mfma_f32_16x16x32_bf16 v[28:31], a[164:167], v[36:39], v[28:31]
  s_waitcnt lgkmcnt(4)
  v_mfma_f32_16x16x32_bf16 v[16:19], a[168:171], v[40:43], v[16:19]
  v_mfma_f32_16x16x32_bf16 v[20:23], a[172:175], v[40:43], v[20:23]
  v_mfma_f32_16x16x32_bf16 v[24:27], a[168:171], v[44:47], v[24:27]
  v_mfma_f32_16x16x32_bf16 v[28:31], a[172:175], v[44:47], v[28:31]
  s_waitcnt lgkmcnt(2)
  v_mfma_f32_16x16x32_bf16 v[16:19], a[176:179], v[48:51], v[16:19]
  v_mfma_f32_16x16x32_bf16 v[20:23], a[180:183], v[48:51], v[20:23]
  v_mfma_f32_16x16x32_bf16 v[24:27], a[176:179], v[52:55], v[24:27]
  v_mfma_f32_16x16x32_bf16 v[28:31], a[180:183], v[52:55], v[28:31]
  s_waitcnt lgkmcnt(0)
  v_mfma_f32_16x16x32_bf16 v[16:19], a[184:187], v[56:59], v[16:19]
  v_mfma_f32_16x16x32_bf16 v[20:23], a[188:191], v[56:59], v[20:23]
  v_mfma_f32_16x16x32_bf16 v[24:27], a[184:187], v[60:63], v[24:27]
  v_mfma_f32_16x16x32_bf16 v[28:31], a[188:191], v[60:63], v[28:31]
  s_waitcnt vmcnt(0)
  s_cmp_lg_u32 s30, 0
  s_cbranch_scc1 w0_73
  v_cmp_gt_u32 vcc, s55, v12
  s_nop 4
  s_cmp_eq_u64 vcc, 0
  s_cselect_b32 s33, 1, 0
  v_mov_b32 v11, s33
  ds_write_b32 v13, v11
  s_waitcnt lgkmcnt(0)
w0_73:
  s_barrier
  ds_read_b32 v11, v13
  s_waitcnt lgkmcnt(0)
  v_readfirstlane_b32 s73, v11
  s_nop 3
  s_cmp_lg_u32 s73, 0
  s_cbranch_scc1 L_WO_ahead
  ds_read_b128 v[32:35], v6 offset:12288
  ds_read_b128 v[36:39], v6 offset:45056
  ds_read_b128 v[40:43], v7 offset:12288
  ds_read_b128 v[44:47], v7 offset:45056
  ds_read_b128 v[48:51], v6 offset:13312
  ds_read_b128 v[52:55], v6 offset:46080
  ds_read_b128 v[56:59], v7 offset:13312
  s_waitcnt lgkmcnt(5)
  v_mfma_f32_16x16x32_bf16 v[16:19], a[192:195], v[32:35], v[16:19]
  ds_read_b128 v[60:63], v7 offset:46080
  v_mfma_f32_16x16x32_bf16 v[20:23], a[196:199], v[32:35], v[20:23]
  v_mfma_f32_16x16x32_bf16 v[24:27], a[192:195], v[36:39], v[24:27]
  ds_read_b128 v[32:35], v6 offset:14336
  v_mfma_f32_16x16x32_bf16 v[28:31], a[196:199], v[36:39], v[28:31]
  s_waitcnt lgkmcnt(5)
  v_mfma_f32_16x16x32_bf16 v[16:19], a[200:203], v[40:43], v[16:19]
  ds_read_b128 v[36:39], v6 offset:47104
  v_mfma_f32_16x16x32_bf16 v[20:23], a[204:207], v[40:43], v[20:23]
  v_mfma_f32_16x16x32_bf16 v[24:27], a[200:203], v[44:47], v[24:27]
  ds_read_b128 v[40:43], v7 offset:14336
  v_mfma_f32_16x16x32_bf16 v[28:31], a[204:207], v[44:47], v[28:31]
  s_waitcnt lgkmcnt(5)
  v_mfma_f32_16x16x32_bf16 v[16:19], a[208:211], v[48:51], v[16:19]
  ds_read_b128 v[44:47], v7 offset:47104
  v_mfma_f32_16x16x32_bf16 v[20:23], a[212:215], v[48:51], v[20:23]
  v_mfma_f32_16x16x32_bf16 v[24:27], a[208:211], v[52:55], v[24:27]
  ds_read_b128 v[48:51], v6 offset:15360
  v_mfma_f32_16x16x32_bf16 v[28:31], a[212:215], v[52:55], v[28:31]
  s_waitcnt lgkmcnt(5)
  v_mfma_f32_16x16x32_bf16 v[16:19], a[216:219], v[56:59], v[16:19]
  ds_read_b128 v[52:55], v6 offset:48128
  v_mfma_f32_16x16x32_bf16 v[20:23], a[220:223], v[56:59], v[20:23]
  v_mfma_f32_16x16x32_bf16 v[24:27], a[216:219], v[60:63], v[24:27]
  ds_read_b128 v[56:59], v7 offset:15360
  v_mfma_f32_16x16x32_bf16 v[28:31], a[220:223], v[60:63], v[28:31]
  s_waitcnt lgkmcnt(5)
  v_mfma_f32_16x16x32_bf16 v[16:19], a[224:227], v[32:35], v[16:19]
  ds_read_b128 v[60:63], v7 offset:48128
  v_mfma_f32_16x16x32_bf16 v[20:23], a[228:231], v[32:35], v[20:23]
  v_mfma_f32_16x16x32_bf16 v[24:27], a[224:227], v[36:39], v[24:27]
  v_mfma_f32_16x16x32_bf16 v[28:31], a[228:231], v[36:39], v[28:31]
  s_waitcnt lgkmcnt(4)
  v_mfma_f32_16x16x32_bf16 v[16:19], a[232:235], v[40:43], v[16:19]
  v_mfma_f32_16x16x32_bf16 v[20:23], a[236:239], v[40:43], v[20:23]
  v_mfma_f32_16x16x32_bf16 v[24:27], a[232:235], v[44:47], v[24:27]
  v_mfma_f32_16x16x32_bf16 v[28:31], a[236:239], v[44:47], v[28:31]
  s_waitcnt lgkmcnt(2)
  v_mfma_f32_16x16x32_bf16 v[16:19], a[240:243], v[48:51], v[16:19]
  v_mfma_f32_16x16x32_bf16 v[20:23], a[244:247], v[48:51], v[20:23]
  v_mfma_f32_16x16x32_bf16 v[24:27], a[240:243], v[52:55], v[24:27]
  v_mfma_f32_16x16x32_bf16 v[28:31], a[244:247], v[52:55], v[28:31]
  s_waitcnt lgkmcnt(0)
  v_mfma_f32_16x16x32_bf16 v[16:19], a[248:251], v[56:59], v[16:19]
  v_mfma_f32_16x16x32_bf16 v[20:23], a[252:255], v[56:59], v[20:23]
  v_mfma_f32_16x16x32_bf16 v[24:27], a[248:251], v[60:63], v[24:27]
  v_mfma_f32_16x16x32_bf16 v[28:31], a[252:255], v[60:63], v[28:31]
  s_nop 4
  v_cvt_pk_bf16_f32 v64, v16, v17
  v_cvt_pk_bf16_f32 v65, v18, v19
  v_cvt_pk_bf16_f32 v66, v20, v21
  v_cvt_pk_bf16_f32 v67, v22, v23
  buffer_store_dwordx4 v[64:67], v8, s[8:11], s49 offen sc1
  v_cvt_pk_bf16_f32 v68, v24, v25
  v_cvt_pk_bf16_f32 v69, v26, v27
  v_cvt_pk_bf16_f32 v70, v28, v29
  v_cvt_pk_bf16_f32 v71, v30, v31
  s_add_u32 s54, s49, s50
  buffer_store_dwordx4 v[68:71], v8, s[8:11], s54 offen sc1
  s_add_u32 s44, s44, s53
  s_lshl_b32 s33, s53, 18
  s_add_u32 s49, s49, s33
  v_xor_b32 v6, 0x10000, v6
  v_xor_b32 v7, 0x10000, v7
  s_waitcnt vmcnt(0)
  s_barrier
  s_cmp_lg_u32 s30, 0
  s_cbranch_scc1 w0_74
  s_mov_b64 s[96:97], exec
  s_mov_b64 exec, 1
  v_mov_b32 v10, s52
  v_mov_b32 v11, s44
  buffer_store_dword v11, v10, s[8:11], 0 offen sc1
  s_mov_b64 exec, s[96:97]
w0_74:
  s_cmp_lt_u32 s44, s74
  s_cbranch_scc1 L_WO_paced
  s_branch L_WO_end
L_WO_ahead:
  ds_read_b128 v[32:35], v6 offset:12288
  ds_read_b128 v[36:39], v6 offset:45056
  ds_read_b128 v[40:43], v7 offset:12288
  ds_read_b128 v[44:47], v7 offset:45056
  ds_read_b128 v[48:51], v6 offset:13312
  ds_read_b128 v[52:55], v6 offset:46080
  ds_read_b128 v[56:59], v7 offset:13312
  s_waitcnt lgkmcnt(5)
  v_mfma_f32_16x16x32_bf16 v[16:19], a[192:195], v[32:35], v[16:19]
  ds_read_b128 v[60:63], v7 offset:46080
  v_mfma_f32_16x16x32_bf16 v[20:23], a[196:199], v[32:35], v[20:23]
  s_add_u32 m0, s48, 0
  s_add_u32 s56, s46, 0
  buffer_load_dwordx4 v5, s[8:11], s56 offen offset:0 sc1 lds
  v_mfma_f32_16x16x32_bf16 v[24:27], a[192:195], v[36:39], v[24:27]
  ds_read_b128 v[32:35], v6 offset:14336
  v_mfma_f32_16x16x32_bf16 v[28:31], a[196:199], v[36:39], v[28:31]
  buffer_load_dwordx4 v5, s[8:11], s56 offen offset:1024 sc1 lds
  s_waitcnt lgkmcnt(5)
  v_mfma_f32_16x16x32_bf16 v[16:19], a[200:203], v[40:43], v[16:19]
  ds_read_b128 v[36:39], v6 offset:47104
  v_mfma_f32_16x16x32_bf16 v[20:23], a[204:207], v[40:43], v[20:23]
  buffer_load_dwordx4 v5, s[8:11], s56 offen offset:2048 sc1 lds
  v_mfma_f32_16x16x32_bf16 v[24:27], a[200:203], v[44:47], v[24:27]
  ds_read_b128 v[40:43], v7 offset:14336
  v_mfma_f32_16x16x32_bf16 v[28:31], a[204:207], v[44:47], v[28:31]
  buffer_load_dwordx4 v5, s[8:11], s56 offen offset:3072 sc1 lds
  s_waitcnt lgkmcnt(5)
  v_mfma_f32_16x16x32_bf16 v[16:19], a[208:211], v[48:51], v[16:19]
  ds_read_b128 v[44:47], v7 offset:47104
  v_mfma_f32_16x16x32_bf16 v[20:23], a[212:215], v[48:51], v[20:23]
  s_add_u32 m0, s48, 4096
  s_add_u32 s56, s46, 4096
  buffer_load_dwordx4 v5, s[8:11], s56 offen offset:0 sc1 lds
  v_mfma_f32_16x16x32_bf16 v[24:27], a[208:211], v[52:55], v[24:27]
  ds_read_b128 v[48:51], v6 offset:15360
  v_mfma_f32_16x16x32_bf16 v[28:31], a[212:215], v[52:55], v[28:31]
  buffer_load_dwordx4 v5, s[8:11], s56 offen offset:1024 sc1 lds
  s_waitcnt lgkmcnt(5)
  v_mfma_f32_16x16x32_bf16 v[16:19], a[216:219], v[56:59], v[16:19]
  ds_read_b128 v[52:55], v6 offset:48128
  v_mfma_f32_16x16x32_bf16 v[20:23], a[220:223], v[56:59], v[20:23]
  buffer_load_dwordx4 v5, s[8:11], s56 offen offset:2048 sc1 lds
  v_mfma_f32_16x16x32_bf16 v[24:27], a[216:219], v[60:63], v[24:27]
  ds_read_b128 v[56:59], v7 offset:15360
  v_mfma_f32_16x16x32_bf16 v[28:31], a[220:223], v[60:63], v[28:31]
  buffer_load_dwordx4 v5, s[8:11], s56 offen offset:3072 sc1 lds
  s_waitcnt lgkmcnt(5)
  v_mfma_f32_16x16x32_bf16 v[16:19], a[224:227], v[32:35], v[16:19]
  ds_read_b128 v[60:63], v7 offset:48128
  v_mfma_f32_16x16x32_bf16 v[20:23], a[228:231], v[32:35], v[20:23]
  s_add_u32 m0, s48, 8192
  s_add_u32 s56, s46, 8192
  buffer_load_dwordx4 v5, s[8:11], s56 offen offset:0 sc1 lds
  v_mfma_f32_16x16x32_bf16 v[24:27], a[224:227], v[36:39], v[24:27]
  v_mfma_f32_16x16x32_bf16 v[28:31], a[228:231], v[36:39], v[28:31]
  buffer_load_dwordx4 v5, s[8:11], s56 offen offset:1024 sc1 lds
  s_waitcnt lgkmcnt(4)
  v_mfma_f32_16x16x32_bf16 v[16:19], a[232:235], v[40:43], v[16:19]
  v_mfma_f32_16x16x32_bf16 v[20:23], a[236:239], v[40:43], v[20:23]
  buffer_load_dwordx4 v5, s[8:11], s56 offen offset:2048 sc1 lds
  v_mfma_f32_16x16x32_bf16 v[24:27], a[232:235], v[44:47], v[24:27]
  v_mfma_f32_16x16x32_bf16 v[28:31], a[236:239], v[44:47], v[28:31]
  buffer_load_dwordx4 v5, s[8:11], s56 offen offset:3072 sc1 lds
  s_waitcnt lgkmcnt(2)
  v_mfma_f32_16x16x32_bf16 v[16:19], a[240:243], v[48:51], v[16:19]
  v_mfma_f32_16x16x32_bf16 v[20:23], a[244:247], v[48:51], v[20:23]
  s_add_u32 m0, s48, 12288
  s_add_u32 s56, s46, 12288
  buffer_load_dwordx4 v5, s[8:11], s56 offen offset:0 sc1 lds
  v_mfma_f32_16x16x32_bf16 v[24:27], a[240:243], v[52:55], v[24:27]
  v_mfma_f32_16x16x32_bf16 v[28:31], a[244:247], v[52:55], v[28:31]
  buffer_load_dwordx4 v5, s[8:11], s56 offen offset:1024 sc1 lds
  s_waitcnt lgkmcnt(0)
  v_mfma_f32_16x16x32_bf16 v[16:19], a[248:251], v[56:59], v[16:19]
  v_mfma_f32_16x16x32_bf16 v[20:23], a[252:255], v[56:59], v[20:23]
  buffer_load_dwordx4 v5, s[8:11], s56 offen offset:2048 sc1 lds
  v_mfma_f32_16x16x32_bf16 v[24:27], a[248:251], v[60:63], v[24:27]
  v_mfma_f32_16x16x32_bf16 v[28:31], a[252:255], v[60:63], v[28:31]
  buffer_load_dwordx4 v5, s[8:11], s56 offen offset:3072 sc1 lds
  s_nop 2
  v_cvt_pk_bf16_f32 v64, v16, v17
  v_cvt_pk_bf16_f32 v65, v18, v19
  v_cvt_pk_bf16_f32 v66, v20, v21
  v_cvt_pk_bf16_f32 v67, v22, v23
  buffer_store_dwordx4 v[64:67], v8, s[8:11], s49 offen sc1
  v_cvt_pk_bf16_f32 v68, v24, v25
  v_cvt_pk_bf16_f32 v69, v26, v27
  v_cvt_pk_bf16_f32 v70, v28, v29
  v_cvt_pk_bf16_f32 v71, v30, v31
  s_add_u32 s54, s49, s50
  buffer_store_dwordx4 v[68:71], v8, s[8:11], s54 offen sc1
  s_add_u32 s44, s44, s53
  s_lshl_b32 s33, s53, 18
  s_add_u32 s49, s49, s33
  v_xor_b32 v6, 0x10000, v6
  v_xor_b32 v7, 0x10000, v7
  s_branch L_WO_got
L_WO_end:
  s_endpgm
L_role_GATE:
  s_lshl_b32 s40, s29, 2
  s_add_u32 s40, s40, s30
  s_lshl_b32 s40, s40, 7
  s_lshl_b32 s42, s29, 7
  s_add_u32 s42, s42, 45056
  s_cmp_lg_u32 s30, 0
  s_cbranch_scc1 w0_75
  s_mov_b64 s[96:97], exec
  s_mov_b64 exec, 1
  v_mov_b32 v3, s42
  v_mov_b32 v4, 0
  buffer_store_dword v4, v3, s[8:11], 0 offen sc1
  s_mov_b64 exec, s[96:97]
w0_75:
  s_waitcnt vmcnt(0)
  s_barrier
  s_cmp_lg_u32 s30, 0
  s_cbranch_scc1 ar_76
  s_mov_b64 s[96:97], exec
  s_mov_b64 exec, 1
  v_mov_b32 v3, 64
  v_mov_b32 v4, 1
  buffer_atomic_add v4, v3, s[12:15], 0 offen
  s_mov_b64 exec, s[96:97]
ar_76:
  s_load_dwordx2 s[4:5], s[0:1], 0
  s_waitcnt lgkmcnt(0)
  s_mov_b32 s16, s4
  s_mov_b32 s17, s5
  s_mov_b32 s18, 4194304
  s_mov_b32 s19, 0x20000
  s_load_dwordx2 s[4:5], s[0:1], 80
  s_waitcnt lgkmcnt(0)
  s_mov_b32 s20, s4
  s_mov_b32 s21, s5
  s_mov_b32 s22, 2048
  s_mov_b32 s23, 0x20000
  v_lshlrev_b32 v2, 4, v1
  s_mov_b32 s43, 0xffff0000
  buffer_load_dwordx4 v[60:63], v2, s[20:23], 0 offen
  buffer_load_dwordx4 v[64:67], v2, s[20:23], 0 offen offset:1024
  s_add_u32 s41, s40, 128
  s_waitcnt vmcnt(0)
  v_lshlrev_b32 v8, 16, v60
  v_and_b32 v9, s43, v60
  v_lshlrev_b32 v10, 16, v61
  v_and_b32 v11, s43, v61
  v_lshlrev_b32 v12, 16, v62
  v_and_b32 v13, s43, v62
  v_lshlrev_b32 v14, 16, v63
  v_and_b32 v15, s43, v63
  v_lshlrev_b32 v16, 16, v64
  v_and_b32 v17, s43, v64
  v_lshlrev_b32 v18, 16, v65
  v_and_b32 v19, s43, v65
  v_lshlrev_b32 v20, 16, v66
  v_and_b32 v21, s43, v66
  v_lshlrev_b32 v22, 16, v67
  v_and_b32 v23, s43, v67
L_GATE_loop:
  s_add_u32 s33, s40, 0
  s_lshl_b32 s33, s33, 11
  buffer_load_dwordx4 v[24:27], v2, s[16:19], s33 offen
  buffer_load_dwordx4 v[28:31], v2, s[16:19], s33 offen offset:1024
  s_add_u32 s33, s40, 1
  s_lshl_b32 s33, s33, 11
  buffer_load_dwordx4 v[32:35], v2, s[16:19], s33 offen
  buffer_load_dwordx4 v[36:39], v2, s[16:19], s33 offen offset:1024
  s_add_u32 s33, s40, 2
  s_lshl_b32 s33, s33, 11
  buffer_load_dwordx4 v[40:43], v2, s[16:19], s33 offen
  buffer_load_dwordx4 v[44:47], v2, s[16:19], s33 offen offset:1024
  s_add_u32 s33, s40, 3
  s_lshl_b32 s33, s33, 11
  buffer_load_dwordx4 v[48:51], v2, s[16:19], s33 offen
  buffer_load_dwordx4 v[52:55], v2, s[16:19], s33 offen offset:1024
  s_waitcnt vmcnt(6)
  v_lshlrev_b32 v3, 16, v24
  v_and_b32 v4, s43, v24
  v_mul_f32 v3, v3, v8
  v_mul_f32 v4, v4, v9
  v_cvt_pk_bf16_f32 v5, v3, v4
  v_lshlrev_b32 v3, 16, v5
  v_and_b32 v4, s43, v5
  v_add_f32 v56, v3, v4
  v_lshlrev_b32 v3, 16, v25
  v_and_b32 v4, s43, v25
  v_mul_f32 v3, v3, v10
  v_mul_f32 v4, v4, v11
  v_cvt_pk_bf16_f32 v5, v3, v4
  v_lshlrev_b32 v3, 16, v5
  v_and_b32 v4, s43, v5
  v_add_f32 v56, v56, v3
  v_add_f32 v56, v56, v4
  v_lshlrev_b32 v3, 16, v26
  v_and_b32 v4, s43, v26
  v_mul_f32 v3, v3, v12
  v_mul_f32 v4, v4, v13
  v_cvt_pk_bf16_f32 v5, v3, v4
  v_lshlrev_b32 v3, 16, v5
  v_and_b32 v4, s43, v5
  v_add_f32 v56, v56, v3
  v_add_f32 v56, v56, v4
  v_lshlrev_b32 v3, 16, v27
  v_and_b32 v4, s43, v27
  v_mul_f32 v3, v3, v14
  v_mul_f32 v4, v4, v15
  v_cvt_pk_bf16_f32 v5, v3, v4
  v_lshlrev_b32 v3, 16, v5
  v_and_b32 v4, s43, v5
  v_add_f32 v56, v56, v3
  v_add_f32 v56, v56, v4
  v_lshlrev_b32 v3, 16, v28
  v_and_b32 v4, s43, v28
  v_mul_f32 v3, v3, v16
  v_mul_f32 v4, v4, v17
  v_cvt_pk_bf16_f32 v5, v3, v4
  v_lshlrev_b32 v3, 16, v5
  v_and_b32 v4, s43, v5
  v_add_f32 v56, v56, v3
  v_add_f32 v56, v56, v4
  v_lshlrev_b32 v3, 16, v29
  v_and_b32 v4, s43, v29
  v_mul_f32 v3, v3, v18
  v_mul_f32 v4, v4, v19
  v_cvt_pk_bf16_f32 v5, v3, v4
  v_lshlrev_b32 v3, 16, v5
  v_and_b32 v4, s43, v5
  v_add_f32 v56, v56, v3
  v_add_f32 v56, v56, v4
  v_lshlrev_b32 v3, 16, v30
  v_and_b32 v4, s43, v30
  v_mul_f32 v3, v3, v20
  v_mul_f32 v4, v4, v21
  v_cvt_pk_bf16_f32 v5, v3, v4
  v_lshlrev_b32 v3, 16, v5
  v_and_b32 v4, s43, v5
  v_add_f32 v56, v56, v3
  v_add_f32 v56, v56, v4
  v_lshlrev_b32 v3, 16, v31
  v_and_b32 v4, s43, v31
  v_mul_f32 v3, v3, v22
  v_mul_f32 v4, v4, v23
  v_cvt_pk_bf16_f32 v5, v3, v4
  v_lshlrev_b32 v3, 16, v5
  v_and_b32 v4, s43, v5
  v_add_f32 v56, v56, v3
  v_add_f32 v56, v56, v4
  s_waitcnt vmcnt(4)
  v_lshlrev_b32 v3, 16, v32
  v_and_b32 v4, s43, v32
  v_mul_f32 v3, v3, v8
  v_mul_f32 v4, v4, v9
  v_cvt_pk_bf16_f32 v5, v3, v4
  v_lshlrev_b32 v3, 16, v5
  v_and_b32 v4, s43, v5
  v_add_f32 v57, v3, v4
  v_lshlrev_b32 v3, 16, v33
  v_and_b32 v4, s43, v33
  v_mul_f32 v3, v3, v10
  v_mul_f32 v4, v4, v11
  v_cvt_pk_bf16_f32 v5, v3, v4
  v_lshlrev_b32 v3, 16, v5
  v_and_b32 v4, s43, v5
  v_add_f32 v57, v57, v3
  v_add_f32 v57, v57, v4
  v_lshlrev_b32 v3, 16, v34
  v_and_b32 v4, s43, v34
  v_mul_f32 v3, v3, v12
  v_mul_f32 v4, v4, v13
  v_cvt_pk_bf16_f32 v5, v3, v4
  v_lshlrev_b32 v3, 16, v5
  v_and_b32 v4, s43, v5
  v_add_f32 v57, v57, v3
  v_add_f32 v57, v57, v4
  v_lshlrev_b32 v3, 16, v35
  v_and_b32 v4, s43, v35
  v_mul_f32 v3, v3, v14
  v_mul_f32 v4, v4, v15
  v_cvt_pk_bf16_f32 v5, v3, v4
  v_lshlrev_b32 v3, 16, v5
  v_and_b32 v4, s43, v5
  v_add_f32 v57, v57, v3
  v_add_f32 v57, v57, v4
  v_lshlrev_b32 v3, 16, v36
  v_and_b32 v4, s43, v36
  v_mul_f32 v3, v3, v16
  v_mul_f32 v4, v4, v17
  v_cvt_pk_bf16_f32 v5, v3, v4
  v_lshlrev_b32 v3, 16, v5
  v_and_b32 v4, s43, v5
  v_add_f32 v57, v57, v3
  v_add_f32 v57, v57, v4
  v_lshlrev_b32 v3, 16, v37
  v_and_b32 v4, s43, v37
  v_mul_f32 v3, v3, v18
  v_mul_f32 v4, v4, v19
  v_cvt_pk_bf16_f32 v5, v3, v4
  v_lshlrev_b32 v3, 16, v5
  v_and_b32 v4, s43, v5
  v_add_f32 v57, v57, v3
  v_add_f32 v57, v57, v4
  v_lshlrev_b32 v3, 16, v38
  v_and_b32 v4, s43, v38
  v_mul_f32 v3, v3, v20
  v_mul_f32 v4, v4, v21
  v_cvt_pk_bf16_f32 v5, v3, v4
  v_lshlrev_b32 v3, 16, v5
  v_and_b32 v4, s43, v5
  v_add_f32 v57, v57, v3
  v_add_f32 v57, v57, v4
  v_lshlrev_b32 v3, 16, v39
  v_and_b32 v4, s43, v39
  v_mul_f32 v3, v3, v22
  v_mul_f32 v4, v4, v23
  v_cvt_pk_bf16_f32 v5, v3, v4
  v_lshlrev_b32 v3, 16, v5
  v_and_b32 v4, s43, v5
  v_add_f32 v57, v57, v3
  v_add_f32 v57, v57, v4
  s_waitcnt vmcnt(2)
  v_lshlrev_b32 v3, 16, v40
  v_and_b32 v4, s43, v40
  v_mul_f32 v3, v3, v8
  v_mul_f32 v4, v4, v9
  v_cvt_pk_bf16_f32 v5, v3, v4
  v_lshlrev_b32 v3, 16, v5
  v_and_b32 v4, s43, v5
  v_add_f32 v58, v3, v4
  v_lshlrev_b32 v3, 16, v41
  v_and_b32 v4, s43, v41
  v_mul_f32 v3, v3, v10
  v_mul_f32 v4, v4, v11
  v_cvt_pk_bf16_f32 v5, v3, v4
  v_lshlrev_b32 v3, 16, v5
  v_and_b32 v4, s43, v5
  v_add_f32 v58, v58, v3
  v_add_f32 v58, v58, v4
  v_lshlrev_b32 v3, 16, v42
  v_and_b32 v4, s43, v42
  v_mul_f32 v3, v3, v12
  v_mul_f32 v4, v4, v13
  v_cvt_pk_bf16_f32 v5, v3, v4
  v_lshlrev_b32 v3, 16, v5
  v_and_b32 v4, s43, v5
  v_add_f32 v58, v58, v3
  v_add_f32 v58, v58, v4
  v_lshlrev_b32 v3, 16, v43
  v_and_b32 v4, s43, v43
  v_mul_f32 v3, v3, v14
  v_mul_f32 v4, v4, v15
  v_cvt_pk_bf16_f32 v5, v3, v4
  v_lshlrev_b32 v3, 16, v5
  v_and_b32 v4, s43, v5
  v_add_f32 v58, v58, v3
  v_add_f32 v58, v58, v4
  v_lshlrev_b32 v3, 16, v44
  v_and_b32 v4, s43, v44
  v_mul_f32 v3, v3, v16
  v_mul_f32 v4, v4, v17
  v_cvt_pk_bf16_f32 v5, v3, v4
  v_lshlrev_b32 v3, 16, v5
  v_and_b32 v4, s43, v5
  v_add_f32 v58, v58, v3
  v_add_f32 v58, v58, v4
  v_lshlrev_b32 v3, 16, v45
  v_and_b32 v4, s43, v45
  v_mul_f32 v3, v3, v18
  v_mul_f32 v4, v4, v19
  v_cvt_pk_bf16_f32 v5, v3, v4
  v_lshlrev_b32 v3, 16, v5
  v_and_b32 v4, s43, v5
  v_add_f32 v58, v58, v3
  v_add_f32 v58, v58, v4
  v_lshlrev_b32 v3, 16, v46
  v_and_b32 v4, s43, v46
  v_mul_f32 v3, v3, v20
  v_mul_f32 v4, v4, v21
  v_cvt_pk_bf16_f32 v5, v3, v4
  v_lshlrev_b32 v3, 16, v5
  v_and_b32 v4, s43, v5
  v_add_f32 v58, v58, v3
  v_add_f32 v58, v58, v4
  v_lshlrev_b32 v3, 16, v47
  v_and_b32 v4, s43, v47
  v_mul_f32 v3, v3, v22
  v_mul_f32 v4, v4, v23
  v_cvt_pk_bf16_f32 v5, v3, v4
  v_lshlrev_b32 v3, 16, v5
  v_and_b32 v4, s43, v5
  v_add_f32 v58, v58, v3
  v_add_f32 v58, v58, v4
  s_waitcnt vmcnt(0)
  v_lshlrev_b32 v3, 16, v48
  v_and_b32 v4, s43, v48
  v_mul_f32 v3, v3, v8
  v_mul_f32 v4, v4, v9
  v_cvt_pk_bf16_f32 v5, v3, v4
  v_lshlrev_b32 v3, 16, v5
  v_and_b32 v4, s43, v5
  v_add_f32 v59, v3, v4
  v_lshlrev_b32 v3, 16, v49
  v_and_b32 v4, s43, v49
  v_mul_f32 v3, v3, v10
  v_mul_f32 v4, v4, v11
  v_cvt_pk_bf16_f32 v5, v3, v4
  v_lshlrev_b32 v3, 16, v5
  v_and_b32 v4, s43, v5
  v_add_f32 v59, v59, v3
  v_add_f32 v59, v59, v4
  v_lshlrev_b32 v3, 16, v50
  v_and_b32 v4, s43, v50
  v_mul_f32 v3, v3, v12
  v_mul_f32 v4, v4, v13
  v_cvt_pk_bf16_f32 v5, v3, v4
  v_lshlrev_b32 v3, 16, v5
  v_and_b32 v4, s43, v5
  v_add_f32 v59, v59, v3
  v_add_f32 v59, v59, v4
  v_lshlrev_b32 v3, 16, v51
  v_and_b32 v4, s43, v51
  v_mul_f32 v3, v3, v14
  v_mul_f32 v4, v4, v15
  v_cvt_pk_bf16_f32 v5, v3, v4
  v_lshlrev_b32 v3, 16, v5
  v_and_b32 v4, s43, v5
  v_add_f32 v59, v59, v3
  v_add_f32 v59, v59, v4
  v_lshlrev_b32 v3, 16, v52
  v_and_b32 v4, s43, v52
  v_mul_f32 v3, v3, v16
  v_mul_f32 v4, v4, v17
  v_cvt_pk_bf16_f32 v5, v3, v4
  v_lshlrev_b32 v3, 16, v5
  v_and_b32 v4, s43, v5
  v_add_f32 v59, v59, v3
  v_add_f32 v59, v59, v4
  v_lshlrev_b32 v3, 16, v53
  v_and_b32 v4, s43, v53
  v_mul_f32 v3, v3, v18
  v_mul_f32 v4, v4, v19
  v_cvt_pk_bf16_f32 v5, v3, v4
  v_lshlrev_b32 v3, 16, v5
  v_and_b32 v4, s43, v5
  v_add_f32 v59, v59, v3
  v_add_f32 v59, v59, v4
  v_lshlrev_b32 v3, 16, v54
  v_and_b32 v4, s43, v54
  v_mul_f32 v3, v3, v20
  v_mul_f32 v4, v4, v21
  v_cvt_pk_bf16_f32 v5, v3, v4
  v_lshlrev_b32 v3, 16, v5
  v_and_b32 v4, s43, v5
  v_add_f32 v59, v59, v3
  v_add_f32 v59, v59, v4
  v_lshlrev_b32 v3, 16, v55
  v_and_b32 v4, s43, v55
  v_mul_f32 v3, v3, v22
  v_mul_f32 v4, v4, v23
  v_cvt_pk_bf16_f32 v5, v3, v4
  v_lshlrev_b32 v3, 16, v5
  v_and_b32 v4, s43, v5
  v_add_f32 v59, v59, v3
  v_add_f32 v59, v59, v4
  v_add_f32_dpp v56, v56, v56 row_ror:8 row_mask:0xf bank_mask:0xf
  v_add_f32_dpp v57, v57, v57 row_ror:8 row_mask:0xf bank_mask:0xf
  v_add_f32_dpp v58, v58, v58 row_ror:8 row_mask:0xf bank_mask:0xf
  v_add_f32_dpp v59, v59, v59 row_ror:8 row_mask:0xf bank_mask:0xf
  v_add_f32_dpp v56, v56, v56 row_ror:4 row_mask:0xf bank_mask:0xf
  v_add_f32_dpp v57, v57, v57 row_ror:4 row_mask:0xf bank_mask:0xf
  v_add_f32_dpp v58, v58, v58 row_ror:4 row_mask:0xf bank_mask:0xf
  v_add_f32_dpp v59, v59, v59 row_ror:4 row_mask:0xf bank_mask:0xf
  v_add_f32_dpp v56, v56, v56 row_ror:2 row_mask:0xf bank_mask:0xf
  v_add_f32_dpp v57, v57, v57 row_ror:2 row_mask:0xf bank_mask:0xf
  v_add_f32_dpp v58, v58, v58 row_ror:2 row_mask:0xf bank_mask:0xf
  v_add_f32_dpp v59, v59, v59 row_ror:2 row_mask:0xf bank_mask:0xf
  v_add_f32_dpp v56, v56, v56 row_ror:1 row_mask:0xf bank_mask:0xf
  v_add_f32_dpp v57, v57, v57 row_ror:1 row_mask:0xf bank_mask:0xf
  v_add_f32_dpp v58, v58, v58 row_ror:1 row_mask:0xf bank_mask:0xf
  v_add_f32_dpp v59, v59, v59 row_ror:1 row_mask:0xf bank_mask:0xf
  v_mov_b32 v60, v56
  v_mov_b32 v61, v57
  v_mov_b32 v62, v58
  v_mov_b32 v63, v59
  v_permlane16_swap_b32 v56, v60
  v_permlane16_swap_b32 v57, v61
  v_permlane16_swap_b32 v58, v62
  v_permlane16_swap_b32 v59, v63
  v_add_f32 v56, v56, v60
  v_add_f32 v57, v57, v61
  v_add_f32 v58, v58, v62
  v_add_f32 v59, v59, v63
  v_mov_b32 v60, v56
  v_mov_b32 v61, v57
  v_mov_b32 v62, v58
  v_mov_b32 v63, v59
  v_permlane32_swap_b32 v56, v60
  v_permlane32_swap_b32 v57, v61
  v_permlane32_swap_b32 v58, v62
  v_permlane32_swap_b32 v59, v63
  v_add_f32 v56, v56, v60
  v_add_f32 v57, v57, v61
  v_add_f32 v58, v58, v62
  v_add_f32 v59, v59, v63
  v_cmp_eq_u32 vcc, 1, v1
  s_nop 1
  v_cndmask_b32 v3, v56, v57, vcc
  v_cmp_eq_u32 vcc, 2, v1
  s_nop 1
  v_cndmask_b32 v3, v3, v58, vcc
  v_cmp_eq_u32 vcc, 3, v1
  s_nop 1
  v_cndmask_b32 v3, v3, v59, vcc
  v_cvt_pk_bf16_f32 v3, v3, v3
  v_and_b32 v3, s43, v3
  v_mul_f32 v3, 0xbfb8aa3b, v3
  v_exp_f32 v3, v3
  s_nop 0
  v_add_f32 v3, 1.0, v3
  v_rcp_f32 v3, v3
  s_nop 0
  v_cvt_pk_bf16_f32 v4, v3, v3
  v_and_b32 v4, s43, v4
  v_sub_f32 v5, 1.0, v4
  v_cvt_pk_bf16_f32 v5, v4, v5
  v_lshlrev_b32 v6, 2, v1
  s_lshl_b32 s44, s40, 2
  s_add_u32 s44, s44, 65536
  s_mov_b64 s[96:97], exec
  s_mov_b64 exec, 15
  buffer_store_dword v5, v6, s[8:11], s44 offen sc1
  s_mov_b64 exec, s[96:97]
  s_add_u32 s40, s40, 4
  s_cmp_lt_u32 s40, s41
  s_cbranch_scc1 L_GATE_loop
  s_waitcnt vmcnt(0)
  s_barrier
  s_cmp_lg_u32 s30, 0
  s_cbranch_scc1 w0_78
  s_mov_b64 s[96:97], exec
  s_mov_b64 exec, 1
  v_mov_b32 v3, s42
  v_mov_b32 v4, 1
  buffer_store_dword v4, v3, s[8:11], 0 offen sc1
  s_mov_b64 exec, s[96:97]
w0_78:
L_role_MIX:
  s_and_b32 s33, s28, 3
  s_lshl_b32 s33, s33, 3
  s_and_b32 s29, s39, 7
  s_add_u32 s29, s29, s33
  s_load_dwordx2 s[4:5], s[0:1], 88
  s_waitcnt lgkmcnt(0)
  s_mov_b32 s16, s4
  s_mov_b32 s17, s5
  s_mov_b32 s18, 4194304
  s_mov_b32 s19, 0x20000
  s_cmp_lg_u32 s30, 0
  s_cbranch_scc1 w0_79
  v_mov_b32 v5, 64
  s_mov_b32 s32, 0
wf_80:
  buffer_load_dword v6, v5, s[12:15], 0 offen sc1
  s_waitcnt vmcnt(0)
  v_cmp_gt_u32 vcc, 256, v6
  s_cbranch_vccz wfd_81
  s_sleep 4
  s_add_u32 s32, s32, 1
  s_cmp_lt_u32 s32, s31
  s_cbranch_scc1 wf_80
  s_mov_b32 s31, 0
wfd_81:
w0_79:
  s_barrier
  s_lshl_b32 s41, s29, 2
  s_add_u32 s41, s41, s30
  s_lshr_b32 s40, s41, 6
  s_and_b32 s41, s41, 63
  v_lshlrev_b32 v2, 4, v1
  s_lshr_b32 s33, s41, 3
  v_and_b32 v5, 3, v1
  v_lshlrev_b32 v5, 3, v5
  v_add_u32 v5, s33, v5
  v_lshlrev_b32 v5, 7, v5
  v_add_u32 v3, 24576, v5
  s_lshl_b32 s34, s40, 12
  s_add_u32 s34, s34, 16384
  v_add_u32 v4, s34, v5
  v_and_b32 v5, 15, v1
  s_bfe_u32 s34, s41, 0x10002
  s_lshl_b32 s34, s34, 4
  v_add_u32 v5, s34, v5
  v_lshlrev_b32 v8, 2, v5
  v_lshlrev_b32 v9, 11, v5
  v_lshrrev_b32 v6, 4, v1
  v_lshl_add_u32 v9, v6, 4, v9
  s_lshl_b32 s33, s33, 8
  s_and_b32 s34, s41, 3
  s_lshl_b32 s34, s34, 6
  s_add_u32 s33, s33, s34
  v_add_u32 v9, s33, v9
  s_mov_b32 s47, 0xffff0000
  v_and_b32 v5, 3, v1
  v_lshlrev_b32 v5, 7, v5
  v_add_u32 v5, 45056, v5
  s_mov_b32 s32, 0
wf_82:
  buffer_load_dword v6, v5, s[8:11], 0 offen sc1
  s_waitcnt vmcnt(0)
  v_cmp_gt_u32 vcc, 1, v6
  s_cbranch_vccz wfd_83
  s_sleep 8
  s_add_u32 s32, s32, 1
  s_cmp_lt_u32 s32, s31
  s_cbranch_scc1 wf_82
  s_mov_b32 s31, 0
wfd_83:
L_MIX_loop:
  s_lshr_b32 s45, s40, 1
  s_add_u32 s45, s45, 1
  s_add_u32 s43, s40, 1
  s_mov_b32 s32, 0
wf_84:
  buffer_load_dword v5, v4, s[8:11], 0 offen sc1
  s_waitcnt vmcnt(0)
  v_cmp_gt_u32 vcc, s45, v5
  s_cbranch_vccz wfd_85
  s_sleep 4
  s_add_u32 s32, s32, 1
  s_cmp_lt_u32 s32, s31
  s_cbranch_scc1 wf_84
  s_mov_b32 s31, 0
wfd_85:
  s_lshl_b32 s42, s40, 18
  s_lshl_b32 s33, s41, 10
  s_add_u32 s42, s42, s33
  s_add_u32 s46, s42, 117440512
  buffer_load_dwordx4 v[32:35], v2, s[8:11], s46 offen sc1
  s_add_u32 s46, s42, 117506048
  buffer_load_dwordx4 v[36:39], v2, s[8:11], s46 offen sc1
  s_add_u32 s46, s42, 117571584
  buffer_load_dwordx4 v[40:43], v2, s[8:11], s46 offen sc1
  s_add_u32 s46, s42, 117637120
  buffer_load_dwordx4 v[44:47], v2, s[8:11], s46 offen sc1
  s_lshl_b32 s44, s40, 7
  s_add_u32 s44, s44, 65536
  buffer_load_dword v7, v8, s[8:11], s44 offen sc1
  s_cmp_eq_u32 s40, 62
  s_cselect_b32 s46, 24576, 0
  s_mov_b32 s32, 0
wf_86:
  buffer_load_dword v5, v3, s[8:11], s46 offen sc1
  s_waitcnt vmcnt(0)
  v_cmp_gt_u32 vcc, s43, v5
  s_cbranch_vccz wfd_87
  s_add_u32 s32, s32, 1
  s_cmp_lt_u32 s32, s31
  s_cbranch_scc1 wf_86
  s_mov_b32 s31, 0
wfd_87:
  s_add_u32 s46, s42, 100663296
  buffer_load_dwordx4 v[16:19], v2, s[8:11], s46 offen sc1
  s_add_u32 s46, s42, 100728832
  buffer_load_dwordx4 v[20:23], v2, s[8:11], s46 offen sc1
  s_add_u32 s46, s42, 100794368
  buffer_load_dwordx4 v[24:27], v2, s[8:11], s46 offen sc1
  s_add_u32 s46, s42, 100859904
  buffer_load_dwordx4 v[28:31], v2, s[8:11], s46 offen sc1
  v_lshlrev_b32 v56, 16, v32
  v_and_b32 v57, s47, v32
  v_lshlrev_b32 v58, 16, v33
  v_and_b32 v59, s47, v33
  v_lshlrev_b32 v60, 16, v34
  v_and_b32 v61, s47, v34
  v_lshlrev_b32 v62, 16, v35
  v_and_b32 v63, s47, v35
  v_lshlrev_b32 v5, 16, v36
  v_and_b32 v6, s47, v36
  v_add_f32 v56, v56, v5
  v_add_f32 v57, v57, v6
  v_lshlrev_b32 v5, 16, v37
  v_and_b32 v6, s47, v37
  v_add_f32 v58, v58, v5
  v_add_f32 v59, v59, v6
  v_lshlrev_b32 v5, 16, v38
  v_and_b32 v6, s47, v38
  v_add_f32 v60, v60, v5
  v_add_f32 v61, v61, v6
  v_lshlrev_b32 v5, 16, v39
  v_and_b32 v6, s47, v39
  v_add_f32 v62, v62, v5
  v_add_f32 v63, v63, v6
  v_lshlrev_b32 v5, 16, v40
  v_and_b32 v6, s47, v40
  v_add_f32 v56, v56, v5
  v_add_f32 v57, v57, v6
  v_lshlrev_b32 v5, 16, v41
  v_and_b32 v6, s47, v41
  v_add_f32 v58, v58, v5
  v_add_f32 v59, v59, v6
  v_lshlrev_b32 v5, 16, v42
  v_and_b32 v6, s47, v42
  v_add_f32 v60, v60, v5
  v_add_f32 v61, v61, v6
  v_lshlrev_b32 v5, 16, v43
  v_and_b32 v6, s47, v43
  v_add_f32 v62, v62, v5
  v_add_f32 v63, v63, v6
  v_lshlrev_b32 v5, 16, v44
  v_and_b32 v6, s47, v44
  v_add_f32 v56, v56, v5
  v_add_f32 v57, v57, v6
  v_lshlrev_b32 v5, 16, v45
  v_and_b32 v6, s47, v45
  v_add_f32 v58, v58, v5
  v_add_f32 v59, v59, v6
  v_lshlrev_b32 v5, 16, v46
  v_and_b32 v6, s47, v46
  v_add_f32 v60, v60, v5
  v_add_f32 v61, v61, v6
  v_lshlrev_b32 v5, 16, v47
  v_and_b32 v6, s47, v47
  v_add_f32 v62, v62, v5
  v_add_f32 v63, v63, v6
  v_lshlrev_b32 v10, 16, v7
  v_and_b32 v11, s47, v7
  v_mul_f32 v56, v56, v11
  v_mul_f32 v57, v57, v11
  v_mul_f32 v58, v58, v11
  v_mul_f32 v59, v59, v11
  v_mul_f32 v60, v60, v11
  v_mul_f32 v61, v61, v11
  v_mul_f32 v62, v62, v11
  v_mul_f32 v63, v63, v11
  s_waitcnt vmcnt(0)
  v_lshlrev_b32 v48, 16, v16
  v_and_b32 v49, s47, v16
  v_lshlrev_b32 v50, 16, v17
  v_and_b32 v51, s47, v17
  v_lshlrev_b32 v52, 16, v18
  v_and_b32 v53, s47, v18
  v_lshlrev_b32 v54, 16, v19
  v_and_b32 v55, s47, v19
  v_lshlrev_b32 v5, 16, v20
  v_and_b32 v6, s47, v20
  v_add_f32 v48, v48, v5
  v_add_f32 v49, v49, v6
  v_lshlrev_b32 v5, 16, v21
  v_and_b32 v6, s47, v21
  v_add_f32 v50, v50, v5
  v_add_f32 v51, v51, v6
  v_lshlrev_b32 v5, 16, v22
  v_and_b32 v6, s47, v22
  v_add_f32 v52, v52, v5
  v_add_f32 v53, v53, v6
  v_lshlrev_b32 v5, 16, v23
  v_and_b32 v6, s47, v23
  v_add_f32 v54, v54, v5
  v_add_f32 v55, v55, v6
  v_lshlrev_b32 v5, 16, v24
  v_and_b32 v6, s47, v24
  v_add_f32 v48, v48, v5
  v_add_f32 v49, v49, v6
  v_lshlrev_b32 v5, 16, v25
  v_and_b32 v6, s47, v25
  v_add_f32 v50, v50, v5
  v_add_f32 v51, v51, v6
  v_lshlrev_b32 v5, 16, v26
  v_and_b32 v6, s47, v26
  v_add_f32 v52, v52, v5
  v_add_f32 v53, v53, v6
  v_lshlrev_b32 v5, 16, v27
  v_and_b32 v6, s47, v27
  v_add_f32 v54, v54, v5
  v_add_f32 v55, v55, v6
  v_lshlrev_b32 v5, 16, v28
  v_and_b32 v6, s47, v28
  v_add_f32 v48, v48, v5
  v_add_f32 v49, v49, v6
  v_lshlrev_b32 v5, 16, v29
  v_and_b32 v6, s47, v29
  v_add_f32 v50, v50, v5
  v_add_f32 v51, v51, v6
  v_lshlrev_b32 v5, 16, v30
  v_and_b32 v6, s47, v30
  v_add_f32 v52, v52, v5
  v_add_f32 v53, v53, v6
  v_lshlrev_b32 v5, 16, v31
  v_and_b32 v6, s47, v31
  v_add_f32 v54, v54, v5
  v_add_f32 v55, v55, v6
  v_fma_f32 v48, v48, v10, v56
  v_fma_f32 v49, v49, v10, v57
  v_fma_f32 v50, v50, v10, v58
  v_fma_f32 v51, v51, v10, v59
  v_fma_f32 v52, v52, v10, v60
  v_fma_f32 v53, v53, v10, v61
  v_fma_f32 v54, v54, v10, v62
  v_fma_f32 v55, v55, v10, v63
  v_cvt_pk_bf16_f32 v64, v48, v49
  v_cvt_pk_bf16_f32 v65, v50, v51
  v_cvt_pk_bf16_f32 v66, v52, v53
  v_cvt_pk_bf16_f32 v67, v54, v55
  s_lshl_b32 s44, s40, 16
  buffer_store_dwordx4 v[64:67], v9, s[16:19], s44 offen
  s_add_u32 s40, s40, 2
  s_cmp_lt_u32 s40, 64
  s_cbranch_scc1 L_MIX_loop
  s_waitcnt vmcnt(0)
  s_barrier
  s_endpgm
L_role_QK:
  s_load_dwordx2 s[4:5], s[0:1], 16
  s_waitcnt lgkmcnt(0)
  s_mov_b32 s20, s4
  s_mov_b32 s21, s5
  s_mov_b32 s22, 8388608
  s_mov_b32 s23, 0x20000
  s_mov_b32 s40, s29
  s_mov_b32 s41, s29
  s_lshl_b32 s33, s28, 3
  s_add_u32 s41, s41, s33
  s_lshl_b32 s42, s28, 20
  s_add_u32 s42, s42, 1048576
  v_and_b32 v120, 15, v1
  v_lshrrev_b32 v121, 4, v1
  v_and_b32 v122, 7, v1
  v_bfe_u32 v123, v1, 3, 1
  v_lshlrev_b32 v2, 4, v1
  v_add_u32 v4, 131072, v2
  v_cmp_eq_u32 s[60:61], 0, v123
  v_and_b32 v9, 1, v1
  v_cmp_eq_u32 s[62:63], 1, v9
  v_mov_b32 v7, 0x44444444
  v_mov_b32 v9, 0xeeeeeeee
  v_cndmask_b32 v7, v7, v9, s[62:63]
  v_mov_b32 v20, -1
  v_mov_b32 v21, -1
  v_mov_b32 v22, -1
  v_mov_b32 v23, -1
  s_cmp_eq_u32 s30, 1
  s_cselect_b32 s34, 1, 3
  s_cselect_b32 s33, 12, 0
  s_sub_u32 s35, s30, 1
  s_cmp_ge_u32 s30, 2
  s_cselect_b32 s33, s35, s33
  s_mul_i32 s35, s34, 0
  s_add_u32 s35, s35, s33
  s_lshl_b32 s80, s35, 10
  s_mul_i32 s35, s34, 1
  s_add_u32 s35, s35, s33
  s_lshl_b32 s81, s35, 10
  s_mul_i32 s35, s34, 2
  s_add_u32 s35, s35, s33
  s_lshl_b32 s82, s35, 10
  s_mul_i32 s35, s34, 3
  s_add_u32 s35, s35, s33
  s_lshl_b32 s83, s35, 10
  v_and_b32 v8, 3, v1
  v_mul_lo_u32 v8, v8, s34
  v_add_u32 v8, s33, v8
  v_lshlrev_b32 v8, 7, v8
  s_add_u32 s33, s42, 344064
  v_add_u32 v3, s33, v8
  s_lshl_b32 s50, s41, 7
  s_add_u32 s50, s50, 28672
  s_lshl_b32 s54, s40, 7
  s_add_u32 s54, s54, s42
  s_add_u32 s54, s54, 327680
  v_lshlrev_b32 v8, 7, v121
  v_lshl_add_u32 v8, v122, 4, v8
  s_lshl_b32 s33, s40, 11
  s_lshl_b32 s34, s30, 9
  s_add_u32 s33, s33, s34
  s_add_u32 s33, s33, s42
  s_add_u32 s34, s33, 65536
  v_add_u32 v5, s34, v8
  s_add_u32 s35, s33, 393216
  v_lshlrev_b32 v8, 2, v1
  v_add_u32 v11, s35, v8
  s_add_u32 s34, s33, 196608
  v_lshlrev_b32 v8, 2, v1
  v_add_u32 v6, s34, v8
  v_lshlrev_b32 v17, 4, v1
  v_add_u32 v18, 147456, v17
  v_cmp_le_u32 s[66:67], 2, v121
  s_lshl_b32 s33, s30, 5
  v_add_u32 v8, s33, v120
  v_lshlrev_b32 v13, 4, v8
  v_lshl_add_u32 v13, v121, 2, v13
  v_add_u32 v14, 157696, v13
  v_add_u32 v13, 155648, v13
  v_bfe_u32 v8, v1, 2, 2
  v_lshl_add_u32 v8, v121, 3, v8
  v_and_b32 v9, 1, v1
  v_lshlrev_b32 v15, 4, v8
  v_lshl_add_u32 v15, v9, 3, v15
  v_add_u32 v16, 157696, v15
  v_add_u32 v15, 155648, v15
  v_and_b32 v8, 1, v1
  v_lshlrev_b32 v8, 12, v8
  s_lshl_b32 s33, s41, 7
  v_add_u32 v223, s33, v8
  s_mov_b32 s53, 0x3e0293ee
  s_lshl_b32 s77, s41, 12
  s_lshl_b32 s33, s30, 10
  s_add_u32 s77, s77, s33
  s_add_u32 s77, s77, 134217728
  s_lshl_b32 s57, s41, 13
  s_lshl_b32 s33, s30, 11
  s_add_u32 s57, s57, s33
  v_lshrrev_b32 v8, 1, v121
  v_and_b32 v9, 1, v121
  v_lshl_or_b32 v8, v9, 1, v8
  v_sub_u32 v8, v8, v121
  v_lshlrev_b32 v8, 6, v8
  v_add_u32 v6, v6, v8
  s_cmp_lg_u32 s30, 0
  s_cbranch_scc1 w0_88
  s_mov_b64 s[96:97], exec
  s_mov_b64 exec, 1
  v_mov_b32 v8, s50
  v_mov_b32 v9, 0
  buffer_store_dword v9, v8, s[8:11], 0 offen sc1
  s_mov_b64 exec, s[96:97]
w0_88:
  v_mov_b32 v27, 0
  buffer_store_dword v27, v27, s[8:11], s54 offen
  s_mov_b64 s[96:97], exec
  s_mov_b64 exec, s[60:61]
  s_mov_b32 s33, 0
  buffer_store_dwordx4 v[20:23], v5, s[8:11], s33 offen
  s_mov_b32 s33, 32768
  buffer_store_dwordx4 v[20:23], v5, s[8:11], s33 offen
  s_mov_b32 s33, 65536
  buffer_store_dwordx4 v[20:23], v5, s[8:11], s33 offen
  s_mov_b64 exec, s[96:97]
  v_lshrrev_b32 v8, 4, v1
  v_and_b32 v9, 15, v1
  v_and_b32 v10, 1, v8
  v_lshlrev_b32 v10, 1, v10
  v_xor_b32 v9, v9, v10
  v_lshlrev_b32 v8, 13, v8
  v_lshl_add_u32 v28, v9, 4, v8
  v_xor_b32 v29, 64, v28
  v_xor_b32 v30, 128, v28
  v_xor_b32 v31, 192, v28
  v_lshrrev_b32 v120, 4, v1
  v_bfe_u32 v121, v1, 2, 2
  v_and_b32 v122, 3, v1
  v_lshrrev_b32 v123, 1, v120
  v_lshlrev_b32 v124, 4, v123
  v_lshrrev_b32 v123, 1, v121
  v_lshl_add_u32 v124, v123, 3, v124
  v_lshlrev_b32 v125, 2, v123
  v_and_b32 v123, 1, v120
  v_lshl_add_u32 v124, v123, 2, v124
  v_lshl_add_u32 v125, v123, 1, v125
  v_and_b32 v123, 1, v121
  v_add_u32 v124, v124, v123
  v_add_u32 v125, v125, v123
  v_lshlrev_b32 v124, 8, v124
  v_lshlrev_b32 v125, 1, v125
  s_lshl_b32 s33, s30, 2
  v_lshrrev_b32 v123, 1, v122
  v_add_u32 v123, s33, v123
  v_xor_b32 v123, v123, v125
  v_lshl_add_u32 v124, v123, 4, v124
  v_and_b32 v123, 1, v122
  v_lshl_add_u32 v32, v123, 3, v124
  v_xor_b32 v33, 32, v32
  s_lshl_b32 s56, s30, 18
  s_lshl_b32 s33, s41, 8
  s_add_u32 s56, s56, s33
  s_lshl_b32 s35, s30, 13
  v_add_u32 v34, s35, v17
  s_mov_b32 s43, 0
  s_mov_b32 s44, 0
  s_mov_b32 s45, 1
  s_mov_b32 s46, 2
  s_mov_b32 s51, 0
  s_mov_b32 s64, 0
  s_mov_b32 s84, 0
  s_mov_b32 s85, 0
  s_add_u32 s47, s56, 0
  buffer_load_dwordx4 a[0:3], v28, s[20:23], s47 offen nt
  s_add_u32 s47, s56, 32768
  buffer_load_dwordx4 a[4:7], v29, s[20:23], s47 offen nt
  s_add_u32 s47, s56, 65536
  buffer_load_dwordx4 a[8:11], v30, s[20:23], s47 offen nt
  s_add_u32 s47, s56, 98304
  buffer_load_dwordx4 a[12:15], v31, s[20:23], s47 offen nt
  s_add_u32 s47, s56, 131072
  buffer_load_dwordx4 a[16:19], v28, s[20:23], s47 offen nt
  s_add_u32 s47, s56, 163840
  buffer_load_dwordx4 a[20:23], v29, s[20:23], s47 offen nt
  s_add_u32 s47, s56, 196608
  buffer_load_dwordx4 a[24:27], v30, s[20:23], s47 offen nt
  s_add_u32 s47, s56, 229376
  buffer_load_dwordx4 a[28:31], v31, s[20:23], s47 offen nt
  s_add_u32 s47, s56, 1048576
  buffer_load_dwordx4 a[32:35], v28, s[20:23], s47 offen nt
  s_add_u32 s47, s56, 1081344
  buffer_load_dwordx4 a[36:39], v29, s[20:23], s47 offen nt
  s_add_u32 s47, s56, 1114112
  buffer_load_dwordx4 a[40:43], v30, s[20:23], s47 offen nt
  s_add_u32 s47, s56, 1146880
  buffer_load_dwordx4 a[44:47], v31, s[20:23], s47 offen nt
  s_add_u32 s47, s56, 1179648
  buffer_load_dwordx4 a[48:51], v28, s[20:23], s47 offen nt
  s_add_u32 s47, s56, 1212416
  buffer_load_dwordx4 a[52:55], v29, s[20:23], s47 offen nt
  s_add_u32 s47, s56, 1245184
  buffer_load_dwordx4 a[56:59], v30, s[20:23], s47 offen nt
  s_add_u32 s47, s56, 1277952
  buffer_load_dwordx4 a[60:63], v31, s[20:23], s47 offen nt
  s_add_u32 s47, s56, 2097152
  buffer_load_dwordx4 a[64:67], v28, s[20:23], s47 offen nt
  s_add_u32 s47, s56, 2129920
  buffer_load_dwordx4 a[68:71], v29, s[20:23], s47 offen nt
  s_add_u32 s47, s56, 2162688
  buffer_load_dwordx4 a[72:75], v30, s[20:23], s47 offen nt
  s_add_u32 s47, s56, 2195456
  buffer_load_dwordx4 a[76:79], v31, s[20:23], s47 offen nt
  s_add_u32 s47, s56, 2228224
  buffer_load_dwordx4 a[80:83], v28, s[20:23], s47 offen nt
  s_add_u32 s47, s56, 2260992
  buffer_load_dwordx4 a[84:87], v29, s[20:23], s47 offen nt
  s_add_u32 s47, s56, 2293760
  buffer_load_dwordx4 a[88:91], v30, s[20:23], s47 offen nt
  s_add_u32 s47, s56, 2326528
  buffer_load_dwordx4 a[92:95], v31, s[20:23], s47 offen nt
  s_add_u32 s47, s56, 3145728
  buffer_load_dwordx4 a[96:99], v28, s[20:23], s47 offen nt
  s_add_u32 s47, s56, 3178496
  buffer_load_dwordx4 a[100:103], v29, s[20:23], s47 offen nt
  s_add_u32 s47, s56, 3211264
  buffer_load_dwordx4 a[104:107], v30, s[20:23], s47 offen nt
  s_add_u32 s47, s56, 3244032
  buffer_load_dwordx4 a[108:111], v31, s[20:23], s47 offen nt
  s_add_u32 s47, s56, 3276800
  buffer_load_dwordx4 a[112:115], v28, s[20:23], s47 offen nt
  s_add_u32 s47, s56, 3309568
  buffer_load_dwordx4 a[116:119], v29, s[20:23], s47 offen nt
  s_add_u32 s47, s56, 3342336
  buffer_load_dwordx4 a[120:123], v30, s[20:23], s47 offen nt
  s_add_u32 s47, s56, 3375104
  buffer_load_dwordx4 a[124:127], v31, s[20:23], s47 offen nt
  s_add_u32 s47, s56, 4194304
  buffer_load_dwordx4 a[128:131], v28, s[20:23], s47 offen nt
  s_add_u32 s47, s56, 4227072
  buffer_load_dwordx4 a[132:135], v29, s[20:23], s47 offen nt
  s_add_u32 s47, s56, 4259840
  buffer_load_dwordx4 a[136:139], v30, s[20:23], s47 offen nt
  s_add_u32 s47, s56, 4292608
  buffer_load_dwordx4 a[140:143], v31, s[20:23], s47 offen nt
  s_add_u32 s47, s56, 4325376
  buffer_load_dwordx4 a[144:147], v28, s[20:23], s47 offen nt
  s_add_u32 s47, s56, 4358144
  buffer_load_dwordx4 a[148:151], v29, s[20:23], s47 offen nt
  s_add_u32 s47, s56, 4390912
  buffer_load_dwordx4 a[152:155], v30, s[20:23], s47 offen nt
  s_add_u32 s47, s56, 4423680
  buffer_load_dwordx4 a[156:159], v31, s[20:23], s47 offen nt
  s_add_u32 s47, s56, 5242880
  buffer_load_dwordx4 a[160:163], v28, s[20:23], s47 offen nt
  s_add_u32 s47, s56, 5275648
  buffer_load_dwordx4 a[164:167], v29, s[20:23], s47 offen nt
  s_add_u32 s47, s56, 5308416
  buffer_load_dwordx4 a[168:171], v30, s[20:23], s47 offen nt
  s_add_u32 s47, s56, 5341184
  buffer_load_dwordx4 a[172:175], v31, s[20:23], s47 offen nt
  s_add_u32 s47, s56, 5373952
  buffer_load_dwordx4 a[176:179], v28, s[20:23], s47 offen nt
  s_add_u32 s47, s56, 5406720
  buffer_load_dwordx4 a[180:183], v29, s[20:23], s47 offen nt
  s_add_u32 s47, s56, 5439488
  buffer_load_dwordx4 a[184:187], v30, s[20:23], s47 offen nt
  s_add_u32 s47, s56, 5472256
  buffer_load_dwordx4 a[188:191], v31, s[20:23], s47 offen nt
  s_add_u32 s47, s56, 6291456
  buffer_load_dwordx4 a[192:195], v28, s[20:23], s47 offen nt
  s_add_u32 s47, s56, 6324224
  buffer_load_dwordx4 a[196:199], v29, s[20:23], s47 offen nt
  s_add_u32 s47, s56, 6356992
  buffer_load_dwordx4 a[200:203], v30, s[20:23], s47 offen nt
  s_add_u32 s47, s56, 6389760
  buffer_load_dwordx4 a[204:207], v31, s[20:23], s47 offen nt
  s_add_u32 s47, s56, 6422528
  buffer_load_dwordx4 a[208:211], v28, s[20:23], s47 offen nt
  s_add_u32 s47, s56, 6455296
  buffer_load_dwordx4 a[212:215], v29, s[20:23], s47 offen nt
  s_add_u32 s47, s56, 6488064
  buffer_load_dwordx4 a[216:219], v30, s[20:23], s47 offen nt
  s_add_u32 s47, s56, 6520832
  buffer_load_dwordx4 a[220:223], v31, s[20:23], s47 offen nt
  s_waitcnt vmcnt(48)
  ds_write_b128 v34, a[0:3] offset:0
  ds_write_b128 v34, a[4:7] offset:1024
  ds_write_b128 v34, a[8:11] offset:2048
  ds_write_b128 v34, a[12:15] offset:3072
  ds_write_b128 v34, a[16:19] offset:4096
  ds_write_b128 v34, a[20:23] offset:5120
  ds_write_b128 v34, a[24:27] offset:6144
  ds_write_b128 v34, a[28:31] offset:7168
  s_waitcnt lgkmcnt(0)
  s_barrier
  ds_read_b64_tr_b16 a[0:1], v32 offset:0
  ds_read_b64_tr_b16 a[2:3], v32 offset:512
  ds_read_b64_tr_b16 a[4:5], v32 offset:8192
  ds_read_b64_tr_b16 a[6:7], v32 offset:8704
  ds_read_b64_tr_b16 a[8:9], v33 offset:0
  ds_read_b64_tr_b16 a[10:11], v33 offset:512
  ds_read_b64_tr_b16 a[12:13], v33 offset:8192
  ds_read_b64_tr_b16 a[14:15], v33 offset:8704
  ds_read_b64_tr_b16 a[16:17], v32 offset:16384
  ds_read_b64_tr_b16 a[18:19], v32 offset:16896
  ds_read_b64_tr_b16 a[20:21], v32 offset:24576
  ds_read_b64_tr_b16 a[22:23], v32 offset:25088
  ds_read_b64_tr_b16 a[24:25], v33 offset:16384
  ds_read_b64_tr_b16 a[26:27], v33 offset:16896
  ds_read_b64_tr_b16 a[28:29], v33 offset:24576
  ds_read_b64_tr_b16 a[30:31], v33 offset:25088
  s_waitcnt lgkmcnt(0)
  s_add_u32 s47, s56, 7340032
  buffer_load_dwordx4 a[224:227], v28, s[20:23], s47 offen nt
  s_add_u32 s47, s56, 7372800
  buffer_load_dwordx4 a[228:231], v29, s[20:23], s47 offen nt
  s_add_u32 s47, s56, 7405568
  buffer_load_dwordx4 a[232:235], v30, s[20:23], s47 offen nt
  s_add_u32 s47, s56, 7438336
  buffer_load_dwordx4 a[236:239], v31, s[20:23], s47 offen nt
  s_add_u32 s47, s56, 7471104
  buffer_load_dwordx4 a[240:243], v28, s[20:23], s47 offen nt
  s_add_u32 s47, s56, 7503872
  buffer_load_dwordx4 a[244:247], v29, s[20:23], s47 offen nt
  s_add_u32 s47, s56, 7536640
  buffer_load_dwordx4 a[248:251], v30, s[20:23], s47 offen nt
  s_add_u32 s47, s56, 7569408
  buffer_load_dwordx4 a[252:255], v31, s[20:23], s47 offen nt
  s_cmp_lg_u32 s30, 0
  s_cbranch_scc1 ar_89
  s_mov_b64 s[96:97], exec
  s_mov_b64 exec, 1
  v_mov_b32 v8, 64
  v_mov_b32 v9, 1
  buffer_atomic_add v9, v8, s[12:15], 0 offen
  s_mov_b64 exec, s[96:97]
  s_branch are_90
ar_89:
  s_mov_b64 s[96:97], exec
  s_mov_b64 exec, 1
  v_mov_b32 v8, 81920
  buffer_load_dword v9, v8, s[8:11], 0 offen
  s_mov_b64 exec, s[96:97]
are_90:
  s_waitcnt vmcnt(49)
  ds_write_b128 v34, a[32:35] offset:32768
  ds_write_b128 v34, a[36:39] offset:33792
  ds_write_b128 v34, a[40:43] offset:34816
  ds_write_b128 v34, a[44:47] offset:35840
  ds_write_b128 v34, a[48:51] offset:36864
  ds_write_b128 v34, a[52:55] offset:37888
  ds_write_b128 v34, a[56:59] offset:38912
  ds_write_b128 v34, a[60:63] offset:39936
  s_waitcnt lgkmcnt(0)
  s_barrier
  ds_read_b64_tr_b16 a[32:33], v32 offset:32768
  ds_read_b64_tr_b16 a[34:35], v32 offset:33280
  ds_read_b64_tr_b16 a[36:37], v32 offset:40960
  ds_read_b64_tr_b16 a[38:39], v32 offset:41472
  ds_read_b64_tr_b16 a[40:41], v33 offset:32768
  ds_read_b64_tr_b16 a[42:43], v33 offset:33280
  ds_read_b64_tr_b16 a[44:45], v33 offset:40960
  ds_read_b64_tr_b16 a[46:47], v33 offset:41472
  ds_read_b64_tr_b16 a[48:49], v32 offset:49152
  ds_read_b64_tr_b16 a[50:51], v32 offset:49664
  ds_read_b64_tr_b16 a[52:53], v32 offset:57344
  ds_read_b64_tr_b16 a[54:55], v32 offset:57856
  ds_read_b64_tr_b16 a[56:57], v33 offset:49152
  ds_read_b64_tr_b16 a[58:59], v33 offset:49664
  ds_read_b64_tr_b16 a[60:61], v33 offset:57344
  ds_read_b64_tr_b16 a[62:63], v33 offset:57856
  s_waitcnt lgkmcnt(0)
  s_waitcnt vmcnt(41)
  ds_write_b128 v34, a[64:67] offset:0
  ds_write_b128 v34, a[68:71] offset:1024
  ds_write_b128 v34, a[72:75] offset:2048
  ds_write_b128 v34, a[76:79] offset:3072
  ds_write_b128 v34, a[80:83] offset:4096
  ds_write_b128 v34, a[84:87] offset:5120
  ds_write_b128 v34, a[88:91] offset:6144
  ds_write_b128 v34, a[92:95] offset:7168
  s_waitcnt lgkmcnt(0)
  s_barrier
  ds_read_b64_tr_b16 a[64:65], v32 offset:0
  ds_read_b64_tr_b16 a[66:67], v32 offset:512
  ds_read_b64_tr_b16 a[68:69], v32 offset:8192
  ds_read_b64_tr_b16 a[70:71], v32 offset:8704
  ds_read_b64_tr_b16 a[72:73], v33 offset:0
  ds_read_b64_tr_b16 a[74:75], v33 offset:512
  ds_read_b64_tr_b16 a[76:77], v33 offset:8192
  ds_read_b64_tr_b16 a[78:79], v33 offset:8704
  ds_read_b64_tr_b16 a[80:81], v32 offset:16384
  ds_read_b64_tr_b16 a[82:83], v32 offset:16896
  ds_read_b64_tr_b16 a[84:85], v32 offset:24576
  ds_read_b64_tr_b16 a[86:87], v32 offset:25088
  ds_read_b64_tr_b16 a[88:89], v33 offset:16384
  ds_read_b64_tr_b16 a[90:91], v33 offset:16896
  ds_read_b64_tr_b16 a[92:93], v33 offset:24576
  ds_read_b64_tr_b16 a[94:95], v33 offset:25088
  s_waitcnt lgkmcnt(0)
  s_waitcnt vmcnt(33)
  ds_write_b128 v34, a[96:99] offset:32768
  ds_write_b128 v34, a[100:103] offset:33792
  ds_write_b128 v34, a[104:107] offset:34816
  ds_write_b128 v34, a[108:111] offset:35840
  ds_write_b128 v34, a[112:115] offset:36864
  ds_write_b128 v34, a[116:119] offset:37888
  ds_write_b128 v34, a[120:123] offset:38912
  ds_write_b128 v34, a[124:127] offset:39936
  s_waitcnt lgkmcnt(0)
  s_barrier
  ds_read_b64_tr_b16 a[96:97], v32 offset:32768
  ds_read_b64_tr_b16 a[98:99], v32 offset:33280
  ds_read_b64_tr_b16 a[100:101], v32 offset:40960
  ds_read_b64_tr_b16 a[102:103], v32 offset:41472
  ds_read_b64_tr_b16 a[104:105], v33 offset:32768
  ds_read_b64_tr_b16 a[106:107], v33 offset:33280
  ds_read_b64_tr_b16 a[108:109], v33 offset:40960
  ds_read_b64_tr_b16 a[110:111], v33 offset:41472
  ds_read_b64_tr_b16 a[112:113], v32 offset:49152
  ds_read_b64_tr_b16 a[114:115], v32 offset:49664
  ds_read_b64_tr_b16 a[116:117], v32 offset:57344
  ds_read_b64_tr_b16 a[118:119], v32 offset:57856
  ds_read_b64_tr_b16 a[120:121], v33 offset:49152
  ds_read_b64_tr_b16 a[122:123], v33 offset:49664
  ds_read_b64_tr_b16 a[124:125], v33 offset:57344
  ds_read_b64_tr_b16 a[126:127], v33 offset:57856
  s_waitcnt lgkmcnt(0)
  s_waitcnt vmcnt(25)
  ds_write_b128 v34, a[128:131] offset:0
  ds_write_b128 v34, a[132:135] offset:1024
  ds_write_b128 v34, a[136:139] offset:2048
  ds_write_b128 v34, a[140:143] offset:3072
  ds_write_b128 v34, a[144:147] offset:4096
  ds_write_b128 v34, a[148:151] offset:5120
  ds_write_b128 v34, a[152:155] offset:6144
  ds_write_b128 v34, a[156:159] offset:7168
  s_waitcnt lgkmcnt(0)
  s_barrier
  ds_read_b64_tr_b16 a[128:129], v32 offset:0
  ds_read_b64_tr_b16 a[130:131], v32 offset:512
  ds_read_b64_tr_b16 a[132:133], v32 offset:8192
  ds_read_b64_tr_b16 a[134:135], v32 offset:8704
  ds_read_b64_tr_b16 a[136:137], v33 offset:0
  ds_read_b64_tr_b16 a[138:139], v33 offset:512
  ds_read_b64_tr_b16 a[140:141], v33 offset:8192
  ds_read_b64_tr_b16 a[142:143], v33 offset:8704
  ds_read_b64_tr_b16 a[144:145], v32 offset:16384
  ds_read_b64_tr_b16 a[146:147], v32 offset:16896
  ds_read_b64_tr_b16 a[148:149], v32 offset:24576
  ds_read_b64_tr_b16 a[150:151], v32 offset:25088
  ds_read_b64_tr_b16 a[152:153], v33 offset:16384
  ds_read_b64_tr_b16 a[154:155], v33 offset:16896
  ds_read_b64_tr_b16 a[156:157], v33 offset:24576
  ds_read_b64_tr_b16 a[158:159], v33 offset:25088
  s_waitcnt lgkmcnt(0)
  s_waitcnt vmcnt(17)
  ds_write_b128 v34, a[160:163] offset:32768
  ds_write_b128 v34, a[164:167] offset:33792
  ds_write_b128 v34, a[168:171] offset:34816
  ds_write_b128 v34, a[172:175] offset:35840
  ds_write_b128 v34, a[176:179] offset:36864
  ds_write_b128 v34, a[180:183] offset:37888
  ds_write_b128 v34, a[184:187] offset:38912
  ds_write_b128 v34, a[188:191] offset:39936
  s_waitcnt lgkmcnt(0)
  s_barrier
  ds_read_b64_tr_b16 a[160:161], v32 offset:32768
  ds_read_b64_tr_b16 a[162:163], v32 offset:33280
  ds_read_b64_tr_b16 a[164:165], v32 offset:40960
  ds_read_b64_tr_b16 a[166:167], v32 offset:41472
  ds_read_b64_tr_b16 a[168:169], v33 offset:32768
  ds_read_b64_tr_b16 a[170:171], v33 offset:33280
  ds_read_b64_tr_b16 a[172:173], v33 offset:40960
  ds_read_b64_tr_b16 a[174:175], v33 offset:41472
  ds_read_b64_tr_b16 a[176:177], v32 offset:49152
  ds_read_b64_tr_b16 a[178:179], v32 offset:49664
  ds_read_b64_tr_b16 a[180:181], v32 offset:57344
  ds_read_b64_tr_b16 a[182:183], v32 offset:57856
  ds_read_b64_tr_b16 a[184:185], v33 offset:49152
  ds_read_b64_tr_b16 a[186:187], v33 offset:49664
  ds_read_b64_tr_b16 a[188:189], v33 offset:57344
  ds_read_b64_tr_b16 a[190:191], v33 offset:57856
  s_waitcnt lgkmcnt(0)
  s_waitcnt vmcnt(9)
  ds_write_b128 v34, a[192:195] offset:0
  ds_write_b128 v34, a[196:199] offset:1024
  ds_write_b128 v34, a[200:203] offset:2048
  ds_write_b128 v34, a[204:207] offset:3072
  ds_write_b128 v34, a[208:211] offset:4096
  ds_write_b128 v34, a[212:215] offset:5120
  ds_write_b128 v34, a[216:219] offset:6144
  ds_write_b128 v34, a[220:223] offset:7168
  s_waitcnt lgkmcnt(0)
  s_barrier
  ds_read_b64_tr_b16 a[192:193], v32 offset:0
  ds_read_b64_tr_b16 a[194:195], v32 offset:512
  ds_read_b64_tr_b16 a[196:197], v32 offset:8192
  ds_read_b64_tr_b16 a[198:199], v32 offset:8704
  ds_read_b64_tr_b16 a[200:201], v33 offset:0
  ds_read_b64_tr_b16 a[202:203], v33 offset:512
  ds_read_b64_tr_b16 a[204:205], v33 offset:8192
  ds_read_b64_tr_b16 a[206:207], v33 offset:8704
  ds_read_b64_tr_b16 a[208:209], v32 offset:16384
  ds_read_b64_tr_b16 a[210:211], v32 offset:16896
  ds_read_b64_tr_b16 a[212:213], v32 offset:24576
  ds_read_b64_tr_b16 a[214:215], v32 offset:25088
  ds_read_b64_tr_b16 a[216:217], v33 offset:16384
  ds_read_b64_tr_b16 a[218:219], v33 offset:16896
  ds_read_b64_tr_b16 a[220:221], v33 offset:24576
  ds_read_b64_tr_b16 a[222:223], v33 offset:25088
  s_waitcnt lgkmcnt(0)
  s_waitcnt vmcnt(0)
  s_cmp_lg_u32 s30, 0
  s_cbranch_scc1 w0_91
  v_mov_b32 v8, 64
  s_mov_b32 s32, 0
wf_92:
  buffer_load_dword v9, v8, s[12:15], 0 offen sc1
  s_waitcnt vmcnt(0)
  v_cmp_gt_u32 vcc, 256, v9
  s_cbranch_vccz wfd_93
  s_sleep 4
  s_add_u32 s32, s32, 1
  s_cmp_lt_u32 s32, s31
  s_cbranch_scc1 wf_92
  s_mov_b32 s31, 0
wfd_93:
w0_91:
  s_barrier
  s_mov_b64 exec, s[60:61]
  s_mov_b32 s33, 0
  buffer_load_dwordx4 v[108:111], v5, s[8:11], s33 offen sc1
  s_mov_b32 s33, 32768
  buffer_load_dwordx4 v[108:111], v5, s[8:11], s33 offen sc1
  s_mov_b32 s33, 65536
  buffer_load_dwordx4 v[108:111], v5, s[8:11], s33 offen sc1
  s_mov_b64 exec, -1
  buffer_load_dword v112, v27, s[8:11], s54 offen sc1
  ds_write_b128 v34, a[224:227] offset:32768
  ds_write_b128 v34, a[228:231] offset:33792
  ds_write_b128 v34, a[232:235] offset:34816
  ds_write_b128 v34, a[236:239] offset:35840
  ds_write_b128 v34, a[240:243] offset:36864
  ds_write_b128 v34, a[244:247] offset:37888
  ds_write_b128 v34, a[248:251] offset:38912
  ds_write_b128 v34, a[252:255] offset:39936
  s_waitcnt lgkmcnt(0)
  s_barrier
  ds_read_b64_tr_b16 a[224:225], v32 offset:32768
  ds_read_b64_tr_b16 a[226:227], v32 offset:33280
  ds_read_b64_tr_b16 a[228:229], v32 offset:40960
  ds_read_b64_tr_b16 a[230:231], v32 offset:41472
  ds_read_b64_tr_b16 a[232:233], v33 offset:32768
  ds_read_b64_tr_b16 a[234:235], v33 offset:33280
  ds_read_b64_tr_b16 a[236:237], v33 offset:40960
  ds_read_b64_tr_b16 a[238:239], v33 offset:41472
  ds_read_b64_tr_b16 a[240:241], v32 offset:49152
  ds_read_b64_tr_b16 a[242:243], v32 offset:49664
  ds_read_b64_tr_b16 a[244:245], v32 offset:57344
  ds_read_b64_tr_b16 a[246:247], v32 offset:57856
  ds_read_b64_tr_b16 a[248:249], v33 offset:49152
  ds_read_b64_tr_b16 a[250:251], v33 offset:49664
  ds_read_b64_tr_b16 a[252:253], v33 offset:57344
  ds_read_b64_tr_b16 a[254:255], v33 offset:57856
  s_waitcnt lgkmcnt(0)
  s_barrier
  v_mov_b32 v118, 0
  v_mov_b32 v119, 0
  v_mov_b32 v121, 0
  v_mov_b32 v122, 0
  s_add_u32 s52, s43, 1
  s_cmp_le_u32 s52, s51
  s_cbranch_scc1 kvok_94
  s_mov_b32 s32, 0
wf_95:
  buffer_load_dword v8, v223, s[8:11], 0 offen sc1
  s_waitcnt vmcnt(0)
  v_cmp_gt_u32 vcc, s52, v8
  s_cbranch_vccz wfd_96
  s_sleep 2
  s_add_u32 s32, s32, 1
  s_cmp_lt_u32 s32, s31
  s_cbranch_scc1 wf_95
  s_mov_b32 s31, 0
wfd_96:
  v_min_u32_dpp v8, v8, v8 row_ror:1 row_mask:0xf bank_mask:0xf
  s_nop 0
  v_readfirstlane_b32 s51, v8
  s_nop 3
kvok_94:
  s_lshl_b32 s47, s43, 18
  s_add_u32 s47, s47, s57
  s_add_u32 s48, s47, 50331648
  s_add_u32 s47, s47, 16777216
  s_lshl_b32 s33, s30, 11
  s_add_u32 m0, s33, 147456
  s_nop 0
  buffer_load_dwordx4 v17, s[8:11], s47 offen sc1 lds
  buffer_load_dwordx4 v17, s[8:11], s47 offen offset:1024 sc1 lds
  buffer_load_dwordx4 v[108:111], v17, s[8:11], s48 offen sc1
  buffer_load_dwordx4 v[112:115], v17, s[8:11], s48 offen offset:1024 sc1
  s_waitcnt vmcnt(0)
  s_barrier
L_QK_loop:
  ds_read_b128 v[160:163], v18 offset:0
  ds_read_b128 v[176:179], v18 offset:4096
  ds_read_b128 v[164:167], v18 offset:1024
  ds_read_b128 v[180:183], v18 offset:5120
  ds_read_b128 v[168:171], v18 offset:2048
  ds_read_b128 v[184:187], v18 offset:6144
  ds_read_b128 v[172:175], v18 offset:3072
  ds_read_b128 v[188:191], v18 offset:7168
  s_lshl_b32 s76, s43, 17
  s_add_u32 s76, s76, s77
  s_add_u32 s52, s43, 1
  s_lshl_b32 s49, s44, 15
  v_mov_b32 v19, s52
  s_waitcnt lgkmcnt(0)
L_QK_again:
  v_mov_b32 v28, 0
  v_mov_b32 v29, 0
  v_mov_b32 v30, 0
  v_mov_b32 v31, 0
  v_mov_b32 v32, 0
  v_mov_b32 v33, 0
  v_mov_b32 v34, 0
  v_mov_b32 v35, 0
  s_lshl_b32 s47, s44, 14
  s_add_u32 s47, s47, s42
  s_mov_b64 exec, 0xf
  s_mov_b32 s32, 0
  buffer_load_dword v8, v3, s[8:11], 0 offen sc1
  s_sleep 1
  buffer_load_dword v9, v3, s[8:11], 0 offen sc1
  s_sleep 1
pp_97:
  buffer_load_dword v10, v3, s[8:11], 0 offen sc1
  s_waitcnt vmcnt(2)
  v_cmp_gt_u32 vcc, s43, v8
  s_cbranch_vccz ppx_99
  buffer_load_dword v8, v3, s[8:11], 0 offen sc1
  s_waitcnt vmcnt(2)
  v_cmp_gt_u32 vcc, s43, v9
  s_cbranch_vccz ppx_100
  buffer_load_dword v9, v3, s[8:11], 0 offen sc1
  s_waitcnt vmcnt(2)
  v_cmp_gt_u32 vcc, s43, v10
  s_cbranch_vccz ppx_101
  s_add_u32 s32, s32, 1
  s_cmp_lt_u32 s32, s31
  s_cbranch_scc1 pp_97
  s_mov_b32 s31, 0
ppx_101:
ppx_100:
ppx_99:
ppd_98:
  s_mov_b64 exec, -1
  s_add_u32 m0, s80, 131072
  s_add_u32 s48, s47, s80
  buffer_load_dwordx4 v2, s[8:11], s48 offen sc1 lds
  s_add_u32 m0, s81, 131072
  s_add_u32 s48, s47, s81
  buffer_load_dwordx4 v2, s[8:11], s48 offen sc1 lds
  s_add_u32 m0, s82, 131072
  s_add_u32 s48, s47, s82
  buffer_load_dwordx4 v2, s[8:11], s48 offen sc1 lds
  s_add_u32 m0, s83, 131072
  s_add_u32 s48, s47, s83
  buffer_load_dwordx4 v2, s[8:11], s48 offen sc1 lds
  s_waitcnt vmcnt(3)
  s_barrier
  ds_read_b128 v[44:47], v4 offset:0
  ds_read_b128 v[48:51], v4 offset:1024
  ds_read_b128 v[52:55], v4 offset:2048
  ds_read_b128 v[56:59], v4 offset:12288
  s_waitcnt lgkmcnt(3)
  v_smfmac_f32_16x16x64_bf16 v[28:31], v[44:47], a[0:7], v7
  v_smfmac_f32_16x16x64_bf16 v[32:35], v[44:47], a[8:15], v7
  s_waitcnt vmcnt(2)
  s_barrier
  ds_read_b128 v[60:63], v4 offset:3072
  ds_read_b128 v[64:67], v4 offset:4096
  ds_read_b128 v[68:71], v4 offset:5120
  ds_read_b128 v[72:75], v4 offset:13312
  s_waitcnt lgkmcnt(6)
  v_smfmac_f32_16x16x64_bf16 v[28:31], v[48:51], a[16:23], v7
  v_smfmac_f32_16x16x64_bf16 v[32:35], v[48:51], a[24:31], v7
  s_waitcnt lgkmcnt(5)
  v_smfmac_f32_16x16x64_bf16 v[28:31], v[52:55], a[32:39], v7
  v_smfmac_f32_16x16x64_bf16 v[32:35], v[52:55], a[40:47], v7
  s_waitcnt lgkmcnt(4)
  v_smfmac_f32_16x16x64_bf16 v[28:31], v[56:59], a[192:199], v7
  v_smfmac_f32_16x16x64_bf16 v[32:35], v[56:59], a[200:207], v7
  s_waitcnt vmcnt(1)
  s_barrier
  ds_read_b128 v[76:79], v4 offset:6144
  ds_read_b128 v[80:83], v4 offset:7168
  ds_read_b128 v[84:87], v4 offset:8192
  ds_read_b128 v[88:91], v4 offset:14336
  s_waitcnt lgkmcnt(7)
  v_smfmac_f32_16x16x64_bf16 v[28:31], v[60:63], a[48:55], v7
  v_smfmac_f32_16x16x64_bf16 v[32:35], v[60:63], a[56:63], v7
  s_waitcnt lgkmcnt(6)
  v_smfmac_f32_16x16x64_bf16 v[28:31], v[64:67], a[64:71], v7
  v_smfmac_f32_16x16x64_bf16 v[32:35], v[64:67], a[72:79], v7
  s_waitcnt lgkmcnt(5)
  v_smfmac_f32_16x16x64_bf16 v[28:31], v[68:71], a[80:87], v7
  v_smfmac_f32_16x16x64_bf16 v[32:35], v[68:71], a[88:95], v7
  s_waitcnt vmcnt(0)
  s_barrier
  ds_read_b128 v[92:95], v4 offset:9216
  ds_read_b128 v[96:99], v4 offset:10240
  ds_read_b128 v[100:103], v4 offset:11264
  ds_read_b128 v[104:107], v4 offset:15360
  s_waitcnt lgkmcnt(8)
  v_smfmac_f32_16x16x64_bf16 v[28:31], v[72:75], a[208:215], v7
  v_smfmac_f32_16x16x64_bf16 v[32:35], v[72:75], a[216:223], v7
  s_waitcnt lgkmcnt(7)
  v_smfmac_f32_16x16x64_bf16 v[28:31], v[76:79], a[96:103], v7
  v_smfmac_f32_16x16x64_bf16 v[32:35], v[76:79], a[104:111], v7
  s_waitcnt lgkmcnt(6)
  v_smfmac_f32_16x16x64_bf16 v[28:31], v[80:83], a[112:119], v7
  s_lshl_b32 s48, s46, 15
  s_mov_b64 exec, s[60:61]
  buffer_store_dwordx4 v[20:23], v5, s[8:11], s48 offen
  s_mov_b64 exec, -1
  v_smfmac_f32_16x16x64_bf16 v[32:35], v[80:83], a[120:127], v7
  s_waitcnt lgkmcnt(5)
  v_smfmac_f32_16x16x64_bf16 v[28:31], v[84:87], a[128:135], v7
  v_smfmac_f32_16x16x64_bf16 v[32:35], v[84:87], a[136:143], v7
  s_waitcnt lgkmcnt(4)
  v_smfmac_f32_16x16x64_bf16 v[28:31], v[88:91], a[224:231], v7
  v_smfmac_f32_16x16x64_bf16 v[32:35], v[88:91], a[232:239], v7
  s_waitcnt lgkmcnt(3)
  v_smfmac_f32_16x16x64_bf16 v[28:31], v[92:95], a[144:151], v7
  v_smfmac_f32_16x16x64_bf16 v[32:35], v[92:95], a[152:159], v7
  s_waitcnt lgkmcnt(2)
  v_smfmac_f32_16x16x64_bf16 v[28:31], v[96:99], a[160:167], v7
  v_smfmac_f32_16x16x64_bf16 v[32:35], v[96:99], a[168:175], v7
  s_waitcnt lgkmcnt(1)
  v_smfmac_f32_16x16x64_bf16 v[28:31], v[100:103], a[176:183], v7
  v_smfmac_f32_16x16x64_bf16 v[32:35], v[100:103], a[184:191], v7
  s_waitcnt lgkmcnt(0)
  v_smfmac_f32_16x16x64_bf16 v[28:31], v[104:107], a[240:247], v7
  v_smfmac_f32_16x16x64_bf16 v[32:35], v[104:107], a[248:255], v7
  s_nop 6
  v_add_f32 v28, v28, v29
  v_add_f32 v30, v30, v31
  v_cvt_pk_bf16_f32 v216, v28, v30
  ds_write_b32 v13, v216 offset:0
  v_add_f32 v32, v32, v33
  v_add_f32 v34, v34, v35
  v_cvt_pk_bf16_f32 v217, v32, v34
  ds_write_b32 v13, v217 offset:256
  buffer_load_dword v192, v11, s[8:11], s49 offen sc1
  buffer_load_dword v193, v11, s[8:11], s49 offen offset:256 sc1
  v_cmp_u_f32 vcc, v28, v30
  s_cbranch_vccnz L_QK_redo
L_QK_cont:
  s_waitcnt lgkmcnt(0)
  s_barrier
  ds_read_b64_tr_b16 v[128:129], v15 offset:0
  ds_read_b64_tr_b16 v[130:131], v15 offset:64
  ds_read_b64_tr_b16 v[132:133], v15 offset:512
  ds_read_b64_tr_b16 v[134:135], v15 offset:576
  ds_read_b64_tr_b16 v[136:137], v15 offset:1024
  ds_read_b64_tr_b16 v[138:139], v15 offset:1088
  ds_read_b64_tr_b16 v[140:141], v15 offset:1536
  ds_read_b64_tr_b16 v[142:143], v15 offset:1600
  s_waitcnt lgkmcnt(6)
  v_mfma_f32_16x16x32_bf16 v[196:199], v[160:163], v[128:131], 0
  s_waitcnt lgkmcnt(4)
  v_mfma_f32_16x16x32_bf16 v[196:199], v[164:167], v[132:135], v[196:199]
  s_waitcnt lgkmcnt(2)
  v_mfma_f32_16x16x32_bf16 v[196:199], v[168:171], v[136:139], v[196:199]
  s_waitcnt vmcnt(0)
  v_max_u32 v8, v192, v193
  v_cmp_eq_u32 vcc, -1, v8
  s_cbranch_vccnz L_QK_kwait
L_QK_kok:
  ds_write_b32 v14, v192
  ds_write_b32 v14, v193 offset:256
  s_waitcnt lgkmcnt(2)
  v_mfma_f32_16x16x32_bf16 v[196:199], v[172:175], v[140:143], v[196:199]
  v_mfma_f32_16x16x32_bf16 v[200:203], v[176:179], v[128:131], 0
  v_mfma_f32_16x16x32_bf16 v[200:203], v[180:183], v[132:135], v[200:203]
  s_waitcnt lgkmcnt(0)
  s_barrier
  ds_read_b64_tr_b16 v[144:145], v16 offset:0
  ds_read_b64_tr_b16 v[146:147], v16 offset:64
  ds_read_b64_tr_b16 v[148:149], v16 offset:512
  ds_read_b64_tr_b16 v[150:151], v16 offset:576
  ds_read_b64_tr_b16 v[152:153], v16 offset:1024
  ds_read_b64_tr_b16 v[154:155], v16 offset:1088
  ds_read_b64_tr_b16 v[156:157], v16 offset:1536
  ds_read_b64_tr_b16 v[158:159], v16 offset:1600
  s_cmp_eq_u32 s43, 63
  s_cbranch_scc1 L_QK_last
  buffer_load_dword v116, v6, s[8:11], s49 offen sc1
  buffer_load_dword v117, v6, s[8:11], s49 offen offset:256 sc1
  v_mfma_f32_16x16x32_bf16 v[200:203], v[184:187], v[136:139], v[200:203]
  v_mfma_f32_16x16x32_bf16 v[200:203], v[188:191], v[140:143], v[200:203]
  s_waitcnt lgkmcnt(6)
  v_mfma_f32_16x16x32_bf16 v[204:207], v[144:147], v[128:131], 0
  s_waitcnt lgkmcnt(4)
  v_mfma_f32_16x16x32_bf16 v[204:207], v[148:151], v[132:135], v[204:207]
  v_max3_f32 v220, v196, v197, v198
  s_waitcnt lgkmcnt(2)
  v_mfma_f32_16x16x32_bf16 v[204:207], v[152:155], v[136:139], v[204:207]
  s_waitcnt lgkmcnt(0)
  v_mfma_f32_16x16x32_bf16 v[204:207], v[156:159], v[140:143], v[204:207]
  v_max3_f32 v220, v220, v199, v200
  v_max3_f32 v220, v220, v201, v202
  v_max_f32 v220, v220, v203
  s_nop 4
  v_cndmask_b32 v204, v204, v206, s[66:67]
  v_cndmask_b32 v205, v205, v207, s[66:67]
  v_max3_f32 v220, v220, v204, v205
  v_mov_b32 v8, v220
  s_nop 1
  v_permlane16_swap_b32 v220, v8
  v_max_f32 v220, v220, v8
  v_mov_b32 v8, v220
  s_nop 1
  v_permlane32_swap_b32 v220, v8
  v_max_f32 v220, v220, v8
  v_mul_f32 v220, s53, v220
  v_fma_f32 v196, v196, s53, -v220
  v_fma_f32 v197, v197, s53, -v220
  v_fma_f32 v198, v198, s53, -v220
  v_fma_f32 v199, v199, s53, -v220
  v_fma_f32 v200, v200, s53, -v220
  v_fma_f32 v201, v201, s53, -v220
  v_fma_f32 v202, v202, s53, -v220
  v_fma_f32 v203, v203, s53, -v220
  v_fma_f32 v204, v204, s53, -v220
  v_fma_f32 v205, v205, s53, -v220
  v_exp_f32 v196, v196
  v_exp_f32 v197, v197
  v_exp_f32 v198, v198
  v_exp_f32 v199, v199
  v_exp_f32 v200, v200
  v_exp_f32 v201, v201
  v_exp_f32 v202, v202
  v_exp_f32 v203, v203
  v_exp_f32 v204, v204
  v_exp_f32 v205, v205
  v_cvt_pk_bf16_f32 v124, v196, v197
  v_cvt_pk_bf16_f32 v125, v198, v199
  v_cvt_pk_bf16_f32 v126, v200, v201
  v_cvt_pk_bf16_f32 v127, v202, v203
  v_cvt_pk_bf16_f32 v120, v204, v205
  v_cvt_pk_bf16_f32 v123, v204, v205
  s_waitcnt vmcnt(0)
  v_max_u32 v8, v116, v117
  v_mfma_f32_16x16x32_bf16 v[208:211], v[108:111], v[124:127], 0
  v_cmp_eq_u32 vcc, -1, v8
  v_add_f32 v196, v196, v197
  v_mfma_f32_16x16x32_bf16 v[212:215], v[112:115], v[124:127], 0
  v_add_f32 v198, v198, v199
  v_add_f32 v200, v200, v201
  s_cbranch_vccnz L_QK_vwait
L_QK_vok:
  v_mfma_f32_16x16x32_bf16 v[208:211], v[116:119], v[120:123], v[208:211]
  v_add_f32 v202, v202, v203
  v_add_f32 v204, v204, v205
  v_mfma_f32_16x16x32_bf16 v[212:215], v[116:119], v[122:125], v[212:215]
  v_add_f32 v196, v196, v198
  v_add_f32 v200, v200, v202
  v_add_f32 v196, v196, v204
  v_add_f32 v222, v196, v200
  v_mov_b32 v8, v222
  s_nop 1
  v_permlane16_swap_b32 v222, v8
  v_add_f32 v222, v222, v8
  v_mov_b32 v8, v222
  s_nop 1
  v_permlane32_swap_b32 v222, v8
  v_add_f32 v222, v222, v8
  v_rcp_f32 v221, v222
  s_mov_b64 exec, s[60:61]
  v_pk_mul_f32 v[208:209], v[208:209], v[220:221] op_sel:[0,1] op_sel_hi:[1,1]
  v_pk_mul_f32 v[210:211], v[210:211], v[220:221] op_sel:[0,1] op_sel_hi:[1,1]
  v_pk_mul_f32 v[212:213], v[212:213], v[220:221] op_sel:[0,1] op_sel_hi:[1,1]
  v_pk_mul_f32 v[214:215], v[214:215], v[220:221] op_sel:[0,1] op_sel_hi:[1,1]
  v_cvt_pk_bf16_f32 v124, v208, v209
  v_cvt_pk_bf16_f32 v125, v210, v211
  v_cvt_pk_bf16_f32 v126, v212, v213
  v_cvt_pk_bf16_f32 v127, v214, v215
  buffer_store_dwordx4 v[124:127], v5, s[8:11], s49 offen
  s_mov_b64 exec, -1
  s_barrier
  s_cmp_lg_u32 s30, 0
  s_cbranch_scc1 w0_102
  s_mov_b64 exec, 1
  buffer_store_dword v19, v27, s[8:11], s54 offen
  s_mov_b64 exec, -1
w0_102:
  s_cmp_eq_u32 s30, 0
  s_cbranch_scc1 km_103
  s_cmp_eq_u32 s30, 1
  s_cbranch_scc1 km_104
  s_cmp_eq_u32 s30, 2
  s_cbranch_scc1 km_105
  buffer_store_dwordx4 v[156:159], v17, s[8:11], s76 offen sc1
  s_branch kme_107
km_103:
  buffer_store_dwordx4 v[144:147], v17, s[8:11], s76 offen sc1
  s_branch kme_107
km_104:
  buffer_store_dwordx4 v[148:151], v17, s[8:11], s76 offen sc1
  s_branch kme_107
km_105:
  buffer_store_dwordx4 v[152:155], v17, s[8:11], s76 offen sc1
kme_107:
  s_mov_b32 s33, s44
  s_mov_b32 s44, s45
  s_mov_b32 s45, s46
  s_mov_b32 s46, s33
  s_add_u32 s43, s43, 1
  s_add_u32 s52, s43, 1
  s_cmp_le_u32 s52, s51
  s_cbranch_scc1 kvok_108
  s_mov_b32 s32, 0
wf_109:
  buffer_load_dword v8, v223, s[8:11], 0 offen sc1
  s_waitcnt vmcnt(0)
  v_cmp_gt_u32 vcc, s52, v8
  s_cbranch_vccz wfd_110
  s_sleep 2
  s_add_u32 s32, s32, 1
  s_cmp_lt_u32 s32, s31
  s_cbranch_scc1 wf_109
  s_mov_b32 s31, 0
wfd_110:
  v_min_u32_dpp v8, v8, v8 row_ror:1 row_mask:0xf bank_mask:0xf
  s_nop 0
  v_readfirstlane_b32 s51, v8
  s_nop 3
kvok_108:
  s_lshl_b32 s47, s43, 18
  s_add_u32 s47, s47, s57
  s_add_u32 s48, s47, 50331648
  s_add_u32 s47, s47, 16777216
  s_lshl_b32 s33, s30, 11
  s_add_u32 m0, s33, 147456
  s_nop 0
  buffer_load_dwordx4 v17, s[8:11], s47 offen sc1 lds
  buffer_load_dwordx4 v17, s[8:11], s47 offen offset:1024 sc1 lds
  buffer_load_dwordx4 v[108:111], v17, s[8:11], s48 offen sc1
  buffer_load_dwordx4 v[112:115], v17, s[8:11], s48 offen offset:1024 sc1
  s_waitcnt vmcnt(4)
  s_barrier
  s_mov_b64 s[96:97], exec
  s_mov_b64 exec, 1
  v_mov_b32 v8, s50
  v_mov_b32 v9, s43
  buffer_store_dword v9, v8, s[8:11], 0 offen sc1
  s_mov_b64 exec, s[96:97]
  s_waitcnt vmcnt(1)
  s_barrier
  s_branch L_QK_loop
L_QK_last:
  s_waitcnt lgkmcnt(0)
  s_cmp_eq_u32 s30, 0
  s_cbranch_scc1 km_111
  s_cmp_eq_u32 s30, 1
  s_cbranch_scc1 km_112
  s_cmp_eq_u32 s30, 2
  s_cbranch_scc1 km_113
  buffer_store_dwordx4 v[156:159], v17, s[8:11], s76 offen sc1
  s_branch kme_115
km_111:
  buffer_store_dwordx4 v[144:147], v17, s[8:11], s76 offen sc1
  s_branch kme_115
km_112:
  buffer_store_dwordx4 v[148:151], v17, s[8:11], s76 offen sc1
  s_branch kme_115
km_113:
  buffer_store_dwordx4 v[152:155], v17, s[8:11], s76 offen sc1
kme_115:
  s_waitcnt vmcnt(0)
  s_barrier
  s_cmp_lg_u32 s30, 0
  s_cbranch_scc1 w0_116
  s_mov_b64 s[96:97], exec
  s_mov_b64 exec, 1
  v_mov_b32 v8, s50
  v_mov_b32 v9, 64
  buffer_store_dword v9, v8, s[8:11], 0 offen sc1
  s_mov_b64 exec, s[96:97]
w0_116:
  s_endpgm
L_QK_redo:
  s_add_u32 s64, s64, 1
  s_cmp_ge_u32 s64, 0x10000
  s_cbranch_scc1 L_QK_cont
  s_waitcnt lgkmcnt(0)
  s_nop 7
  s_barrier
  s_branch L_QK_again
L_QK_kwait:
  s_add_u32 s85, s85, 1
  s_mov_b32 s32, 0
pd_117:
  buffer_load_dword v192, v11, s[8:11], s49 offen sc1
  buffer_load_dword v193, v11, s[8:11], s49 offen offset:256 sc1
  s_waitcnt vmcnt(0)
  v_max_u32 v8, v192, v193
  v_cmp_eq_u32 vcc, -1, v8
  s_cbranch_vccz pdd_118
  s_add_u32 s32, s32, 1
  s_cmp_lt_u32 s32, s31
  s_cbranch_scc1 pd_117
  s_mov_b32 s31, 0
pdd_118:
  s_branch L_QK_kok
L_QK_vwait:
  s_add_u32 s84, s84, 1
  s_mov_b32 s32, 0
pd_119:
  buffer_load_dword v116, v6, s[8:11], s49 offen sc1
  buffer_load_dword v117, v6, s[8:11], s49 offen offset:256 sc1
  s_waitcnt vmcnt(0)
  v_max_u32 v8, v116, v117
  v_cmp_eq_u32 vcc, -1, v8
  s_cbranch_vccz pdd_120
  s_add_u32 s32, s32, 1
  s_cmp_lt_u32 s32, s31
  s_cbranch_scc1 pd_119
  s_mov_b32 s31, 0
pdd_120:
  s_branch L_QK_vok
L_role_VO:
  s_load_dwordx2 s[4:5], s[0:1], 32
  s_waitcnt lgkmcnt(0)
  s_mov_b32 s20, s4
  s_mov_b32 s21, s5
  s_mov_b32 s22, 8388608
  s_mov_b32 s23, 0x20000
  s_load_dwordx2 s[4:5], s[0:1], 40
  s_waitcnt lgkmcnt(0)
  s_mov_b32 s24, s4
  s_mov_b32 s25, s5
  s_mov_b32 s26, 8388608
  s_mov_b32 s27, 0x20000
  s_load_dwordx2 s[4:5], s[0:1], 8
  s_waitcnt lgkmcnt(0)
  s_mov_b32 s16, s4
  s_mov_b32 s17, s5
  s_mov_b32 s18, 16384
  s_mov_b32 s19, 0x20000
  s_add_u32 s59, s36, 8388607
  s_and_b32 s59, s59, 0xffe00000
  s_sub_u32 s59, s59, s36
  s_sub_u32 s40, s29, 8
  s_lshr_b32 s41, s40, 1
  s_lshl_b32 s33, s28, 3
  s_add_u32 s41, s41, s33
  s_lshl_b32 s42, s28, 20
  s_add_u32 s42, s42, 1048576
  v_and_b32 v120, 15, v1
  v_lshrrev_b32 v121, 4, v1
  v_and_b32 v122, 7, v1
  v_bfe_u32 v123, v1, 3, 1
  v_lshlrev_b32 v2, 4, v1
  v_add_u32 v4, 131072, v2
  v_cmp_eq_u32 s[60:61], 0, v123
  v_and_b32 v9, 1, v1
  v_cmp_eq_u32 s[62:63], 1, v9
  v_mov_b32 v7, 0x44444444
  v_mov_b32 v9, 0xeeeeeeee
  v_cndmask_b32 v7, v7, v9, s[62:63]
  v_mov_b32 v20, -1
  v_mov_b32 v21, -1
  v_mov_b32 v22, -1
  v_mov_b32 v23, -1
  s_mov_b32 s78, s40
  s_xor_b32 s79, s40, 2
  s_xor_b32 s40, s40, 4
  s_lshr_b32 s41, s79, 1
  s_lshl_b32 s33, s28, 3
  s_add_u32 s41, s41, s33
  s_cmp_eq_u32 s30, 1
  s_cselect_b32 s34, 1, 3
  s_cselect_b32 s33, 12, 0
  s_sub_u32 s35, s30, 1
  s_cmp_ge_u32 s30, 2
  s_cselect_b32 s33, s35, s33
  s_mul_i32 s35, s34, 0
  s_add_u32 s35, s35, s33
  s_lshl_b32 s80, s35, 10
  s_mul_i32 s35, s34, 1
  s_add_u32 s35, s35, s33
  s_lshl_b32 s81, s35, 10
  s_mul_i32 s35, s34, 2
  s_add_u32 s35, s35, s33
  s_lshl_b32 s82, s35, 10
  s_mul_i32 s35, s34, 3
  s_add_u32 s35, s35, s33
  s_lshl_b32 s83, s35, 10
  v_and_b32 v8, 3, v1
  v_mul_lo_u32 v8, v8, s34
  v_add_u32 v8, s33, v8
  v_lshlrev_b32 v8, 7, v8
  s_add_u32 s33, s42, 344064
  v_add_u32 v3, s33, v8
  s_lshl_b32 s50, s41, 1
  s_and_b32 s33, s79, 1
  s_add_u32 s50, s50, s33
  s_lshl_b32 s50, s50, 7
  s_add_u32 s50, s50, 32768
  v_lshlrev_b32 v16, 4, v1
  s_lshl_b32 s33, s30, 10
  s_add_u32 s33, s33, s42
  s_add_u32 s33, s33, 65536
  v_add_u32 v5, s33, v16
  v_lshrrev_b32 v8, 1, v121
  v_lshlrev_b32 v8, 9, v8
  v_and_b32 v9, 1, v121
  v_lshl_add_u32 v8, v9, 8, v8
  v_and_b32 v9, 1, v1
  v_lshl_add_u32 v8, v9, 7, v8
  v_lshrrev_b32 v9, 1, v120
  v_lshl_add_u32 v8, v9, 4, v8
  v_add_u32 v15, 131072, v8
  s_lshr_b32 s33, s30, 1
  s_lshl_b32 s33, s33, 7
  s_add_u32 s33, s33, s42
  s_add_u32 s33, s33, 327680
  v_and_b32 v8, 3, v1
  v_lshlrev_b32 v8, 8, v8
  v_add_u32 v24, s33, v8
  v_lshlrev_b32 v8, 3, v1
  s_lshl_b32 s33, s30, 9
  v_add_u32 v14, s33, v8
  v_lshlrev_b32 v8, 2, v1
  s_lshl_b32 s33, s30, 8
  v_add_u32 v8, s33, v8
  s_lshl_b32 s34, s40, 10
  s_add_u32 s34, s34, s42
  v_add_u32 v10, s34, v8
  s_lshl_b32 s34, s79, 10
  s_add_u32 s34, s34, s42
  s_add_u32 s34, s34, 196608
  v_add_u32 v6, s34, v8
  s_lshl_b32 s34, s28, 4
  s_add_u32 s34, s34, s79
  s_lshl_b32 s34, s34, 10
  s_add_u32 s34, s34, 142606336
  v_add_u32 v18, s34, v8
  v_and_b32 v8, 1, v1
  v_lshl_add_u32 v8, v121, 1, v8
  v_lshlrev_b32 v8, 5, v8
  v_lshrrev_b32 v9, 1, v120
  v_lshl_add_u32 v8, v9, 2, v8
  s_lshl_b32 s33, s40, 10
  s_lshl_b32 s34, s30, 8
  s_add_u32 s33, s33, s34
  s_add_u32 s33, s33, s42
  v_add_u32 v13, s33, v8
  s_lshr_b32 s33, s40, 2
  s_lshl_b32 s33, s33, 14
  s_and_b32 s34, s40, 3
  s_lshl_b32 s34, s34, 11
  s_add_u32 s33, s33, s34
  s_add_u32 s59, s59, s33
  s_lshl_b32 s33, s28, 16
  s_add_u32 s54, s59, s33
  s_xor_b32 s33, s28, 1
  s_lshl_b32 s33, s33, 16
  s_add_u32 s66, s59, s33
  s_xor_b32 s33, s28, 2
  s_lshl_b32 s33, s33, 16
  s_add_u32 s67, s59, s33
  s_xor_b32 s33, s28, 3
  s_lshl_b32 s33, s33, 16
  s_add_u32 s68, s59, s33
  s_lshl_b32 s33, s78, 10
  s_lshl_b32 s34, s30, 8
  s_add_u32 s33, s33, s34
  s_add_u32 s33, s33, s42
  s_add_u32 s33, s33, 393216
  v_lshlrev_b32 v8, 2, v1
  v_add_u32 v12, s33, v8
  v_lshrrev_b32 v8, 3, v1
  v_lshlrev_b32 v8, 11, v8
  v_lshl_add_u32 v8, v122, 2, v8
  s_lshl_b32 s33, s40, 7
  s_lshl_b32 s34, s30, 5
  s_add_u32 s33, s33, s34
  buffer_load_dword v110, v8, s[16:19], s33 offen
  s_cmp_lg_u32 s30, 0
  s_cbranch_scc1 w0_121
  s_mov_b64 s[96:97], exec
  s_mov_b64 exec, 1
  v_mov_b32 v124, s50
  v_mov_b32 v125, 0
  buffer_store_dword v125, v124, s[8:11], 0 offen sc1
  s_mov_b64 exec, s[96:97]
w0_121:
  s_lshl_b32 s57, s40, 7
  s_add_u32 s57, s57, s42
  s_add_u32 s57, s57, 344064
  v_mov_b32 v19, 0
  s_cmp_lg_u32 s30, 0
  s_cbranch_scc1 w0_122
  buffer_store_dword v19, v19, s[8:11], s57 offen
w0_122:
  v_mov_b32 v126, 0
  v_mov_b32 v127, 0
  s_mov_b32 s33, 0
  buffer_store_dword v20, v6, s[8:11], s33 offen
  buffer_store_dword v20, v12, s[8:11], s33 offen
  s_mov_b32 s33, 16384
  buffer_store_dword v20, v13, s[8:11], s33 offen
  s_mov_b32 s33, 32768
  buffer_store_dword v20, v6, s[8:11], s33 offen
  buffer_store_dword v20, v12, s[8:11], s33 offen
  s_mov_b32 s33, 32768
  buffer_store_dword v20, v13, s[8:11], s33 offen
  s_mov_b32 s33, 65536
  buffer_store_dword v20, v6, s[8:11], s33 offen
  buffer_store_dword v20, v12, s[8:11], s33 offen
  s_add_u32 s33, s54, 0
  buffer_store_dwordx2 v[126:127], v14, s[8:11], s33 offen sc1
  s_add_u32 s33, s54, 262144
  buffer_store_dwordx2 v[126:127], v14, s[8:11], s33 offen sc1
  v_mov_b32 v126, 1
  s_add_u32 s33, s54, 8192
  buffer_store_dwordx2 v[126:127], v14, s[8:11], s33 offen sc1
  s_add_u32 s33, s54, 270336
  buffer_store_dwordx2 v[126:127], v14, s[8:11], s33 offen sc1
  v_mov_b32 v111, v10
  v_lshrrev_b32 v8, 3, v1
  v_and_b32 v9, 7, v1
  v_lshrrev_b32 v10, 2, v8
  v_lshlrev_b32 v10, 1, v10
  v_xor_b32 v9, v9, v10
  v_lshlrev_b32 v10, 11, v8
  v_lshl_add_u32 v30, v9, 4, v10
  v_xor_b32 v31, 64, v30
  v_lshlrev_b32 v10, 13, v8
  v_lshl_add_u32 v28, v9, 4, v10
  v_xor_b32 v29, 64, v28
  v_lshrrev_b32 v120, 4, v1
  v_bfe_u32 v121, v1, 2, 2
  v_and_b32 v122, 3, v1
  v_lshrrev_b32 v123, 1, v121
  v_lshlrev_b32 v124, 3, v123
  v_lshlrev_b32 v125, 1, v123
  v_lshrrev_b32 v123, 1, v120
  v_lshl_add_u32 v124, v123, 4, v124
  v_and_b32 v123, 1, v120
  v_lshl_add_u32 v124, v123, 2, v124
  v_add_u32 v125, v125, v123
  v_and_b32 v123, 1, v121
  v_add_u32 v124, v124, v123
  v_lshlrev_b32 v124, 7, v124
  v_lshlrev_b32 v125, 1, v125
  v_lshrrev_b32 v123, 1, v122
  s_lshl_b32 s33, s30, 1
  v_add_u32 v123, s33, v123
  v_xor_b32 v123, v123, v125
  v_lshl_add_u32 v123, v123, 4, v124
  v_and_b32 v8, 1, v122
  v_lshl_add_u32 v34, v8, 3, v123
  v_add_u32 v35, 0x10000, v34
  s_and_b32 s33, s30, 2
  s_lshl_b32 s33, s33, 1
  v_add_u32 v123, s33, v122
  v_xor_b32 v123, v123, v125
  v_lshl_add_u32 v123, v123, 4, v124
  s_and_b32 s33, s30, 1
  s_lshl_b32 s33, s33, 3
  v_add_u32 v32, s33, v123
  v_add_u32 v33, 0x10000, v32
  s_lshl_b32 s56, s28, 4
  s_add_u32 s56, s56, s30
  s_lshl_b32 s56, s56, 17
  s_lshl_b32 s33, s40, 7
  s_add_u32 s56, s56, s33
  s_lshl_b32 s73, s30, 19
  s_lshl_b32 s33, s28, 11
  s_add_u32 s73, s73, s33
  s_lshl_b32 s33, s78, 7
  s_add_u32 s75, s73, s33
  s_lshl_b32 s33, s79, 7
  s_add_u32 s73, s73, s33
  s_lshl_b32 s74, s30, 13
  v_add_u32 v36, s74, v16
  s_load_dwordx2 s[4:5], s[0:1], 24
  s_waitcnt lgkmcnt(0)
  s_mov_b32 s84, s4
  s_mov_b32 s85, s5
  s_mov_b32 s86, 8388608
  s_mov_b32 s87, 0x20000
  s_add_u32 s47, s75, 0
  buffer_load_dwordx4 v[128:131], v28, s[84:87], s47 offen nt
  s_add_u32 s47, s75, 65536
  buffer_load_dwordx4 v[132:135], v29, s[84:87], s47 offen nt
  s_add_u32 s47, s75, 131072
  buffer_load_dwordx4 v[136:139], v28, s[84:87], s47 offen nt
  s_add_u32 s47, s75, 196608
  buffer_load_dwordx4 v[140:143], v29, s[84:87], s47 offen nt
  s_add_u32 s47, s75, 262144
  buffer_load_dwordx4 v[144:147], v28, s[84:87], s47 offen nt
  s_add_u32 s47, s75, 327680
  buffer_load_dwordx4 v[148:151], v29, s[84:87], s47 offen nt
  s_add_u32 s47, s75, 393216
  buffer_load_dwordx4 v[152:155], v28, s[84:87], s47 offen nt
  s_add_u32 s47, s75, 458752
  buffer_load_dwordx4 v[156:159], v29, s[84:87], s47 offen nt
  s_add_u32 s47, s75, 2097152
  buffer_load_dwordx4 v[160:163], v28, s[84:87], s47 offen nt
  s_add_u32 s47, s75, 2162688
  buffer_load_dwordx4 v[164:167], v29, s[84:87], s47 offen nt
  s_add_u32 s47, s75, 2228224
  buffer_load_dwordx4 v[168:171], v28, s[84:87], s47 offen nt
  s_add_u32 s47, s75, 2293760
  buffer_load_dwordx4 v[172:175], v29, s[84:87], s47 offen nt
  s_add_u32 s47, s75, 2359296
  buffer_load_dwordx4 v[176:179], v28, s[84:87], s47 offen nt
  s_add_u32 s47, s75, 2424832
  buffer_load_dwordx4 v[180:183], v29, s[84:87], s47 offen nt
  s_add_u32 s47, s75, 2490368
  buffer_load_dwordx4 v[184:187], v28, s[84:87], s47 offen nt
  s_add_u32 s47, s75, 2555904
  buffer_load_dwordx4 v[188:191], v29, s[84:87], s47 offen nt
  s_add_u32 s47, s75, 4194304
  buffer_load_dwordx4 v[192:195], v28, s[84:87], s47 offen nt
  s_add_u32 s47, s75, 4259840
  buffer_load_dwordx4 v[196:199], v29, s[84:87], s47 offen nt
  s_add_u32 s47, s75, 4325376
  buffer_load_dwordx4 v[200:203], v28, s[84:87], s47 offen nt
  s_add_u32 s47, s75, 4390912
  buffer_load_dwordx4 v[204:207], v29, s[84:87], s47 offen nt
  s_add_u32 s47, s75, 4456448
  buffer_load_dwordx4 v[208:211], v28, s[84:87], s47 offen nt
  s_add_u32 s47, s75, 4521984
  buffer_load_dwordx4 v[212:215], v29, s[84:87], s47 offen nt
  s_add_u32 s47, s75, 4587520
  buffer_load_dwordx4 v[216:219], v28, s[84:87], s47 offen nt
  s_add_u32 s47, s75, 4653056
  buffer_load_dwordx4 v[220:223], v29, s[84:87], s47 offen nt
  s_add_u32 s47, s75, 6291456
  buffer_load_dwordx4 v[224:227], v28, s[84:87], s47 offen nt
  s_add_u32 s47, s75, 6356992
  buffer_load_dwordx4 v[228:231], v29, s[84:87], s47 offen nt
  s_add_u32 s47, s75, 6422528
  buffer_load_dwordx4 v[232:235], v28, s[84:87], s47 offen nt
  s_add_u32 s47, s75, 6488064
  buffer_load_dwordx4 v[236:239], v29, s[84:87], s47 offen nt
  s_add_u32 s47, s75, 6553600
  buffer_load_dwordx4 v[240:243], v28, s[84:87], s47 offen nt
  s_add_u32 s47, s75, 6619136
  buffer_load_dwordx4 v[244:247], v29, s[84:87], s47 offen nt
  s_add_u32 s47, s75, 6684672
  buffer_load_dwordx4 v[248:251], v28, s[84:87], s47 offen nt
  s_add_u32 s47, s75, 6750208
  buffer_load_dwordx4 v[252:255], v29, s[84:87], s47 offen nt
  s_add_u32 s47, s73, 0
  buffer_load_dwordx4 a[0:3], v28, s[20:23], s47 offen nt
  s_add_u32 s47, s73, 65536
  buffer_load_dwordx4 a[4:7], v29, s[20:23], s47 offen nt
  s_add_u32 s47, s73, 131072
  buffer_load_dwordx4 a[8:11], v28, s[20:23], s47 offen nt
  s_add_u32 s47, s73, 196608
  buffer_load_dwordx4 a[12:15], v29, s[20:23], s47 offen nt
  s_add_u32 s47, s73, 262144
  buffer_load_dwordx4 a[16:19], v28, s[20:23], s47 offen nt
  s_add_u32 s47, s73, 327680
  buffer_load_dwordx4 a[20:23], v29, s[20:23], s47 offen nt
  s_add_u32 s47, s73, 393216
  buffer_load_dwordx4 a[24:27], v28, s[20:23], s47 offen nt
  s_add_u32 s47, s73, 458752
  buffer_load_dwordx4 a[28:31], v29, s[20:23], s47 offen nt
  s_waitcnt vmcnt(32)
  ds_write_b128 v36, v[128:131] offset:0
  ds_write_b128 v36, v[132:135] offset:1024
  ds_write_b128 v36, v[136:139] offset:2048
  ds_write_b128 v36, v[140:143] offset:3072
  ds_write_b128 v36, v[144:147] offset:4096
  ds_write_b128 v36, v[148:151] offset:5120
  ds_write_b128 v36, v[152:155] offset:6144
  ds_write_b128 v36, v[156:159] offset:7168
  s_waitcnt lgkmcnt(0)
  s_barrier
  ds_read_b64_tr_b16 v[128:129], v34 offset:0
  ds_read_b64_tr_b16 v[130:131], v34 offset:256
  ds_read_b64_tr_b16 v[132:133], v34 offset:4096
  ds_read_b64_tr_b16 v[134:135], v34 offset:4352
  ds_read_b64_tr_b16 v[136:137], v34 offset:8192
  ds_read_b64_tr_b16 v[138:139], v34 offset:8448
  ds_read_b64_tr_b16 v[140:141], v34 offset:12288
  ds_read_b64_tr_b16 v[142:143], v34 offset:12544
  ds_read_b64_tr_b16 v[144:145], v34 offset:16384
  ds_read_b64_tr_b16 v[146:147], v34 offset:16640
  ds_read_b64_tr_b16 v[148:149], v34 offset:20480
  ds_read_b64_tr_b16 v[150:151], v34 offset:20736
  ds_read_b64_tr_b16 v[152:153], v34 offset:24576
  ds_read_b64_tr_b16 v[154:155], v34 offset:24832
  ds_read_b64_tr_b16 v[156:157], v34 offset:28672
  ds_read_b64_tr_b16 v[158:159], v34 offset:28928
  s_waitcnt lgkmcnt(0)
  buffer_store_dword v110, v111, s[8:11], 0 offen
  s_add_u32 s47, s73, 2097152
  buffer_load_dwordx4 a[32:35], v28, s[20:23], s47 offen nt
  s_add_u32 s47, s73, 2162688
  buffer_load_dwordx4 a[36:39], v29, s[20:23], s47 offen nt
  s_add_u32 s47, s73, 2228224
  buffer_load_dwordx4 a[40:43], v28, s[20:23], s47 offen nt
  s_add_u32 s47, s73, 2293760
  buffer_load_dwordx4 a[44:47], v29, s[20:23], s47 offen nt
  s_add_u32 s47, s73, 2359296
  buffer_load_dwordx4 a[48:51], v28, s[20:23], s47 offen nt
  s_add_u32 s47, s73, 2424832
  buffer_load_dwordx4 a[52:55], v29, s[20:23], s47 offen nt
  s_add_u32 s47, s73, 2490368
  buffer_load_dwordx4 a[56:59], v28, s[20:23], s47 offen nt
  s_add_u32 s47, s73, 2555904
  buffer_load_dwordx4 a[60:63], v29, s[20:23], s47 offen nt
  s_waitcnt vmcnt(33)
  ds_write_b128 v36, v[160:163] offset:32768
  ds_write_b128 v36, v[164:167] offset:33792
  ds_write_b128 v36, v[168:171] offset:34816
  ds_write_b128 v36, v[172:175] offset:35840
  ds_write_b128 v36, v[176:179] offset:36864
  ds_write_b128 v36, v[180:183] offset:37888
  ds_write_b128 v36, v[184:187] offset:38912
  ds_write_b128 v36, v[188:191] offset:39936
  s_waitcnt lgkmcnt(0)
  s_barrier
  ds_read_b64_tr_b16 v[160:161], v34 offset:32768
  ds_read_b64_tr_b16 v[162:163], v34 offset:33024
  ds_read_b64_tr_b16 v[164:165], v34 offset:36864
  ds_read_b64_tr_b16 v[166:167], v34 offset:37120
  ds_read_b64_tr_b16 v[168:169], v34 offset:40960
  ds_read_b64_tr_b16 v[170:171], v34 offset:41216
  ds_read_b64_tr_b16 v[172:173], v34 offset:45056
  ds_read_b64_tr_b16 v[174:175], v34 offset:45312
  ds_read_b64_tr_b16 v[176:177], v34 offset:49152
  ds_read_b64_tr_b16 v[178:179], v34 offset:49408
  ds_read_b64_tr_b16 v[180:181], v34 offset:53248
  ds_read_b64_tr_b16 v[182:183], v34 offset:53504
  ds_read_b64_tr_b16 v[184:185], v34 offset:57344
  ds_read_b64_tr_b16 v[186:187], v34 offset:57600
  ds_read_b64_tr_b16 v[188:189], v34 offset:61440
  ds_read_b64_tr_b16 v[190:191], v34 offset:61696
  s_waitcnt lgkmcnt(0)
  s_add_u32 s47, s73, 4194304
  buffer_load_dwordx4 a[64:67], v28, s[20:23], s47 offen nt
  s_add_u32 s47, s73, 4259840
  buffer_load_dwordx4 a[68:71], v29, s[20:23], s47 offen nt
  s_add_u32 s47, s73, 4325376
  buffer_load_dwordx4 a[72:75], v28, s[20:23], s47 offen nt
  s_add_u32 s47, s73, 4390912
  buffer_load_dwordx4 a[76:79], v29, s[20:23], s47 offen nt
  s_add_u32 s47, s73, 4456448
  buffer_load_dwordx4 a[80:83], v28, s[20:23], s47 offen nt
  s_add_u32 s47, s73, 4521984
  buffer_load_dwordx4 a[84:87], v29, s[20:23], s47 offen nt
  s_add_u32 s47, s73, 4587520
  buffer_load_dwordx4 a[88:91], v28, s[20:23], s47 offen nt
  s_add_u32 s47, s73, 4653056
  buffer_load_dwordx4 a[92:95], v29, s[20:23], s47 offen nt
  s_waitcnt vmcnt(33)
  ds_write_b128 v36, v[192:195] offset:0
  ds_write_b128 v36, v[196:199] offset:1024
  ds_write_b128 v36, v[200:203] offset:2048
  ds_write_b128 v36, v[204:207] offset:3072
  ds_write_b128 v36, v[208:211] offset:4096
  ds_write_b128 v36, v[212:215] offset:5120
  ds_write_b128 v36, v[216:219] offset:6144
  ds_write_b128 v36, v[220:223] offset:7168
  s_waitcnt lgkmcnt(0)
  s_barrier
  ds_read_b64_tr_b16 v[192:193], v34 offset:0
  ds_read_b64_tr_b16 v[194:195], v34 offset:256
  ds_read_b64_tr_b16 v[196:197], v34 offset:4096
  ds_read_b64_tr_b16 v[198:199], v34 offset:4352
  ds_read_b64_tr_b16 v[200:201], v34 offset:8192
  ds_read_b64_tr_b16 v[202:203], v34 offset:8448
  ds_read_b64_tr_b16 v[204:205], v34 offset:12288
  ds_read_b64_tr_b16 v[206:207], v34 offset:12544
  ds_read_b64_tr_b16 v[208:209], v34 offset:16384
  ds_read_b64_tr_b16 v[210:211], v34 offset:16640
  ds_read_b64_tr_b16 v[212:213], v34 offset:20480
  ds_read_b64_tr_b16 v[214:215], v34 offset:20736
  ds_read_b64_tr_b16 v[216:217], v34 offset:24576
  ds_read_b64_tr_b16 v[218:219], v34 offset:24832
  ds_read_b64_tr_b16 v[220:221], v34 offset:28672
  ds_read_b64_tr_b16 v[222:223], v34 offset:28928
  s_waitcnt lgkmcnt(0)
  s_add_u32 s47, s73, 6291456
  buffer_load_dwordx4 a[96:99], v28, s[20:23], s47 offen nt
  s_add_u32 s47, s73, 6356992
  buffer_load_dwordx4 a[100:103], v29, s[20:23], s47 offen nt
  s_add_u32 s47, s73, 6422528
  buffer_load_dwordx4 a[104:107], v28, s[20:23], s47 offen nt
  s_add_u32 s47, s73, 6488064
  buffer_load_dwordx4 a[108:111], v29, s[20:23], s47 offen nt
  s_add_u32 s47, s73, 6553600
  buffer_load_dwordx4 a[112:115], v28, s[20:23], s47 offen nt
  s_add_u32 s47, s73, 6619136
  buffer_load_dwordx4 a[116:119], v29, s[20:23], s47 offen nt
  s_add_u32 s47, s73, 6684672
  buffer_load_dwordx4 a[120:123], v28, s[20:23], s47 offen nt
  s_add_u32 s47, s73, 6750208
  buffer_load_dwordx4 a[124:127], v29, s[20:23], s47 offen nt
  s_waitcnt vmcnt(33)
  ds_write_b128 v36, v[224:227] offset:32768
  ds_write_b128 v36, v[228:231] offset:33792
  ds_write_b128 v36, v[232:235] offset:34816
  ds_write_b128 v36, v[236:239] offset:35840
  ds_write_b128 v36, v[240:243] offset:36864
  ds_write_b128 v36, v[244:247] offset:37888
  ds_write_b128 v36, v[248:251] offset:38912
  ds_write_b128 v36, v[252:255] offset:39936
  s_waitcnt lgkmcnt(0)
  s_barrier
  ds_read_b64_tr_b16 v[224:225], v34 offset:32768
  ds_read_b64_tr_b16 v[226:227], v34 offset:33024
  ds_read_b64_tr_b16 v[228:229], v34 offset:36864
  ds_read_b64_tr_b16 v[230:231], v34 offset:37120
  ds_read_b64_tr_b16 v[232:233], v34 offset:40960
  ds_read_b64_tr_b16 v[234:235], v34 offset:41216
  ds_read_b64_tr_b16 v[236:237], v34 offset:45056
  ds_read_b64_tr_b16 v[238:239], v34 offset:45312
  ds_read_b64_tr_b16 v[240:241], v34 offset:49152
  ds_read_b64_tr_b16 v[242:243], v34 offset:49408
  ds_read_b64_tr_b16 v[244:245], v34 offset:53248
  ds_read_b64_tr_b16 v[246:247], v34 offset:53504
  ds_read_b64_tr_b16 v[248:249], v34 offset:57344
  ds_read_b64_tr_b16 v[250:251], v34 offset:57600
  ds_read_b64_tr_b16 v[252:253], v34 offset:61440
  ds_read_b64_tr_b16 v[254:255], v34 offset:61696
  s_waitcnt lgkmcnt(0)
  s_add_u32 s47, s56, 0
  buffer_load_dwordx4 a[128:131], v30, s[24:27], s47 offen nt
  s_add_u32 s47, s56, 16384
  buffer_load_dwordx4 a[132:135], v31, s[24:27], s47 offen nt
  s_add_u32 s47, s56, 32768
  buffer_load_dwordx4 a[136:139], v30, s[24:27], s47 offen nt
  s_add_u32 s47, s56, 49152
  buffer_load_dwordx4 a[140:143], v31, s[24:27], s47 offen nt
  s_add_u32 s47, s56, 65536
  buffer_load_dwordx4 a[144:147], v30, s[24:27], s47 offen nt
  s_add_u32 s47, s56, 81920
  buffer_load_dwordx4 a[148:151], v31, s[24:27], s47 offen nt
  s_add_u32 s47, s56, 98304
  buffer_load_dwordx4 a[152:155], v30, s[24:27], s47 offen nt
  s_add_u32 s47, s56, 114688
  buffer_load_dwordx4 a[156:159], v31, s[24:27], s47 offen nt
  s_waitcnt vmcnt(33)
  ds_write_b128 v36, a[0:3] offset:0
  ds_write_b128 v36, a[4:7] offset:1024
  ds_write_b128 v36, a[8:11] offset:2048
  ds_write_b128 v36, a[12:15] offset:3072
  ds_write_b128 v36, a[16:19] offset:4096
  ds_write_b128 v36, a[20:23] offset:5120
  ds_write_b128 v36, a[24:27] offset:6144
  ds_write_b128 v36, a[28:31] offset:7168
  s_waitcnt lgkmcnt(0)
  s_barrier
  ds_read_b64_tr_b16 a[0:1], v32 offset:0
  ds_read_b64_tr_b16 a[2:3], v32 offset:256
  ds_read_b64_tr_b16 a[4:5], v32 offset:4096
  ds_read_b64_tr_b16 a[6:7], v32 offset:4352
  ds_read_b64_tr_b16 a[8:9], v32 offset:8192
  ds_read_b64_tr_b16 a[10:11], v32 offset:8448
  ds_read_b64_tr_b16 a[12:13], v32 offset:12288
  ds_read_b64_tr_b16 a[14:15], v32 offset:12544
  ds_read_b64_tr_b16 a[16:17], v32 offset:16384
  ds_read_b64_tr_b16 a[18:19], v32 offset:16640
  ds_read_b64_tr_b16 a[20:21], v32 offset:20480
  ds_read_b64_tr_b16 a[22:23], v32 offset:20736
  ds_read_b64_tr_b16 a[24:25], v32 offset:24576
  ds_read_b64_tr_b16 a[26:27], v32 offset:24832
  ds_read_b64_tr_b16 a[28:29], v32 offset:28672
  ds_read_b64_tr_b16 a[30:31], v32 offset:28928
  s_waitcnt lgkmcnt(0)
  s_add_u32 s47, s56, 524288
  buffer_load_dwordx4 a[160:163], v30, s[24:27], s47 offen nt
  s_add_u32 s47, s56, 540672
  buffer_load_dwordx4 a[164:167], v31, s[24:27], s47 offen nt
  s_add_u32 s47, s56, 557056
  buffer_load_dwordx4 a[168:171], v30, s[24:27], s47 offen nt
  s_add_u32 s47, s56, 573440
  buffer_load_dwordx4 a[172:175], v31, s[24:27], s47 offen nt
  s_add_u32 s47, s56, 589824
  buffer_load_dwordx4 a[176:179], v30, s[24:27], s47 offen nt
  s_add_u32 s47, s56, 606208
  buffer_load_dwordx4 a[180:183], v31, s[24:27], s47 offen nt
  s_add_u32 s47, s56, 622592
  buffer_load_dwordx4 a[184:187], v30, s[24:27], s47 offen nt
  s_add_u32 s47, s56, 638976
  buffer_load_dwordx4 a[188:191], v31, s[24:27], s47 offen nt
  s_waitcnt vmcnt(32)
  ds_write_b128 v36, a[32:35] offset:32768
  ds_write_b128 v36, a[36:39] offset:33792
  ds_write_b128 v36, a[40:43] offset:34816
  ds_write_b128 v36, a[44:47] offset:35840
  ds_write_b128 v36, a[48:51] offset:36864
  ds_write_b128 v36, a[52:55] offset:37888
  ds_write_b128 v36, a[56:59] offset:38912
  ds_write_b128 v36, a[60:63] offset:39936
  s_waitcnt lgkmcnt(0)
  s_barrier
  ds_read_b64_tr_b16 a[32:33], v32 offset:32768
  ds_read_b64_tr_b16 a[34:35], v32 offset:33024
  ds_read_b64_tr_b16 a[36:37], v32 offset:36864
  ds_read_b64_tr_b16 a[38:39], v32 offset:37120
  ds_read_b64_tr_b16 a[40:41], v32 offset:40960
  ds_read_b64_tr_b16 a[42:43], v32 offset:41216
  ds_read_b64_tr_b16 a[44:45], v32 offset:45056
  ds_read_b64_tr_b16 a[46:47], v32 offset:45312
  ds_read_b64_tr_b16 a[48:49], v32 offset:49152
  ds_read_b64_tr_b16 a[50:51], v32 offset:49408
  ds_read_b64_tr_b16 a[52:53], v32 offset:53248
  ds_read_b64_tr_b16 a[54:55], v32 offset:53504
  ds_read_b64_tr_b16 a[56:57], v32 offset:57344
  ds_read_b64_tr_b16 a[58:59], v32 offset:57600
  ds_read_b64_tr_b16 a[60:61], v32 offset:61440
  ds_read_b64_tr_b16 a[62:63], v32 offset:61696
  s_waitcnt lgkmcnt(0)
  s_add_u32 s47, s56, 1048576
  buffer_load_dwordx4 a[192:195], v30, s[24:27], s47 offen nt
  s_add_u32 s47, s56, 1064960
  buffer_load_dwordx4 a[196:199], v31, s[24:27], s47 offen nt
  s_add_u32 s47, s56, 1081344
  buffer_load_dwordx4 a[200:203], v30, s[24:27], s47 offen nt
  s_add_u32 s47, s56, 1097728
  buffer_load_dwordx4 a[204:207], v31, s[24:27], s47 offen nt
  s_add_u32 s47, s56, 1114112
  buffer_load_dwordx4 a[208:211], v30, s[24:27], s47 offen nt
  s_add_u32 s47, s56, 1130496
  buffer_load_dwordx4 a[212:215], v31, s[24:27], s47 offen nt
  s_add_u32 s47, s56, 1146880
  buffer_load_dwordx4 a[216:219], v30, s[24:27], s47 offen nt
  s_add_u32 s47, s56, 1163264
  buffer_load_dwordx4 a[220:223], v31, s[24:27], s47 offen nt
  s_waitcnt vmcnt(32)
  ds_write_b128 v36, a[64:67] offset:0
  ds_write_b128 v36, a[68:71] offset:1024
  ds_write_b128 v36, a[72:75] offset:2048
  ds_write_b128 v36, a[76:79] offset:3072
  ds_write_b128 v36, a[80:83] offset:4096
  ds_write_b128 v36, a[84:87] offset:5120
  ds_write_b128 v36, a[88:91] offset:6144
  ds_write_b128 v36, a[92:95] offset:7168
  s_waitcnt lgkmcnt(0)
  s_barrier
  ds_read_b64_tr_b16 a[64:65], v32 offset:0
  ds_read_b64_tr_b16 a[66:67], v32 offset:256
  ds_read_b64_tr_b16 a[68:69], v32 offset:4096
  ds_read_b64_tr_b16 a[70:71], v32 offset:4352
  ds_read_b64_tr_b16 a[72:73], v32 offset:8192
  ds_read_b64_tr_b16 a[74:75], v32 offset:8448
  ds_read_b64_tr_b16 a[76:77], v32 offset:12288
  ds_read_b64_tr_b16 a[78:79], v32 offset:12544
  ds_read_b64_tr_b16 a[80:81], v32 offset:16384
  ds_read_b64_tr_b16 a[82:83], v32 offset:16640
  ds_read_b64_tr_b16 a[84:85], v32 offset:20480
  ds_read_b64_tr_b16 a[86:87], v32 offset:20736
  ds_read_b64_tr_b16 a[88:89], v32 offset:24576
  ds_read_b64_tr_b16 a[90:91], v32 offset:24832
  ds_read_b64_tr_b16 a[92:93], v32 offset:28672
  ds_read_b64_tr_b16 a[94:95], v32 offset:28928
  s_waitcnt lgkmcnt(0)
  s_add_u32 s47, s56, 1572864
  buffer_load_dwordx4 a[224:227], v30, s[24:27], s47 offen nt
  s_add_u32 s47, s56, 1589248
  buffer_load_dwordx4 a[228:231], v31, s[24:27], s47 offen nt
  s_add_u32 s47, s56, 1605632
  buffer_load_dwordx4 a[232:235], v30, s[24:27], s47 offen nt
  s_add_u32 s47, s56, 1622016
  buffer_load_dwordx4 a[236:239], v31, s[24:27], s47 offen nt
  s_add_u32 s47, s56, 1638400
  buffer_load_dwordx4 a[240:243], v30, s[24:27], s47 offen nt
  s_add_u32 s47, s56, 1654784
  buffer_load_dwordx4 a[244:247], v31, s[24:27], s47 offen nt
  s_add_u32 s47, s56, 1671168
  buffer_load_dwordx4 a[248:251], v30, s[24:27], s47 offen nt
  s_add_u32 s47, s56, 1687552
  buffer_load_dwordx4 a[252:255], v31, s[24:27], s47 offen nt
  s_cmp_lg_u32 s30, 0
  s_cbranch_scc1 ar_123
  s_mov_b64 s[96:97], exec
  s_mov_b64 exec, 1
  v_mov_b32 v8, 64
  v_mov_b32 v9, 1
  buffer_atomic_add v9, v8, s[12:15], 0 offen
  s_mov_b64 exec, s[96:97]
  s_branch are_124
ar_123:
  s_mov_b64 s[96:97], exec
  s_mov_b64 exec, 1
  v_mov_b32 v8, 81920
  buffer_load_dword v9, v8, s[8:11], 0 offen
  s_mov_b64 exec, s[96:97]
are_124:
  s_waitcnt vmcnt(33)
  ds_write_b128 v36, a[96:99] offset:32768
  ds_write_b128 v36, a[100:103] offset:33792
  ds_write_b128 v36, a[104:107] offset:34816
  ds_write_b128 v36, a[108:111] offset:35840
  ds_write_b128 v36, a[112:115] offset:36864
  ds_write_b128 v36, a[116:119] offset:37888
  ds_write_b128 v36, a[120:123] offset:38912
  ds_write_b128 v36, a[124:127] offset:39936
  s_waitcnt lgkmcnt(0)
  s_barrier
  ds_read_b64_tr_b16 a[96:97], v32 offset:32768
  ds_read_b64_tr_b16 a[98:99], v32 offset:33024
  ds_read_b64_tr_b16 a[100:101], v32 offset:36864
  ds_read_b64_tr_b16 a[102:103], v32 offset:37120
  ds_read_b64_tr_b16 a[104:105], v32 offset:40960
  ds_read_b64_tr_b16 a[106:107], v32 offset:41216
  ds_read_b64_tr_b16 a[108:109], v32 offset:45056
  ds_read_b64_tr_b16 a[110:111], v32 offset:45312
  ds_read_b64_tr_b16 a[112:113], v32 offset:49152
  ds_read_b64_tr_b16 a[114:115], v32 offset:49408
  ds_read_b64_tr_b16 a[116:117], v32 offset:53248
  ds_read_b64_tr_b16 a[118:119], v32 offset:53504
  ds_read_b64_tr_b16 a[120:121], v32 offset:57344
  ds_read_b64_tr_b16 a[122:123], v32 offset:57600
  ds_read_b64_tr_b16 a[124:125], v32 offset:61440
  ds_read_b64_tr_b16 a[126:127], v32 offset:61696
  s_waitcnt lgkmcnt(0)
  s_waitcnt vmcnt(25)
  ds_write_b128 v36, a[128:131] offset:0
  ds_write_b128 v36, a[132:135] offset:1024
  ds_write_b128 v36, a[136:139] offset:2048
  ds_write_b128 v36, a[140:143] offset:3072
  ds_write_b128 v36, a[144:147] offset:4096
  ds_write_b128 v36, a[148:151] offset:5120
  ds_write_b128 v36, a[152:155] offset:6144
  ds_write_b128 v36, a[156:159] offset:7168
  s_waitcnt lgkmcnt(0)
  s_barrier
  ds_read_b64_tr_b16 a[128:129], v34 offset:0
  ds_read_b64_tr_b16 a[130:131], v34 offset:256
  ds_read_b64_tr_b16 a[132:133], v34 offset:4096
  ds_read_b64_tr_b16 a[134:135], v34 offset:4352
  ds_read_b64_tr_b16 a[136:137], v34 offset:8192
  ds_read_b64_tr_b16 a[138:139], v34 offset:8448
  ds_read_b64_tr_b16 a[140:141], v34 offset:12288
  ds_read_b64_tr_b16 a[142:143], v34 offset:12544
  ds_read_b64_tr_b16 a[144:145], v34 offset:16384
  ds_read_b64_tr_b16 a[146:147], v34 offset:16640
  ds_read_b64_tr_b16 a[148:149], v34 offset:20480
  ds_read_b64_tr_b16 a[150:151], v34 offset:20736
  ds_read_b64_tr_b16 a[152:153], v34 offset:24576
  ds_read_b64_tr_b16 a[154:155], v34 offset:24832
  ds_read_b64_tr_b16 a[156:157], v34 offset:28672
  ds_read_b64_tr_b16 a[158:159], v34 offset:28928
  s_waitcnt lgkmcnt(0)
  s_waitcnt vmcnt(17)
  ds_write_b128 v36, a[160:163] offset:32768
  ds_write_b128 v36, a[164:167] offset:33792
  ds_write_b128 v36, a[168:171] offset:34816
  ds_write_b128 v36, a[172:175] offset:35840
  ds_write_b128 v36, a[176:179] offset:36864
  ds_write_b128 v36, a[180:183] offset:37888
  ds_write_b128 v36, a[184:187] offset:38912
  ds_write_b128 v36, a[188:191] offset:39936
  s_waitcnt lgkmcnt(0)
  s_barrier
  ds_read_b64_tr_b16 a[160:161], v34 offset:32768
  ds_read_b64_tr_b16 a[162:163], v34 offset:33024
  ds_read_b64_tr_b16 a[164:165], v34 offset:36864
  ds_read_b64_tr_b16 a[166:167], v34 offset:37120
  ds_read_b64_tr_b16 a[168:169], v34 offset:40960
  ds_read_b64_tr_b16 a[170:171], v34 offset:41216
  ds_read_b64_tr_b16 a[172:173], v34 offset:45056
  ds_read_b64_tr_b16 a[174:175], v34 offset:45312
  ds_read_b64_tr_b16 a[176:177], v34 offset:49152
  ds_read_b64_tr_b16 a[178:179], v34 offset:49408
  ds_read_b64_tr_b16 a[180:181], v34 offset:53248
  ds_read_b64_tr_b16 a[182:183], v34 offset:53504
  ds_read_b64_tr_b16 a[184:185], v34 offset:57344
  ds_read_b64_tr_b16 a[186:187], v34 offset:57600
  ds_read_b64_tr_b16 a[188:189], v34 offset:61440
  ds_read_b64_tr_b16 a[190:191], v34 offset:61696
  s_waitcnt lgkmcnt(0)
  s_waitcnt vmcnt(9)
  ds_write_b128 v36, a[192:195] offset:0
  ds_write_b128 v36, a[196:199] offset:1024
  ds_write_b128 v36, a[200:203] offset:2048
  ds_write_b128 v36, a[204:207] offset:3072
  ds_write_b128 v36, a[208:211] offset:4096
  ds_write_b128 v36, a[212:215] offset:5120
  ds_write_b128 v36, a[216:219] offset:6144
  ds_write_b128 v36, a[220:223] offset:7168
  s_waitcnt lgkmcnt(0)
  s_barrier
  ds_read_b64_tr_b16 a[192:193], v34 offset:0
  ds_read_b64_tr_b16 a[194:195], v34 offset:256
  ds_read_b64_tr_b16 a[196:197], v34 offset:4096
  ds_read_b64_tr_b16 a[198:199], v34 offset:4352
  ds_read_b64_tr_b16 a[200:201], v34 offset:8192
  ds_read_b64_tr_b16 a[202:203], v34 offset:8448
  ds_read_b64_tr_b16 a[204:205], v34 offset:12288
  ds_read_b64_tr_b16 a[206:207], v34 offset:12544
  ds_read_b64_tr_b16 a[208:209], v34 offset:16384
  ds_read_b64_tr_b16 a[210:211], v34 offset:16640
  ds_read_b64_tr_b16 a[212:213], v34 offset:20480
  ds_read_b64_tr_b16 a[214:215], v34 offset:20736
  ds_read_b64_tr_b16 a[216:217], v34 offset:24576
  ds_read_b64_tr_b16 a[218:219], v34 offset:24832
  ds_read_b64_tr_b16 a[220:221], v34 offset:28672
  ds_read_b64_tr_b16 a[222:223], v34 offset:28928
  s_waitcnt lgkmcnt(0)
  s_waitcnt vmcnt(0)
  s_cmp_lg_u32 s30, 0
  s_cbranch_scc1 w0_125
  v_mov_b32 v8, 64
  s_mov_b32 s32, 0
wf_126:
  buffer_load_dword v9, v8, s[12:15], 0 offen sc1
  s_waitcnt vmcnt(0)
  v_cmp_gt_u32 vcc, 256, v9
  s_cbranch_vccz wfd_127
  s_sleep 4
  s_add_u32 s32, s32, 1
  s_cmp_lt_u32 s32, s31
  s_cbranch_scc1 wf_126
  s_mov_b32 s31, 0
wfd_127:
w0_125:
  s_barrier
  s_mov_b32 s33, 0
  buffer_load_dword v44, v13, s[8:11], s33 offen sc1
  s_mov_b32 s33, 0
  buffer_load_dword v46, v6, s[8:11], s33 offen sc1
  buffer_load_dword v47, v12, s[8:11], s33 offen sc1
  s_mov_b32 s33, 16384
  buffer_load_dword v44, v13, s[8:11], s33 offen sc1
  s_mov_b32 s33, 32768
  buffer_load_dword v46, v6, s[8:11], s33 offen sc1
  buffer_load_dword v47, v12, s[8:11], s33 offen sc1
  s_mov_b32 s33, 32768
  buffer_load_dword v44, v13, s[8:11], s33 offen sc1
  s_mov_b32 s33, 65536
  buffer_load_dword v46, v6, s[8:11], s33 offen sc1
  buffer_load_dword v47, v12, s[8:11], s33 offen sc1
  buffer_load_dword v45, v19, s[8:11], s57 offen sc1
  ds_write_b128 v36, a[224:227] offset:32768
  ds_write_b128 v36, a[228:231] offset:33792
  ds_write_b128 v36, a[232:235] offset:34816
  ds_write_b128 v36, a[236:239] offset:35840
  ds_write_b128 v36, a[240:243] offset:36864
  ds_write_b128 v36, a[244:247] offset:37888
  ds_write_b128 v36, a[248:251] offset:38912
  ds_write_b128 v36, a[252:255] offset:39936
  s_waitcnt lgkmcnt(0)
  s_barrier
  ds_read_b64_tr_b16 a[224:225], v34 offset:32768
  ds_read_b64_tr_b16 a[226:227], v34 offset:33024
  ds_read_b64_tr_b16 a[228:229], v34 offset:36864
  ds_read_b64_tr_b16 a[230:231], v34 offset:37120
  ds_read_b64_tr_b16 a[232:233], v34 offset:40960
  ds_read_b64_tr_b16 a[234:235], v34 offset:41216
  ds_read_b64_tr_b16 a[236:237], v34 offset:45056
  ds_read_b64_tr_b16 a[238:239], v34 offset:45312
  ds_read_b64_tr_b16 a[240:241], v34 offset:49152
  ds_read_b64_tr_b16 a[242:243], v34 offset:49408
  ds_read_b64_tr_b16 a[244:245], v34 offset:53248
  ds_read_b64_tr_b16 a[246:247], v34 offset:53504
  ds_read_b64_tr_b16 a[248:249], v34 offset:57344
  ds_read_b64_tr_b16 a[250:251], v34 offset:57600
  ds_read_b64_tr_b16 a[252:253], v34 offset:61440
  ds_read_b64_tr_b16 a[254:255], v34 offset:61696
  s_waitcnt lgkmcnt(0)
  s_barrier
  s_mov_b32 s43, 0
  s_mov_b32 s44, 0
  s_mov_b32 s45, 1
  s_mov_b32 s46, 2
  s_mov_b32 s69, 0
  s_mov_b32 s64, 0
L_VO_loop:
  v_mov_b32 v28, 0
  v_mov_b32 v29, 0
  v_mov_b32 v30, 0
  v_mov_b32 v31, 0
  v_mov_b32 v32, 0
  v_mov_b32 v33, 0
  v_mov_b32 v34, 0
  v_mov_b32 v35, 0
L_VO_next:
  s_lshl_b32 s47, s44, 14
  s_add_u32 s47, s47, s42
  s_mov_b64 exec, 0xf
  s_mov_b32 s32, 0
  buffer_load_dword v8, v3, s[8:11], 0 offen sc1
  s_sleep 1
  buffer_load_dword v9, v3, s[8:11], 0 offen sc1
  s_sleep 1
pp_128:
  buffer_load_dword v10, v3, s[8:11], 0 offen sc1
  s_waitcnt vmcnt(2)
  v_cmp_gt_u32 vcc, s43, v8
  s_cbranch_vccz ppx_130
  buffer_load_dword v8, v3, s[8:11], 0 offen sc1
  s_waitcnt vmcnt(2)
  v_cmp_gt_u32 vcc, s43, v9
  s_cbranch_vccz ppx_131
  buffer_load_dword v9, v3, s[8:11], 0 offen sc1
  s_waitcnt vmcnt(2)
  v_cmp_gt_u32 vcc, s43, v10
  s_cbranch_vccz ppx_132
  s_add_u32 s32, s32, 1
  s_cmp_lt_u32 s32, s31
  s_cbranch_scc1 pp_128
  s_mov_b32 s31, 0
ppx_132:
ppx_131:
ppx_130:
ppd_129:
  s_mov_b64 exec, -1
  s_add_u32 m0, s80, 131072
  s_add_u32 s48, s47, s80
  buffer_load_dwordx4 v2, s[8:11], s48 offen sc1 lds
  s_add_u32 m0, s81, 131072
  s_add_u32 s48, s47, s81
  buffer_load_dwordx4 v2, s[8:11], s48 offen sc1 lds
  s_add_u32 m0, s82, 131072
  s_add_u32 s48, s47, s82
  buffer_load_dwordx4 v2, s[8:11], s48 offen sc1 lds
  s_add_u32 m0, s83, 131072
  s_add_u32 s48, s47, s83
  buffer_load_dwordx4 v2, s[8:11], s48 offen sc1 lds
  s_waitcnt vmcnt(3)
  s_barrier
  ds_read_b128 v[44:47], v4 offset:0
  ds_read_b128 v[48:51], v4 offset:1024
  ds_read_b128 v[52:55], v4 offset:2048
  ds_read_b128 v[56:59], v4 offset:12288
  s_waitcnt lgkmcnt(3)
  v_smfmac_f32_16x16x64_bf16 v[28:31], v[44:47], v[128:135], v7
  s_waitcnt lgkmcnt(2)
  v_smfmac_f32_16x16x64_bf16 v[28:31], v[48:51], v[136:143], v7
  s_waitcnt vmcnt(2)
  s_barrier
  ds_read_b128 v[60:63], v4 offset:3072
  ds_read_b128 v[64:67], v4 offset:4096
  ds_read_b128 v[68:71], v4 offset:5120
  ds_read_b128 v[72:75], v4 offset:13312
  s_waitcnt lgkmcnt(5)
  v_smfmac_f32_16x16x64_bf16 v[28:31], v[52:55], v[144:151], v7
  s_waitcnt lgkmcnt(4)
  v_smfmac_f32_16x16x64_bf16 v[28:31], v[56:59], v[224:231], v7
  s_waitcnt lgkmcnt(3)
  v_smfmac_f32_16x16x64_bf16 v[28:31], v[60:63], v[152:159], v7
  s_waitcnt lgkmcnt(2)
  v_smfmac_f32_16x16x64_bf16 v[28:31], v[64:67], v[160:167], v7
  s_waitcnt vmcnt(1)
  s_barrier
  ds_read_b128 v[76:79], v4 offset:6144
  ds_read_b128 v[80:83], v4 offset:7168
  ds_read_b128 v[84:87], v4 offset:8192
  ds_read_b128 v[88:91], v4 offset:14336
  s_waitcnt lgkmcnt(5)
  v_smfmac_f32_16x16x64_bf16 v[28:31], v[68:71], v[168:175], v7
  s_waitcnt lgkmcnt(4)
  v_smfmac_f32_16x16x64_bf16 v[28:31], v[72:75], v[232:239], v7
  s_waitcnt lgkmcnt(3)
  v_smfmac_f32_16x16x64_bf16 v[28:31], v[76:79], v[176:183], v7
  s_waitcnt lgkmcnt(2)
  v_smfmac_f32_16x16x64_bf16 v[28:31], v[80:83], v[184:191], v7
  s_waitcnt vmcnt(0)
  s_barrier
  ds_read_b128 v[92:95], v4 offset:9216
  ds_read_b128 v[96:99], v4 offset:10240
  ds_read_b128 v[100:103], v4 offset:11264
  ds_read_b128 v[104:107], v4 offset:15360
  s_waitcnt lgkmcnt(5)
  v_smfmac_f32_16x16x64_bf16 v[28:31], v[84:87], v[192:199], v7
  s_waitcnt lgkmcnt(4)
  v_smfmac_f32_16x16x64_bf16 v[28:31], v[88:91], v[240:247], v7
  s_waitcnt lgkmcnt(3)
  v_smfmac_f32_16x16x64_bf16 v[28:31], v[92:95], v[200:207], v7
  s_waitcnt lgkmcnt(2)
  v_smfmac_f32_16x16x64_bf16 v[28:31], v[96:99], v[208:215], v7
  s_waitcnt lgkmcnt(1)
  v_smfmac_f32_16x16x64_bf16 v[28:31], v[100:103], v[216:223], v7
  s_waitcnt lgkmcnt(0)
  v_smfmac_f32_16x16x64_bf16 v[28:31], v[104:107], v[248:255], v7
  s_lshl_b32 s47, s44, 15
  v_smfmac_f32_16x16x64_bf16 v[32:35], v[44:47], a[0:7], v7
  v_smfmac_f32_16x16x64_bf16 v[32:35], v[48:51], a[8:15], v7
  s_nop 4
  v_add_f32 v28, v28, v29
  v_add_f32 v30, v30, v31
  v_cmp_u_f32 vcc, v28, v30
  v_cvt_pk_bf16_f32 v109, v28, v30
  s_nop 0
  v_cndmask_b32 v109, v109, v20, vcc
  buffer_store_dword v109, v12, s[8:11], s47 offen
  s_cbranch_vccnz L_VO_redo
L_VO_cont:
  v_smfmac_f32_16x16x64_bf16 v[32:35], v[52:55], a[16:23], v7
  v_smfmac_f32_16x16x64_bf16 v[32:35], v[56:59], a[96:103], v7
  v_smfmac_f32_16x16x64_bf16 v[32:35], v[60:63], a[24:31], v7
  v_smfmac_f32_16x16x64_bf16 v[32:35], v[64:67], a[32:39], v7
  v_smfmac_f32_16x16x64_bf16 v[32:35], v[68:71], a[40:47], v7
  v_smfmac_f32_16x16x64_bf16 v[32:35], v[72:75], a[104:111], v7
  v_smfmac_f32_16x16x64_bf16 v[32:35], v[76:79], a[48:55], v7
  v_smfmac_f32_16x16x64_bf16 v[32:35], v[80:83], a[56:63], v7
  v_smfmac_f32_16x16x64_bf16 v[32:35], v[84:87], a[64:71], v7
  v_smfmac_f32_16x16x64_bf16 v[32:35], v[88:91], a[112:119], v7
  v_smfmac_f32_16x16x64_bf16 v[32:35], v[92:95], a[72:79], v7
  v_smfmac_f32_16x16x64_bf16 v[32:35], v[96:99], a[80:87], v7
  v_smfmac_f32_16x16x64_bf16 v[32:35], v[100:103], a[88:95], v7
  v_smfmac_f32_16x16x64_bf16 v[32:35], v[104:107], a[120:127], v7
  s_nop 7
  v_add_f32 v32, v32, v33
  v_add_f32 v34, v34, v35
  v_cvt_pk_bf16_f32 v108, v32, v34
  buffer_store_dword v108, v6, s[8:11], s47 offen
  s_lshl_b32 s48, s43, 16
  buffer_store_dword v108, v18, s[8:11], s48 offen sc1
  s_lshl_b32 s48, s46, 15
  buffer_store_dword v20, v6, s[8:11], s48 offen
  buffer_store_dword v20, v12, s[8:11], s48 offen
  s_lshl_b32 s48, s46, 14
  buffer_store_dword v20, v13, s[8:11], s48 offen
  s_add_u32 s52, s43, 1
  v_mov_b32 v110, s50
  v_mov_b32 v111, s52
  s_barrier
  s_cmp_lg_u32 s43, 2
  s_cbranch_scc1 pg_133
  v_mov_b32 v8, 68
  s_mov_b32 s32, 0
wf_134:
  buffer_load_dword v9, v8, s[12:15], 0 offen sc1
  s_waitcnt vmcnt(0)
  v_cmp_gt_u32 vcc, 1, v9
  s_cbranch_vccz wfd_135
  s_sleep 2
  s_add_u32 s32, s32, 1
  s_cmp_lt_u32 s32, s31
  s_cbranch_scc1 wf_134
  s_mov_b32 s31, 0
wfd_135:
  v_readfirstlane_b32 s58, v9
  s_nop 3
  s_and_b32 s58, s58, 2
  s_lshl_b32 s58, s58, 12
  s_add_u32 s54, s54, s58
  s_add_u32 s66, s66, s58
  s_add_u32 s67, s67, s58
  s_add_u32 s68, s68, s58
pg_133:
  s_cmp_eq_u32 s43, 63
  s_cbranch_scc1 L_VO_last
  s_lshr_b32 s65, s43, 1
  s_not_b32 s65, s65
  s_and_b32 s65, s65, 1
  s_and_b32 s48, s43, 1
  s_lshl_b32 s48, s48, 18
  s_add_u32 s59, s48, s54
  s_add_u32 s70, s48, s66
  s_add_u32 s71, s48, s67
  s_add_u32 s72, s48, s68
  s_lshl_b32 s35, s30, 10
  s_add_u32 s35, s35, 131072
L_VO_oagain:
  v_mov_b32 v28, 0
  v_mov_b32 v29, 0
  v_mov_b32 v30, 0
  v_mov_b32 v31, 0
  s_mov_b64 exec, 0xf
  s_mov_b32 s32, 0
  buffer_load_dword v8, v24, s[8:11], 0 offen sc1
  s_sleep 1
  buffer_load_dword v9, v24, s[8:11], 0 offen sc1
  s_sleep 1
pp_136:
  buffer_load_dword v10, v24, s[8:11], 0 offen sc1
  s_waitcnt vmcnt(2)
  v_cmp_gt_u32 vcc, s52, v8
  s_cbranch_vccz ppx_138
  buffer_load_dword v8, v24, s[8:11], 0 offen sc1
  s_waitcnt vmcnt(2)
  v_cmp_gt_u32 vcc, s52, v9
  s_cbranch_vccz ppx_139
  buffer_load_dword v9, v24, s[8:11], 0 offen sc1
  s_waitcnt vmcnt(2)
  v_cmp_gt_u32 vcc, s52, v10
  s_cbranch_vccz ppx_140
  s_add_u32 s32, s32, 1
  s_cmp_lt_u32 s32, s31
  s_cbranch_scc1 pp_136
  s_mov_b32 s31, 0
ppx_140:
ppx_139:
ppx_138:
ppd_137:
  s_mov_b64 exec, -1
  s_add_u32 m0, s35, 0
  s_add_u32 s48, s47, 0
  buffer_load_dwordx4 v5, s[8:11], s48 offen sc1 lds
  s_add_u32 m0, s35, 4096
  s_add_u32 s48, s47, 4096
  buffer_load_dwordx4 v5, s[8:11], s48 offen sc1 lds
  s_add_u32 m0, s35, 8192
  s_add_u32 s48, s47, 8192
  buffer_load_dwordx4 v5, s[8:11], s48 offen sc1 lds
  s_add_u32 m0, s35, 12288
  s_add_u32 s48, s47, 12288
  buffer_load_dwordx4 v5, s[8:11], s48 offen sc1 lds
  s_waitcnt vmcnt(3)
  s_barrier
  s_mov_b64 exec, 1
  buffer_store_dword v111, v110, s[8:11], 0 offen sc1
  s_mov_b64 exec, -1
  ds_read_b128 v[44:47], v15 offset:0
  ds_read_b128 v[48:51], v15 offset:1024
  ds_read_b128 v[52:55], v15 offset:2048
  ds_read_b128 v[56:59], v15 offset:3072
  s_waitcnt lgkmcnt(3)
  v_smfmac_f32_16x16x64_bf16 v[28:31], v[44:47], a[128:135], v7
  s_waitcnt lgkmcnt(2)
  v_smfmac_f32_16x16x64_bf16 v[28:31], v[48:51], a[136:143], v7
  s_waitcnt vmcnt(3)
  s_barrier
  ds_read_b128 v[60:63], v15 offset:4096
  ds_read_b128 v[64:67], v15 offset:5120
  ds_read_b128 v[68:71], v15 offset:6144
  ds_read_b128 v[72:75], v15 offset:7168
  s_waitcnt lgkmcnt(5)
  v_smfmac_f32_16x16x64_bf16 v[28:31], v[52:55], a[144:151], v7
  s_waitcnt lgkmcnt(4)
  v_smfmac_f32_16x16x64_bf16 v[28:31], v[56:59], a[152:159], v7
  s_waitcnt lgkmcnt(3)
  v_smfmac_f32_16x16x64_bf16 v[28:31], v[60:63], a[160:167], v7
  s_waitcnt lgkmcnt(2)
  v_smfmac_f32_16x16x64_bf16 v[28:31], v[64:67], a[168:175], v7
  s_waitcnt vmcnt(2)
  s_barrier
  ds_read_b128 v[76:79], v15 offset:8192
  ds_read_b128 v[80:83], v15 offset:9216
  ds_read_b128 v[84:87], v15 offset:10240
  ds_read_b128 v[88:91], v15 offset:11264
  s_waitcnt lgkmcnt(5)
  v_smfmac_f32_16x16x64_bf16 v[28:31], v[68:71], a[176:183], v7
  s_waitcnt lgkmcnt(4)
  v_smfmac_f32_16x16x64_bf16 v[28:31], v[72:75], a[184:191], v7
  s_waitcnt lgkmcnt(3)
  v_smfmac_f32_16x16x64_bf16 v[28:31], v[76:79], a[192:199], v7
  s_waitcnt lgkmcnt(2)
  v_smfmac_f32_16x16x64_bf16 v[28:31], v[80:83], a[200:207], v7
  s_waitcnt vmcnt(1)
  s_barrier
  ds_read_b128 v[92:95], v15 offset:12288
  ds_read_b128 v[96:99], v15 offset:13312
  ds_read_b128 v[100:103], v15 offset:14336
  ds_read_b128 v[104:107], v15 offset:15360
  s_waitcnt lgkmcnt(5)
  v_smfmac_f32_16x16x64_bf16 v[28:31], v[84:87], a[208:215], v7
  s_waitcnt lgkmcnt(4)
  v_smfmac_f32_16x16x64_bf16 v[28:31], v[88:91], a[216:223], v7
  s_waitcnt lgkmcnt(3)
  v_smfmac_f32_16x16x64_bf16 v[28:31], v[92:95], a[224:231], v7
  s_waitcnt lgkmcnt(2)
  v_smfmac_f32_16x16x64_bf16 v[28:31], v[96:99], a[232:239], v7
  s_waitcnt lgkmcnt(1)
  v_smfmac_f32_16x16x64_bf16 v[28:31], v[100:103], a[240:247], v7
  s_waitcnt lgkmcnt(0)
  v_smfmac_f32_16x16x64_bf16 v[28:31], v[104:107], a[248:255], v7
  s_nop 7
  v_add_f32 v112, v28, v29
  v_add_f32 v113, v30, v31
  v_mov_b32 v8, s65
  v_cmp_u_f32 vcc, v112, v113
  v_xor_b32 v9, 1, v8
  s_nop 0
  v_cndmask_b32 v8, v8, v9, vcc
  v_bfi_b32 v112, 1, v8, v112
  buffer_store_dwordx2 v[112:113], v14, s[8:11], s59 offen sc1
  s_cbranch_vccnz L_VO_oredo
L_VO_ogo:
  s_barrier
  s_lshl_b32 s47, s45, 14
  v_mov_b32 v28, 0
  v_mov_b32 v29, 0
  v_mov_b32 v30, 0
  v_mov_b32 v31, 0
  v_mov_b32 v32, 0
  v_mov_b32 v33, 0
  v_mov_b32 v34, 0
  v_mov_b32 v35, 0
  s_mov_b32 s33, s44
  s_mov_b32 s44, s45
  s_mov_b32 s45, s46
  s_mov_b32 s46, s33
  s_add_u32 s43, s43, 1
  s_sleep 4
  s_mov_b32 s32, 0
  buffer_load_dwordx2 v[116:117], v14, s[8:11], s70 offen sc1
  buffer_load_dwordx2 v[118:119], v14, s[8:11], s71 offen sc1
  buffer_load_dwordx2 v[120:121], v14, s[8:11], s72 offen sc1
  s_sleep 2
pp_141:
  buffer_load_dwordx2 v[122:123], v14, s[8:11], s70 offen sc1
  buffer_load_dwordx2 v[124:125], v14, s[8:11], s71 offen sc1
  buffer_load_dwordx2 v[126:127], v14, s[8:11], s72 offen sc1
  s_waitcnt vmcnt(3)
  v_bitop3_b32 v17, v116, v118, s65 bitop3:0x7e
  v_xor_b32 v10, s65, v120
  v_or_b32 v17, v17, v10
  v_and_b32 v17, 1, v17
  v_cmp_eq_u32 vcc, 1, v17
  s_cbranch_vccz ppx_143
  buffer_load_dwordx2 v[116:117], v14, s[8:11], s70 offen sc1
  buffer_load_dwordx2 v[118:119], v14, s[8:11], s71 offen sc1
  buffer_load_dwordx2 v[120:121], v14, s[8:11], s72 offen sc1
  s_waitcnt vmcnt(3)
  v_bitop3_b32 v17, v122, v124, s65 bitop3:0x7e
  v_xor_b32 v10, s65, v126
  v_or_b32 v17, v17, v10
  v_and_b32 v17, 1, v17
  v_cmp_eq_u32 vcc, 1, v17
  s_cbranch_vccz ppx_144
  s_add_u32 s32, s32, 1
  s_cmp_lt_u32 s32, s31
  s_cbranch_scc1 pp_141
  s_mov_b32 s31, 0
ppx_144:
  v_add_f32 v112, v112, v122
  v_add_f32 v113, v113, v123
  v_add_f32 v114, v124, v126
  v_add_f32 v115, v125, v127
  v_add_f32 v112, v112, v114
  v_add_f32 v113, v113, v115
  s_branch ppd_142
ppx_143:
  v_add_f32 v112, v112, v116
  v_add_f32 v113, v113, v117
  v_add_f32 v114, v118, v120
  v_add_f32 v115, v119, v121
  v_add_f32 v112, v112, v114
  v_add_f32 v113, v113, v115
ppd_142:
  s_nop 0
  v_mov_b32_dpp v114, v112 quad_perm:[1,0,3,2] row_mask:0xf bank_mask:0xf
  v_mov_b32_dpp v115, v113 quad_perm:[1,0,3,2] row_mask:0xf bank_mask:0xf
  v_cndmask_b32 v112, v112, v115, s[62:63]
  v_cndmask_b32 v113, v114, v113, s[62:63]
  v_cvt_pk_bf16_f32 v8, v112, v113
  buffer_store_dword v8, v13, s[8:11], s47 offen
  v_mov_b32 v9, s52
  s_barrier
  s_cmp_lg_u32 s30, 0
  s_cbranch_scc1 w0_145
  s_mov_b64 exec, 1
  buffer_store_dword v9, v19, s[8:11], s57 offen
  s_mov_b64 exec, -1
w0_145:
  s_branch L_VO_next
L_VO_last:
  s_waitcnt vmcnt(0)
  s_barrier
  s_cmp_lg_u32 s30, 0
  s_cbranch_scc1 w0_146
  s_mov_b64 s[96:97], exec
  s_mov_b64 exec, 1
  v_mov_b32 v8, s50
  v_mov_b32 v9, s52
  buffer_store_dword v9, v8, s[8:11], 0 offen sc1
  s_mov_b64 exec, s[96:97]
w0_146:
  s_endpgm
L_VO_redo:
  s_add_u32 s64, s64, 1
  s_cmp_ge_u32 s64, 0x10000
  s_cbranch_scc1 L_VO_cont
  s_waitcnt lgkmcnt(0)
  s_nop 7
  s_barrier
  s_branch L_VO_loop
L_VO_oredo:
  s_add_u32 s69, s69, 1
  s_cmp_ge_u32 s69, 0x10000
  s_cbranch_scc1 L_VO_ogo
  s_waitcnt vmcnt(0) lgkmcnt(0)
  s_barrier
  s_branch L_VO_oagain

.section .rodata,"a"
.p2align 6
.amdhsa_kernel gated_mix__memory_aug_recurrent_mem_tr__dense_activation_silu__prompt_kernel
  .amdhsa_next_free_vgpr 512
  .amdhsa_next_free_sgpr 102
  .amdhsa_accum_offset 256
  .amdhsa_group_segment_fixed_size 0
  .amdhsa_kernarg_size 112
  .amdhsa_user_sgpr_count 2
  .amdhsa_user_sgpr_kernarg_segment_ptr 1
  .amdhsa_system_sgpr_workgroup_id_x 1
  .amdhsa_float_denorm_mode_32 3
.end_amdhsa_kernel
```
